```python
import torch

def _softmax(x, axis=-1):
    return torch.softmax(x, dim=axis)
def _gelu(x):
    return torch.nn.functional.gelu(x, approximate="tanh")
def _silu(x):
    return torch.nn.functional.silu(x)
def _sigmoid(x):
    return torch.sigmoid(x)
def _layernorm(x, axis=-1, eps=1e-5):
    m = x.mean(dim=axis, keepdim=True)
    v = x.var(dim=axis, keepdim=True, unbiased=False)
    return (x - m) / torch.sqrt(v + eps)
def _scatter_add(tgt, idx, src, axis=0):
    return tgt.clone().index_add_(axis, idx, src)
def _segment_sum(src, seg, n):
    out = torch.zeros((n,) + src.shape[1:], dtype=src.dtype)
    return out.index_add_(0, seg, src)
def _pad(x, pw):
    flat = tuple(v for pair in reversed(pw) for v in pair)
    return torch.nn.functional.pad(x, flat)

kernel_name = 'recurrent_scan__mha_block__swiglu_ffn__prompt'

def setup_inputs():

    _w = (lambda a: (lambda t: t.to(torch.bfloat16) if t.is_floating_point() else t)(torch.as_tensor(a)))
    def _A_setup():
        B, S, D, H = 1, 2048, 1024, 32
        return {
            "x": _w((lambda *s: torch.randn(*s, dtype=torch.bfloat16) * 0.05)(B, S, D)),
            "wqkv": _w((lambda *s: torch.randn(*s, dtype=torch.bfloat16) * 0.05)(D, 3 * D)),
            "wo": _w((lambda *s: torch.randn(*s, dtype=torch.bfloat16) * 0.05)(D, D)),
        }
    _A_in = _A_setup()

    def _B_setup():
        B, S, D, F = 1, 2048, 1024, 3584
        return {
            "x": _w((lambda *s: torch.randn(*s, dtype=torch.bfloat16) * 0.05)(B, S, D)),
            "w_gate": _w((lambda *s: torch.randn(*s, dtype=torch.bfloat16) * 0.05)(D, F)),
            "w_up": _w((lambda *s: torch.randn(*s, dtype=torch.bfloat16) * 0.05)(D, F)),
            "w_down": _w((lambda *s: torch.randn(*s, dtype=torch.bfloat16) * 0.05)(F, D)),
        }
    _B_in = _B_setup()

    return {
        "A_x": _A_in["x"],
        "A_wqkv": _A_in["wqkv"],
        "A_wo": _A_in["wo"],
        "B_x": _B_in["x"],
        "B_w_gate": _B_in["w_gate"],
        "B_w_up": _B_in["w_up"],
        "B_w_down": _B_in["w_down"],
    }

def reference(A_x, A_wqkv, A_wo, B_x, B_w_gate, B_w_up, B_w_down):
    def _A_ref(x, wqkv, wo):
        B, S, D = x.shape
        H = 32
        Dh = D // H
        qkv = (lambda x, *d: x.permute(*d))((x @ wqkv).reshape(B, S, 3, H, Dh), 2, 0, 3, 1, 4)
        q, k, v = qkv[0], qkv[1], qkv[2]
        scores = torch.einsum("bhqd,bhkd->bhqk", q, k) * (Dh ** -0.5)
        p = _softmax(scores, axis=-1)
        o = torch.einsum("bhqk,bhkd->bhqd", p, v)
        return (lambda x, *d: x.permute(*d))(o, 0, 2, 1, 3).reshape(B, S, D) @ wo

    def _B_ref(x, w_gate, w_up, w_down):
        g = _silu(x @ w_gate)
        u = x @ w_up
        return (g * u) @ w_down

    x = A_x
    xn = _layernorm(x, axis=-1)
    s = _A_ref(xn, A_wqkv, A_wo)
    g = _silu(_B_ref(xn, B_w_gate, B_w_up, B_w_down))
    return x + s * g
```

```asm
; @launch grid=(256,1,1) block=(512,1,1) lds=163840
.amdgcn_target "amdgcn-amd-amdhsa--gfx950"
.text
.globl recurrent_scan__mha_block__swiglu_ffn__prompt_kernel
.p2align 8
.type recurrent_scan__mha_block__swiglu_ffn__prompt_kernel,@function
recurrent_scan__mha_block__swiglu_ffn__prompt_kernel:
  s_cmp_ge_u32 s2, 256
  s_cbranch_scc1 L_end
  s_load_dwordx16 s[4:19], s[0:1], 0
  s_load_dwordx4 s[20:23], s[0:1], 64
  s_memrealtime s[54:55]
  v_lshrrev_b32 v1, 6, v0
  v_and_b32 v221, 63, v0
  v_readfirstlane_b32 s48, v1
  s_lshr_b32 s56, s2, 3
  s_and_b32 s57, s2, 7
  s_and_b32 s49, s56, 7
  s_lshr_b32 s58, s56, 3
  s_lshl_b32 s50, s57, 2
  s_add_u32 s50, s50, s58
  s_add_u32 s50, s50, 0
  s_and_b32 s50, s50, 31
  s_bfe_u32 s65, s2, 0x10005
  s_and_b32 s52, s2, 3
  s_lshl_b32 s52, s52, 2
  s_and_b32 s66, s56, 3
  s_add_u32 s52, s52, s66
  s_and_b32 s66, s2, 4
  s_add_u32 s66, s66, s58
  s_lshl_b32 s53, s66, 1
  s_add_u32 s53, s53, s65
  s_and_b32 s51, s48, 3
  s_lshl_b32 s59, s2, 3
  s_add_u32 s59, s59, s48
  s_lshl_b32 s77, s59, 3
  s_add_u32 s77, s77, 131072
  s_lshr_b32 s69, s2, 2
  s_lshl_b32 s69, s69, 5
  s_and_b32 s56, s2, 1
  s_lshl_b32 s56, s56, 4
  s_add_u32 s69, s69, s56
  s_and_b32 s56, s2, 2
  s_lshl_b32 s56, s56, 1
  s_add_u32 s69, s69, s56
  s_and_b32 s56, s48, 4
  s_lshl_b32 s56, s56, 1
  s_add_u32 s69, s69, s56
  s_add_u32 s69, s69, s51
  s_lshl_b32 s69, s69, 11
  v_lshlrev_b32 v224, 4, v221
  s_waitcnt lgkmcnt(0)
  s_mov_b32 s24, s4
  s_and_b32 s25, s5, 0xffff
  s_mov_b32 s26, 4194304
  s_mov_b32 s27, 0x20000
  buffer_load_dwordx4 v[2:5], v224, s[24:27], s69 offen
  buffer_load_dwordx4 v[6:9], v224, s[24:27], s69 offen offset:1024
  s_mov_b32 s40, s20
  s_and_b32 s41, s21, 0xffff
  s_mov_b32 s42, 256
  s_mov_b32 s43, 0x20000
  s_cmp_lg_u32 s59, 0
  s_cbranch_scc1 L_no_tag
  s_or_b32 s54, s54, 1
  v_mov_b32 v10, s54
  v_mov_b32 v11, s55
  s_mov_b64 exec, 1
  buffer_store_dwordx2 v[10:11], off, s[40:43], 0 sc1
  s_mov_b64 exec, -1
L_no_tag:
  s_getpc_b64 s[56:57]
L_pc:
  s_lshl_b32 s58, s48, 13
  v_lshlrev_b32 v12, 7, v221
  s_cmp_lt_u32 s2, 16
  s_cselect_b32 s3, -1, 0
  v_add_u32 v12, s58, v12
  v_and_b32 v12, s3, v12
  v_min_u32 v12, L_end - L_pc, v12
  global_load_dword v229, v12, s[56:57]
  s_add_u32 s44, s22, 34603008
  s_addc_u32 s45, s23, 0
  s_and_b32 s45, s45, 0xffff
  s_mov_b32 s46, 1048576
  s_mov_b32 s47, 0x20000
  s_mov_b32 s36, s6
  s_and_b32 s37, s7, 0xffff
  s_mov_b32 s38, 6291456
  s_mov_b32 s39, 0x20000
  s_cmp_eq_u32 s48, 7
  s_cbranch_scc1 L_w7
  s_mov_b32 s28, s12
  s_and_b32 s29, s13, 0xffff
  s_mov_b32 s30, 7340032
  s_mov_b32 s31, 0x20000
  s_mov_b32 s32, s14
  s_and_b32 s33, s15, 0xffff
  s_mov_b32 s34, 7340032
  s_mov_b32 s35, 0x20000
  s_lshl_b32 s56, s48, 6
  v_add_u32 v225, s56, v221
  v_mul_u32_u24 v226, 4682, v225
  v_lshrrev_b32 v226, 16, v226
  v_mul_u32_u24 v227, 14, v226
  v_sub_u32 v225, v225, v227
  v_lshrrev_b32 v227, 1, v225
  v_xor_b32 v228, 8, v225
  v_cmp_eq_u32 vcc, 3, v227
  v_bfe_u32 v227, v226, 3, 1
  v_mul_u32_u24 v226, 7168, v226
  v_cndmask_b32 v228, v228, v225, vcc
  v_cmp_eq_u32 vcc, 1, v227
  s_mul_i32 s56, s50, 224
  s_nop 0
  v_cndmask_b32 v225, v225, v228, vcc
  v_lshl_add_u32 v218, v225, 4, v226
  v_add_u32 v218, s56, v218
  v_mov_b32 v219, v218
  s_lshl_b32 s56, s51, 6
  v_add_u32 v225, s56, v221
  v_mul_u32_u24 v226, 5462, v225
  v_lshrrev_b32 v226, 16, v226
  v_mul_u32_u24 v227, 12, v226
  v_sub_u32 v225, v225, v227
  v_bfe_u32 v227, v226, 3, 1
  v_lshlrev_b32 v227, 1, v227
  v_xor_b32 v225, v225, v227
  v_mul_u32_u24 v226, 6144, v226
  v_lshrrev_b32 v227, 2, v225
  v_lshl_add_u32 v226, v227, 11, v226
  v_and_b32 v225, 3, v225
  v_lshl_add_u32 v220, v225, 4, v226
  s_lshl_b32 s56, s50, 6
  v_add_u32 v220, s56, v220
  s_lshl_b32 s56, s48, 10
  s_add_u32 s74, s56, 65536
  s_add_u32 s75, s56, 72704
  s_lshl_b32 s56, s51, 10
  s_add_u32 s76, s56, 122880
  s_mov_b32 s72, 229376
  s_mov_b32 s68, 14336
  s_branch L_common
L_w7:
  s_mov_b32 s28, s6
  s_and_b32 s29, s7, 0xffff
  s_mov_b32 s30, 6291456
  s_mov_b32 s31, 0x20000
  s_mov_b32 s32, s6
  s_and_b32 s33, s7, 0xffff
  s_mov_b32 s34, 6291456
  s_mov_b32 s35, 0x20000
  s_lshl_b32 s56, 3, 6
  v_add_u32 v225, s56, v221
  v_mul_u32_u24 v226, 5462, v225
  v_lshrrev_b32 v226, 16, v226
  v_mul_u32_u24 v227, 12, v226
  v_sub_u32 v225, v225, v227
  v_bfe_u32 v227, v226, 3, 1
  v_lshlrev_b32 v227, 1, v227
  v_xor_b32 v225, v225, v227
  v_mul_u32_u24 v226, 6144, v226
  v_lshrrev_b32 v227, 2, v225
  v_lshl_add_u32 v226, v227, 11, v226
  v_and_b32 v225, 3, v225
  v_lshl_add_u32 v218, v225, 4, v226
  s_lshl_b32 s56, s50, 6
  v_add_u32 v218, s56, v218
  s_lshl_b32 s56, 4, 6
  v_add_u32 v225, s56, v221
  v_mul_u32_u24 v226, 5462, v225
  v_lshrrev_b32 v226, 16, v226
  v_mul_u32_u24 v227, 12, v226
  v_sub_u32 v225, v225, v227
  v_bfe_u32 v227, v226, 3, 1
  v_lshlrev_b32 v227, 1, v227
  v_xor_b32 v225, v225, v227
  v_mul_u32_u24 v226, 6144, v226
  v_lshrrev_b32 v227, 2, v225
  v_lshl_add_u32 v226, v227, 11, v226
  v_and_b32 v225, 3, v225
  v_lshl_add_u32 v219, v225, 4, v226
  s_lshl_b32 s56, s50, 6
  v_add_u32 v219, s56, v219
  s_lshl_b32 s56, 5, 6
  v_add_u32 v225, s56, v221
  v_mul_u32_u24 v226, 5462, v225
  v_lshrrev_b32 v226, 16, v226
  v_mul_u32_u24 v227, 12, v226
  v_sub_u32 v225, v225, v227
  v_bfe_u32 v227, v226, 3, 1
  v_lshlrev_b32 v227, 1, v227
  v_xor_b32 v225, v225, v227
  v_mul_u32_u24 v226, 6144, v226
  v_lshrrev_b32 v227, 2, v225
  v_lshl_add_u32 v226, v227, 11, v226
  v_and_b32 v225, 3, v225
  v_lshl_add_u32 v220, v225, 4, v226
  s_lshl_b32 s56, s50, 6
  v_add_u32 v220, s56, v220
  s_mov_b32 s74, 125952
  s_mov_b32 s75, 126976
  s_mov_b32 s76, 128000
  s_mov_b32 s72, 196608
  s_mov_b32 s68, 6144
L_common:
  s_and_b32 s60, s2, 7
  s_mul_i32 s60, s60, 0
  s_and_b32 s60, s60, 31
  s_mul_i32 s70, s60, s72
  s_mul_i32 s71, s60, 196608
  s_lshl_b32 s61, s72, 5
  v_and_b32 v30, 7, v221
  v_xor_b32 v30, s48, v30
  v_lshl_add_u32 v30, v221, 3, v30
  v_lshlrev_b32 v30, 4, v30
  v_add_u32 v30, 49152, v30
  v_lshrrev_b32 v31, 3, v221
  v_and_b32 v32, 7, v221
  v_xor_b32 v33, v31, v32
  v_lshl_add_u32 v33, v31, 3, v33
  v_lshlrev_b32 v33, 4, v33
  s_lshl_b32 s56, s48, 11
  s_add_u32 s56, s56, 49152
  v_add_u32 v33, s56, v33
  v_and_b32 v31, 3, v31
  v_lshlrev_b32 v31, 8, v31
  v_lshl_add_u32 v34, v32, 4, v31
  v_lshrrev_b32 v31, 5, v221
  v_lshl_add_u32 v34, v31, 11, v34
  s_lshr_b32 s69, s2, 2
  s_mul_i32 s69, s69, 69888
  s_and_b32 s56, s2, 2
  s_lshl_b32 s56, s56, 9
  s_add_u32 s69, s69, s56
  s_and_b32 s56, s2, 1
  s_lshl_b32 s56, s56, 7
  s_add_u32 s69, s69, s56
  s_lshl_b32 s56, s48, 13
  s_add_u32 s69, s69, s56
  s_add_u32 s79, s69, 4096
  s_waitcnt vmcnt(1)
  s_mov_b32 m0, s74
  s_nop 0
  buffer_load_dwordx4 v218, s[28:31], s70 offen lds
  s_mov_b32 m0, s75
  s_nop 0
  buffer_load_dwordx4 v219, s[32:35], s70 offen lds
  s_add_u32 s70, s70, s72
  s_add_u32 m0, s74, s68
  s_nop 0
  buffer_load_dwordx4 v218, s[28:31], s70 offen lds
  s_add_u32 m0, s75, s68
  s_nop 0
  buffer_load_dwordx4 v219, s[32:35], s70 offen lds
  s_add_u32 s70, s70, s72
  s_cmp_ge_u32 s48, 4
  s_cselect_b32 s38, s38, 0
  s_cselect_b32 s76, s76, 196608
  s_add_u32 m0, s76, 0
  s_nop 0
  buffer_load_dwordx4 v220, s[36:39], s71 offen lds
  s_add_u32 s71, s71, 196608
  s_add_u32 m0, s76, 6144
  s_nop 0
  buffer_load_dwordx4 v220, s[36:39], s71 offen lds
  s_add_u32 s71, s71, 196608
  v_lshlrev_b32 v10, 16, v2
  v_and_b32 v11, 0xffff0000, v2
  v_lshlrev_b32 v12, 16, v3
  v_and_b32 v13, 0xffff0000, v3
  v_lshlrev_b32 v14, 16, v4
  v_and_b32 v15, 0xffff0000, v4
  v_lshlrev_b32 v16, 16, v5
  v_and_b32 v17, 0xffff0000, v5
  v_lshlrev_b32 v18, 16, v6
  v_and_b32 v19, 0xffff0000, v6
  v_lshlrev_b32 v20, 16, v7
  v_and_b32 v21, 0xffff0000, v7
  v_lshlrev_b32 v22, 16, v8
  v_and_b32 v23, 0xffff0000, v8
  v_lshlrev_b32 v24, 16, v9
  v_and_b32 v25, 0xffff0000, v9
  v_pk_add_f32 v[26:27], v[10:11], v[12:13]
  v_pk_add_f32 v[28:29], v[14:15], v[16:17]
  v_pk_add_f32 v[40:41], v[18:19], v[20:21]
  v_pk_add_f32 v[42:43], v[22:23], v[24:25]
  v_pk_add_f32 v[26:27], v[26:27], v[28:29]
  v_pk_add_f32 v[40:41], v[40:41], v[42:43]
  v_pk_add_f32 v[26:27], v[26:27], v[40:41]
  v_add_f32 v26, v26, v27
  s_nop 1
  v_add_f32_dpp v26, v26, v26 quad_perm:[1,0,3,2] row_mask:0xf bank_mask:0xf
  s_nop 1
  v_add_f32_dpp v26, v26, v26 quad_perm:[2,3,0,1] row_mask:0xf bank_mask:0xf
  s_nop 1
  v_add_f32_dpp v26, v26, v26 row_half_mirror row_mask:0xf bank_mask:0xf
  s_nop 1
  v_add_f32_dpp v26, v26, v26 row_mirror row_mask:0xf bank_mask:0xf
  v_mov_b32 v27, v26
  s_nop 1
  v_permlane16_swap_b32 v26, v27
  s_nop 1
  v_add_f32 v26, v26, v27
  v_mov_b32 v27, v26
  s_nop 1
  v_permlane32_swap_b32 v26, v27
  s_nop 1
  v_add_f32 v26, v26, v27
  v_mul_f32 v26, 0xba800000, v26
  buffer_load_dwordx2 v[60:61], off, s[40:43], 0 sc1
  v_pk_add_f32 v[40:41], v[10:11], v[26:27] op_sel_hi:[1,0]
  v_pk_add_f32 v[42:43], v[12:13], v[26:27] op_sel_hi:[1,0]
  v_pk_add_f32 v[44:45], v[14:15], v[26:27] op_sel_hi:[1,0]
  v_pk_add_f32 v[46:47], v[16:17], v[26:27] op_sel_hi:[1,0]
  v_pk_add_f32 v[48:49], v[18:19], v[26:27] op_sel_hi:[1,0]
  v_pk_add_f32 v[50:51], v[20:21], v[26:27] op_sel_hi:[1,0]
  v_pk_add_f32 v[52:53], v[22:23], v[26:27] op_sel_hi:[1,0]
  v_pk_add_f32 v[54:55], v[24:25], v[26:27] op_sel_hi:[1,0]
  v_pk_mul_f32 v[28:29], v[40:41], v[40:41]
  v_pk_mul_f32 v[56:57], v[42:43], v[42:43]
  v_pk_fma_f32 v[28:29], v[44:45], v[44:45], v[28:29]
  v_pk_fma_f32 v[56:57], v[46:47], v[46:47], v[56:57]
  v_pk_fma_f32 v[28:29], v[48:49], v[48:49], v[28:29]
  v_pk_fma_f32 v[56:57], v[50:51], v[50:51], v[56:57]
  v_pk_fma_f32 v[28:29], v[52:53], v[52:53], v[28:29]
  v_pk_fma_f32 v[56:57], v[54:55], v[54:55], v[56:57]
  v_cvt_pk_bf16_f32 v26, v26, v26
  v_lshlrev_b32 v26, 16, v26
  v_pk_add_f32 v[28:29], v[28:29], v[56:57]
  v_add_f32 v28, v28, v29
  v_pk_add_f32 v[10:11], v[10:11], v[26:27] op_sel_hi:[1,0]
  v_pk_add_f32 v[12:13], v[12:13], v[26:27] op_sel_hi:[1,0]
  v_add_f32_dpp v28, v28, v28 quad_perm:[1,0,3,2] row_mask:0xf bank_mask:0xf
  v_pk_add_f32 v[14:15], v[14:15], v[26:27] op_sel_hi:[1,0]
  v_pk_add_f32 v[16:17], v[16:17], v[26:27] op_sel_hi:[1,0]
  v_add_f32_dpp v28, v28, v28 quad_perm:[2,3,0,1] row_mask:0xf bank_mask:0xf
  v_pk_add_f32 v[18:19], v[18:19], v[26:27] op_sel_hi:[1,0]
  v_pk_add_f32 v[20:21], v[20:21], v[26:27] op_sel_hi:[1,0]
  v_add_f32_dpp v28, v28, v28 row_half_mirror row_mask:0xf bank_mask:0xf
  v_pk_add_f32 v[22:23], v[22:23], v[26:27] op_sel_hi:[1,0]
  v_pk_add_f32 v[24:25], v[24:25], v[26:27] op_sel_hi:[1,0]
  v_add_f32_dpp v28, v28, v28 row_mirror row_mask:0xf bank_mask:0xf
  v_mov_b32 v29, v28
  v_cvt_pk_bf16_f32 v2, v10, v11
  v_cvt_pk_bf16_f32 v3, v12, v13
  v_permlane16_swap_b32 v28, v29
  v_cvt_pk_bf16_f32 v4, v14, v15
  v_cvt_pk_bf16_f32 v5, v16, v17
  v_add_f32 v28, v28, v29
  v_mov_b32 v29, v28
  v_cvt_pk_bf16_f32 v6, v18, v19
  v_cvt_pk_bf16_f32 v7, v20, v21
  v_permlane32_swap_b32 v28, v29
  v_cvt_pk_bf16_f32 v8, v22, v23
  v_cvt_pk_bf16_f32 v9, v24, v25
  v_add_f32 v28, v28, v29
  v_mul_f32 v28, 0x3a800000, v28
  v_cvt_pk_bf16_f32 v28, v28, v28
  v_lshlrev_b32 v28, 16, v28
  v_add_f32 v28, 0x3727c5ac, v28
  v_cvt_pk_bf16_f32 v28, v28, v28
  v_lshlrev_b32 v28, 16, v28
  v_sqrt_f32 v28, v28
  v_lshlrev_b32 v10, 16, v2
  v_and_b32 v11, 0xffff0000, v2
  v_lshlrev_b32 v12, 16, v3
  v_and_b32 v13, 0xffff0000, v3
  v_lshlrev_b32 v14, 16, v4
  v_and_b32 v15, 0xffff0000, v4
  v_lshlrev_b32 v16, 16, v5
  v_and_b32 v17, 0xffff0000, v5
  v_cvt_pk_bf16_f32 v28, v28, v28
  v_lshlrev_b32 v28, 16, v28
  v_rcp_f32 v28, v28
  v_lshlrev_b32 v18, 16, v6
  v_and_b32 v19, 0xffff0000, v6
  v_lshlrev_b32 v20, 16, v7
  v_and_b32 v21, 0xffff0000, v7
  v_lshlrev_b32 v22, 16, v8
  v_and_b32 v23, 0xffff0000, v8
  v_lshlrev_b32 v24, 16, v9
  v_and_b32 v25, 0xffff0000, v9
  v_pk_mul_f32 v[10:11], v[10:11], v[28:29] op_sel_hi:[1,0]
  v_pk_mul_f32 v[12:13], v[12:13], v[28:29] op_sel_hi:[1,0]
  v_pk_mul_f32 v[14:15], v[14:15], v[28:29] op_sel_hi:[1,0]
  v_pk_mul_f32 v[16:17], v[16:17], v[28:29] op_sel_hi:[1,0]
  v_pk_mul_f32 v[18:19], v[18:19], v[28:29] op_sel_hi:[1,0]
  v_pk_mul_f32 v[20:21], v[20:21], v[28:29] op_sel_hi:[1,0]
  v_pk_mul_f32 v[22:23], v[22:23], v[28:29] op_sel_hi:[1,0]
  v_pk_mul_f32 v[24:25], v[24:25], v[28:29] op_sel_hi:[1,0]
  v_cvt_pk_bf16_f32 v2, v10, v11
  v_cvt_pk_bf16_f32 v3, v12, v13
  v_cvt_pk_bf16_f32 v4, v14, v15
  v_cvt_pk_bf16_f32 v5, v16, v17
  v_cvt_pk_bf16_f32 v6, v18, v19
  v_cvt_pk_bf16_f32 v7, v20, v21
  v_cvt_pk_bf16_f32 v8, v22, v23
  v_cvt_pk_bf16_f32 v9, v24, v25
  s_add_u32 s24, s22, 29360128
  s_addc_u32 s25, s23, 0
  s_and_b32 s25, s25, 0xffff
  s_mov_b32 s26, 4472832
  s_mov_b32 s27, 0x20000
  ds_write_b128 v30, v[2:5]
  ds_write_b128 v30, v[6:9] offset:8192
  s_waitcnt lgkmcnt(0)
  s_barrier
  ds_read_b128 v[2:5], v33
  ds_read_b128 v[6:9], v33 offset:1024
  s_waitcnt lgkmcnt(1)
  buffer_store_dwordx4 v[2:5], v34, s[24:27], s69 offen sc1
  s_waitcnt lgkmcnt(0)
  buffer_store_dwordx4 v[6:9], v34, s[24:27], s79 offen sc1
  s_lshl_b32 s56, s49, 3
  s_add_u32 s56, s56, s48
  s_mul_i32 s57, s56, 69888
  v_add_u32 v216, s57, v224
  s_lshl_b32 s73, s48, 11
  s_lshl_b32 s79, s56, 8
  s_add_u32 s79, s79, 131072
  s_lshl_b32 s57, s51, 12
  v_add_u32 v212, s57, v224
  v_lshrrev_b32 v227, 4, v221
  v_lshlrev_b32 v225, 3, v227
  v_bfe_u32 v226, v221, 2, 2
  v_add_u32 v225, v225, v226
  v_and_b32 v226, 3, v221
  v_lshlrev_b32 v226, 3, v226
  v_and_b32 v227, 1, v227
  v_mul_u32_u24 v228, 224, v225
  v_add_u32 v228, v228, v226
  v_add_u32 v228, 65536, v228
  s_cmp_ge_u32 s48, 4
  s_cbranch_scc1 L_addr1
  v_lshl_add_u32 v215, v227, 7, v228
  v_mul_u32_u24 v228, 192, v225
  v_add_u32 v228, v228, v226
  v_add_u32 v228, 122880, v228
  v_lshl_add_u32 v213, v227, 5, v228
  v_xor_b32 v227, 1, v227
  v_lshl_add_u32 v214, v227, 5, v228
  s_branch L_addr2
L_addr1:
  v_lshlrev_b32 v227, 7, v227
  v_add_u32 v213, v228, v227
  v_mov_b32 v214, v228
  v_sub_u32 v215, v228, v227
L_addr2:
  v_mov_b32 v62, 0
  v_mov_b32 v63, 0
  v_mov_b32 v64, 0
  v_mov_b32 v65, 0
  v_mov_b32 v66, 0
  v_mov_b32 v67, 0
  v_mov_b32 v68, 0
  v_mov_b32 v69, 0
  v_mov_b32 v70, 0
  v_mov_b32 v71, 0
  v_mov_b32 v72, 0
  v_mov_b32 v73, 0
  v_mov_b32 v74, 0
  v_mov_b32 v75, 0
  v_mov_b32 v76, 0
  v_mov_b32 v77, 0
  v_mov_b32 v78, 0
  v_mov_b32 v79, 0
  v_mov_b32 v80, 0
  v_mov_b32 v81, 0
  v_mov_b32 v82, 0
  v_mov_b32 v83, 0
  v_mov_b32 v84, 0
  v_mov_b32 v85, 0
  v_mov_b32 v86, 0
  v_mov_b32 v87, 0
  v_mov_b32 v88, 0
  v_mov_b32 v89, 0
  v_mov_b32 v90, 0
  v_mov_b32 v91, 0
  v_mov_b32 v92, 0
  v_mov_b32 v93, 0
  v_mov_b32 v94, 0
  v_mov_b32 v95, 0
  v_mov_b32 v96, 0
  v_mov_b32 v97, 0
  v_mov_b32 v98, 0
  v_mov_b32 v99, 0
  v_mov_b32 v100, 0
  v_mov_b32 v101, 0
  v_mov_b32 v102, 0
  v_mov_b32 v103, 0
  v_mov_b32 v104, 0
  v_mov_b32 v105, 0
  v_mov_b32 v106, 0
  v_mov_b32 v107, 0
  v_mov_b32 v108, 0
  v_mov_b32 v109, 0
  v_mov_b32 v110, 0
  v_mov_b32 v111, 0
  v_mov_b32 v112, 0
  v_mov_b32 v113, 0
  v_mov_b32 v114, 0
  v_mov_b32 v115, 0
  v_mov_b32 v116, 0
  v_mov_b32 v117, 0
  v_mov_b32 v118, 0
  v_mov_b32 v119, 0
  v_mov_b32 v120, 0
  v_mov_b32 v121, 0
  v_mov_b32 v122, 0
  v_mov_b32 v123, 0
  v_mov_b32 v124, 0
  v_mov_b32 v125, 0
  v_mov_b32 v126, 0
  v_mov_b32 v127, 0
  v_mov_b32 v128, 0
  v_mov_b32 v129, 0
  v_mov_b32 v130, 0
  v_mov_b32 v131, 0
  v_mov_b32 v132, 0
  v_mov_b32 v133, 0
  v_mov_b32 v134, 0
  v_mov_b32 v135, 0
  v_mov_b32 v136, 0
  v_mov_b32 v137, 0
  v_mov_b32 v138, 0
  v_mov_b32 v139, 0
  v_mov_b32 v140, 0
  v_mov_b32 v141, 0
  v_mov_b32 v142, 0
  v_mov_b32 v143, 0
  v_mov_b32 v144, 0
  v_mov_b32 v145, 0
  v_mov_b32 v146, 0
  v_mov_b32 v147, 0
  v_mov_b32 v148, 0
  v_mov_b32 v149, 0
  v_mov_b32 v150, 0
  v_mov_b32 v151, 0
  v_mov_b32 v152, 0
  v_mov_b32 v153, 0
  v_mov_b32 v154, 0
  v_mov_b32 v155, 0
  v_mov_b32 v156, 0
  v_mov_b32 v157, 0
  v_mov_b32 v158, 0
  v_mov_b32 v159, 0
  s_mov_b32 s78, 0
  s_sub_u32 s58, s54, 5000
  s_subb_u32 s59, s55, 0
  s_waitcnt vmcnt(0)
L_tag:
  v_readfirstlane_b32 s54, v60
  v_readfirstlane_b32 s55, v61
  s_add_u32 s78, s78, 1
  s_cmp_gt_u32 s78, 262144
  s_cbranch_scc1 L_tag_done
  s_sub_u32 s56, s54, s58
  s_subb_u32 s57, s55, s59
  s_cbranch_scc0 L_tag_done
  s_cmp_gt_u32 s78, 256
  s_cselect_b32 s56, s54, 0
  s_cmp_lg_u32 s56, 0
  s_cbranch_scc1 L_tag_done
  buffer_load_dwordx2 v[60:61], off, s[40:43], 0 sc1
  s_waitcnt vmcnt(0)
  s_branch L_tag
L_tag_done:
  v_mov_b32 v226, s54
  v_mov_b32 v227, s55
  s_mov_b64 exec, 1
  buffer_store_dwordx2 v[226:227], off, s[44:47], s77 sc1
  s_mov_b64 exec, -1
  v_mov_b32 v0, 0
  v_mov_b32 v1, 0
  v_mov_b32 v2, 0
  v_mov_b32 v3, 0
  v_mov_b32 v4, 0
  v_mov_b32 v5, 0
  v_mov_b32 v6, 0
  v_mov_b32 v7, 0
  v_mov_b32 v8, 0
  v_mov_b32 v9, 0
  v_mov_b32 v10, 0
  v_mov_b32 v11, 0
  v_mov_b32 v12, 0
  v_mov_b32 v13, 0
  v_mov_b32 v14, 0
  v_mov_b32 v15, 0
  v_mov_b32 v16, 0
  v_mov_b32 v17, 0
  v_mov_b32 v18, 0
  v_mov_b32 v19, 0
  v_mov_b32 v20, 0
  v_mov_b32 v21, 0
  v_mov_b32 v22, 0
  v_mov_b32 v23, 0
  v_mov_b32 v24, 0
  v_mov_b32 v25, 0
  v_mov_b32 v26, 0
  v_mov_b32 v27, 0
  v_mov_b32 v28, 0
  v_mov_b32 v29, 0
  v_mov_b32 v30, 0
  v_mov_b32 v31, 0
  v_mov_b32 v32, 0
  v_mov_b32 v33, 0
  v_mov_b32 v34, 0
  v_mov_b32 v35, 0
  v_mov_b32 v36, 0
  v_mov_b32 v37, 0
  v_mov_b32 v38, 0
  v_mov_b32 v39, 0
  v_mov_b32 v40, 0
  v_mov_b32 v41, 0
  v_mov_b32 v42, 0
  v_mov_b32 v43, 0
  v_mov_b32 v44, 0
  v_mov_b32 v45, 0
  v_mov_b32 v46, 0
  v_mov_b32 v47, 0
  v_mov_b32 v48, 0
  v_mov_b32 v49, 0
  v_mov_b32 v50, 0
  v_mov_b32 v51, 0
  v_mov_b32 v52, 0
  v_mov_b32 v53, 0
  v_mov_b32 v54, 0
  v_mov_b32 v55, 0
  v_mov_b32 v56, 0
  v_mov_b32 v57, 0
  v_mov_b32 v58, 0
  v_mov_b32 v59, 0
  v_mov_b32 v60, 0
  v_mov_b32 v61, 0
  v_and_b32 v225, 31, v221
  v_lshlrev_b32 v225, 3, v225
  s_mov_b32 s78, 0
  s_mov_b64 vcc, 0
L_pollx:
  s_not_b64 exec, vcc
  buffer_load_dwordx2 v[226:227], v225, s[44:47], s79 offen sc1
  s_mov_b64 exec, -1
  s_add_u32 s78, s78, 1
  s_cmp_gt_u32 s78, 262144
  s_cbranch_scc1 L_pollx_done
  s_waitcnt vmcnt(0)
  v_cmp_eq_u64 vcc, s[54:55], v[226:227]
  s_cmp_eq_u64 vcc, -1
  s_cbranch_scc0 L_pollx
L_pollx_done:
L_x_ok:
  s_lshl_b32 s69, s60, 11
  s_add_u32 m0, s73, 0
  s_nop 0
  buffer_load_dwordx4 v216, s[24:27], s69 offen sc1 lds
  buffer_load_dwordx4 v216, s[24:27], s69 offen offset:1024 sc1 lds
  s_add_u32 s69, s69, 2048
  s_add_u32 m0, s73, 16384
  s_nop 0
  buffer_load_dwordx4 v216, s[24:27], s69 offen sc1 lds
  buffer_load_dwordx4 v216, s[24:27], s69 offen offset:1024 sc1 lds
  s_add_u32 s69, s69, 2048
  s_add_u32 m0, s73, 32768
  s_nop 0
  buffer_load_dwordx4 v216, s[24:27], s69 offen sc1 lds
  buffer_load_dwordx4 v216, s[24:27], s69 offen offset:1024 sc1 lds
  s_add_u32 s69, s69, 2048
  s_mul_i32 s67, s68, 3
  s_mov_b32 s64, 0
  s_lshr_b32 s77, s2, 3
  s_and_b32 s77, s77, 3
  s_add_u32 s77, s77, 1
  s_waitcnt vmcnt(4)
  s_barrier
  s_cmp_ge_u32 s48, 4
  s_cbranch_scc1 L_role1
  ds_read_b64_tr_b16 v[192:193], v213 offset:64
  ds_read_b64_tr_b16 v[194:195], v213 offset:832
  ds_read_b128 v[160:163], v212 offset:0
  ds_read_b128 v[164:167], v212 offset:1024
  ds_read_b64_tr_b16 v[196:197], v214 offset:64
  ds_read_b64_tr_b16 v[198:199], v214 offset:832
  ds_read_b128 v[168:171], v212 offset:2048
  ds_read_b128 v[172:175], v212 offset:3072
  ds_read_b64_tr_b16 v[200:201], v213 offset:128
  ds_read_b64_tr_b16 v[202:203], v213 offset:896
.p2align 6
L_g0:
  s_waitcnt lgkmcnt(2)
  v_mfma_f32_16x16x32_bf16 v[0:3], v[192:195], v[160:163], v[0:3]
  ds_read_b64_tr_b16 v[204:205], v214 offset:128
  ds_read_b64_tr_b16 v[206:207], v214 offset:896
  v_mfma_f32_16x16x32_bf16 v[4:7], v[192:195], v[164:167], v[4:7]
  s_lshl1_add_u32 m0, s68, s74
  v_mfma_f32_16x16x32_bf16 v[8:11], v[192:195], v[168:171], v[8:11]
  buffer_load_dwordx4 v218, s[28:31], s70 offen lds
  v_mfma_f32_16x16x32_bf16 v[12:15], v[192:195], v[172:175], v[12:15]
  v_mfma_f32_16x16x32_bf16 v[16:19], v[196:199], v[160:163], v[16:19]
  ds_read_b64_tr_b16 v[208:209], v213 offset:0
  ds_read_b64_tr_b16 v[210:211], v213 offset:768
  v_mfma_f32_16x16x32_bf16 v[20:23], v[196:199], v[164:167], v[20:23]
  v_mfma_f32_16x16x32_bf16 v[24:27], v[196:199], v[168:171], v[24:27]
  v_mfma_f32_16x16x32_bf16 v[28:31], v[196:199], v[172:175], v[28:31]
  s_waitcnt lgkmcnt(4)
  v_mfma_f32_16x16x32_bf16 v[32:35], v[160:163], v[200:203], v[32:35]
  ds_read_b64_tr_b16 v[192:193], v214 offset:0
  ds_read_b64_tr_b16 v[194:195], v214 offset:768
  v_mfma_f32_16x16x32_bf16 v[36:39], v[164:167], v[200:203], v[36:39]
  s_lshl1_add_u32 m0, s68, s75
  v_mfma_f32_16x16x32_bf16 v[40:43], v[168:171], v[200:203], v[40:43]
  buffer_load_dwordx4 v219, s[32:35], s70 offen lds
  s_add_u32 s70, s70, s72
  v_mfma_f32_16x16x32_bf16 v[44:47], v[172:175], v[200:203], v[44:47]
  s_waitcnt lgkmcnt(4)
  v_mfma_f32_16x16x32_bf16 v[48:51], v[160:163], v[204:207], v[48:51]
  ds_read_b64_tr_b16 v[196:197], v215 offset:0
  ds_read_b64_tr_b16 v[198:199], v215 offset:896
  v_mfma_f32_16x16x32_bf16 v[52:55], v[164:167], v[204:207], v[52:55]
  v_mfma_f32_16x16x32_bf16 v[56:59], v[168:171], v[204:207], v[56:59]
  v_mfma_f32_16x16x32_bf16 v[60:63], v[172:175], v[204:207], v[60:63]
  s_waitcnt lgkmcnt(4)
  v_mfma_f32_16x16x32_bf16 v[64:67], v[208:211], v[160:163], v[64:67]
  ds_read_b64_tr_b16 v[200:201], v215 offset:7168
  ds_read_b64_tr_b16 v[202:203], v215 offset:8064
  v_mfma_f32_16x16x32_bf16 v[68:71], v[208:211], v[164:167], v[68:71]
  v_mfma_f32_16x16x32_bf16 v[72:75], v[208:211], v[168:171], v[72:75]
  v_mfma_f32_16x16x32_bf16 v[76:79], v[208:211], v[172:175], v[76:79]
  s_waitcnt lgkmcnt(4)
  v_mfma_f32_16x16x32_bf16 v[80:83], v[192:195], v[160:163], v[80:83]
  ds_read_b64_tr_b16 v[204:205], v215 offset:32
  ds_read_b64_tr_b16 v[206:207], v215 offset:928
  v_mfma_f32_16x16x32_bf16 v[84:87], v[192:195], v[164:167], v[84:87]
  v_mfma_f32_16x16x32_bf16 v[88:91], v[192:195], v[168:171], v[88:91]
  v_mfma_f32_16x16x32_bf16 v[92:95], v[192:195], v[172:175], v[92:95]
  s_waitcnt lgkmcnt(4)
  v_mfma_f32_16x16x32_bf16 v[96:99], v[196:199], v[160:163], v[96:99]
  ds_read_b64_tr_b16 v[208:209], v215 offset:7200
  ds_read_b64_tr_b16 v[210:211], v215 offset:8096
  v_mfma_f32_16x16x32_bf16 v[100:103], v[196:199], v[164:167], v[100:103]
  v_mfma_f32_16x16x32_bf16 v[104:107], v[196:199], v[168:171], v[104:107]
  s_waitcnt vmcnt(4)
  v_mfma_f32_16x16x32_bf16 v[108:111], v[196:199], v[172:175], v[108:111]
  s_waitcnt lgkmcnt(4)
  s_barrier
  v_mfma_f32_16x16x32_bf16 v[112:115], v[200:203], v[160:163], v[112:115]
  ds_read_b64_tr_b16 v[192:193], v213 offset:6208
  ds_read_b64_tr_b16 v[194:195], v213 offset:6976
  v_mfma_f32_16x16x32_bf16 v[116:119], v[200:203], v[164:167], v[116:119]
  ds_read_b128 v[176:179], v212 offset:16384
  ds_read_b128 v[180:183], v212 offset:17408
  v_mfma_f32_16x16x32_bf16 v[120:123], v[200:203], v[168:171], v[120:123]
  v_mfma_f32_16x16x32_bf16 v[124:127], v[200:203], v[172:175], v[124:127]
  s_waitcnt lgkmcnt(6)
  v_mfma_f32_16x16x32_bf16 v[128:131], v[204:207], v[160:163], v[128:131]
  ds_read_b64_tr_b16 v[196:197], v214 offset:6208
  ds_read_b64_tr_b16 v[198:199], v214 offset:6976
  v_mfma_f32_16x16x32_bf16 v[132:135], v[204:207], v[164:167], v[132:135]
  ds_read_b128 v[184:187], v212 offset:18432
  ds_read_b128 v[188:191], v212 offset:19456
  v_mfma_f32_16x16x32_bf16 v[136:139], v[204:207], v[168:171], v[136:139]
  s_add_u32 m0, s73, 49152
  v_mfma_f32_16x16x32_bf16 v[140:143], v[204:207], v[172:175], v[140:143]
  buffer_load_dwordx4 v216, s[24:27], s69 offen sc1 lds
  s_waitcnt lgkmcnt(8)
  v_mfma_f32_16x16x32_bf16 v[144:147], v[208:211], v[160:163], v[144:147]
  ds_read_b64_tr_b16 v[200:201], v213 offset:6272
  ds_read_b64_tr_b16 v[202:203], v213 offset:7040
  v_mfma_f32_16x16x32_bf16 v[148:151], v[208:211], v[164:167], v[148:151]
  v_mfma_f32_16x16x32_bf16 v[152:155], v[208:211], v[168:171], v[152:155]
  buffer_load_dwordx4 v216, s[24:27], s69 offen offset:1024 sc1 lds
  s_add_u32 s69, s69, 2048
  v_mfma_f32_16x16x32_bf16 v[156:159], v[208:211], v[172:175], v[156:159]
  s_waitcnt lgkmcnt(2)
  v_mfma_f32_16x16x32_bf16 v[0:3], v[192:195], v[176:179], v[0:3]
  ds_read_b64_tr_b16 v[204:205], v214 offset:6272
  ds_read_b64_tr_b16 v[206:207], v214 offset:7040
  v_mfma_f32_16x16x32_bf16 v[4:7], v[192:195], v[180:183], v[4:7]
  s_add_u32 m0, s74, s67
  v_mfma_f32_16x16x32_bf16 v[8:11], v[192:195], v[184:187], v[8:11]
  buffer_load_dwordx4 v218, s[28:31], s70 offen lds
  v_mfma_f32_16x16x32_bf16 v[12:15], v[192:195], v[188:191], v[12:15]
  v_mfma_f32_16x16x32_bf16 v[16:19], v[196:199], v[176:179], v[16:19]
  ds_read_b64_tr_b16 v[208:209], v213 offset:6144
  ds_read_b64_tr_b16 v[210:211], v213 offset:6912
  v_mfma_f32_16x16x32_bf16 v[20:23], v[196:199], v[180:183], v[20:23]
  v_mfma_f32_16x16x32_bf16 v[24:27], v[196:199], v[184:187], v[24:27]
  v_mfma_f32_16x16x32_bf16 v[28:31], v[196:199], v[188:191], v[28:31]
  s_waitcnt lgkmcnt(4)
  v_mfma_f32_16x16x32_bf16 v[32:35], v[176:179], v[200:203], v[32:35]
  ds_read_b64_tr_b16 v[192:193], v214 offset:6144
  ds_read_b64_tr_b16 v[194:195], v214 offset:6912
  v_mfma_f32_16x16x32_bf16 v[36:39], v[180:183], v[200:203], v[36:39]
  s_add_u32 m0, s75, s67
  v_mfma_f32_16x16x32_bf16 v[40:43], v[184:187], v[200:203], v[40:43]
  buffer_load_dwordx4 v219, s[32:35], s70 offen lds
  s_add_u32 s70, s70, s72
  v_mfma_f32_16x16x32_bf16 v[44:47], v[188:191], v[200:203], v[44:47]
  s_waitcnt lgkmcnt(4)
  v_mfma_f32_16x16x32_bf16 v[48:51], v[176:179], v[204:207], v[48:51]
  ds_read_b64_tr_b16 v[196:197], v215 offset:14336
  ds_read_b64_tr_b16 v[198:199], v215 offset:15232
  v_mfma_f32_16x16x32_bf16 v[52:55], v[180:183], v[204:207], v[52:55]
  v_mfma_f32_16x16x32_bf16 v[56:59], v[184:187], v[204:207], v[56:59]
  v_mfma_f32_16x16x32_bf16 v[60:63], v[188:191], v[204:207], v[60:63]
  s_waitcnt lgkmcnt(4)
  v_mfma_f32_16x16x32_bf16 v[64:67], v[208:211], v[176:179], v[64:67]
  ds_read_b64_tr_b16 v[200:201], v215 offset:21504
  ds_read_b64_tr_b16 v[202:203], v215 offset:22400
  v_mfma_f32_16x16x32_bf16 v[68:71], v[208:211], v[180:183], v[68:71]
  v_mfma_f32_16x16x32_bf16 v[72:75], v[208:211], v[184:187], v[72:75]
  v_mfma_f32_16x16x32_bf16 v[76:79], v[208:211], v[188:191], v[76:79]
  s_waitcnt lgkmcnt(4)
  v_mfma_f32_16x16x32_bf16 v[80:83], v[192:195], v[176:179], v[80:83]
  ds_read_b64_tr_b16 v[204:205], v215 offset:14368
  ds_read_b64_tr_b16 v[206:207], v215 offset:15264
  v_mfma_f32_16x16x32_bf16 v[84:87], v[192:195], v[180:183], v[84:87]
  v_mfma_f32_16x16x32_bf16 v[88:91], v[192:195], v[184:187], v[88:91]
  v_mfma_f32_16x16x32_bf16 v[92:95], v[192:195], v[188:191], v[92:95]
  s_waitcnt lgkmcnt(4)
  v_mfma_f32_16x16x32_bf16 v[96:99], v[196:199], v[176:179], v[96:99]
  ds_read_b64_tr_b16 v[208:209], v215 offset:21536
  ds_read_b64_tr_b16 v[210:211], v215 offset:22432
  v_mfma_f32_16x16x32_bf16 v[100:103], v[196:199], v[180:183], v[100:103]
  s_cmp_eq_u32 s64, 7
  s_cbranch_scc1 L_g0_stop
L_g0_stop_ret:
  v_mfma_f32_16x16x32_bf16 v[104:107], v[196:199], v[184:187], v[104:107]
  s_waitcnt vmcnt(4)
  v_mfma_f32_16x16x32_bf16 v[108:111], v[196:199], v[188:191], v[108:111]
  s_waitcnt lgkmcnt(4)
  s_barrier
  v_mfma_f32_16x16x32_bf16 v[112:115], v[200:203], v[176:179], v[112:115]
  ds_read_b64_tr_b16 v[192:193], v213 offset:12352
  ds_read_b64_tr_b16 v[194:195], v213 offset:13120
  v_mfma_f32_16x16x32_bf16 v[116:119], v[200:203], v[180:183], v[116:119]
  ds_read_b128 v[160:163], v212 offset:32768
  ds_read_b128 v[164:167], v212 offset:33792
  v_mfma_f32_16x16x32_bf16 v[120:123], v[200:203], v[184:187], v[120:123]
  v_mfma_f32_16x16x32_bf16 v[124:127], v[200:203], v[188:191], v[124:127]
  s_waitcnt lgkmcnt(6)
  v_mfma_f32_16x16x32_bf16 v[128:131], v[204:207], v[176:179], v[128:131]
  ds_read_b64_tr_b16 v[196:197], v214 offset:12352
  ds_read_b64_tr_b16 v[198:199], v214 offset:13120
  v_mfma_f32_16x16x32_bf16 v[132:135], v[204:207], v[180:183], v[132:135]
  ds_read_b128 v[168:171], v212 offset:34816
  ds_read_b128 v[172:175], v212 offset:35840
  v_mfma_f32_16x16x32_bf16 v[136:139], v[204:207], v[184:187], v[136:139]
  s_add_u32 m0, s73, 0
  v_mfma_f32_16x16x32_bf16 v[140:143], v[204:207], v[188:191], v[140:143]
  buffer_load_dwordx4 v216, s[24:27], s69 offen sc1 lds
  s_waitcnt lgkmcnt(8)
  v_mfma_f32_16x16x32_bf16 v[144:147], v[208:211], v[176:179], v[144:147]
  ds_read_b64_tr_b16 v[200:201], v213 offset:12416
  ds_read_b64_tr_b16 v[202:203], v213 offset:13184
  v_mfma_f32_16x16x32_bf16 v[148:151], v[208:211], v[180:183], v[148:151]
  v_mfma_f32_16x16x32_bf16 v[152:155], v[208:211], v[184:187], v[152:155]
  buffer_load_dwordx4 v216, s[24:27], s69 offen offset:1024 sc1 lds
  s_add_u32 s69, s69, 2048
  v_mfma_f32_16x16x32_bf16 v[156:159], v[208:211], v[188:191], v[156:159]
  s_waitcnt lgkmcnt(2)
  v_mfma_f32_16x16x32_bf16 v[0:3], v[192:195], v[160:163], v[0:3]
  ds_read_b64_tr_b16 v[204:205], v214 offset:12416
  ds_read_b64_tr_b16 v[206:207], v214 offset:13184
  v_mfma_f32_16x16x32_bf16 v[4:7], v[192:195], v[164:167], v[4:7]
  s_mov_b32 m0, s74
  v_mfma_f32_16x16x32_bf16 v[8:11], v[192:195], v[168:171], v[8:11]
  buffer_load_dwordx4 v218, s[28:31], s70 offen lds
  v_mfma_f32_16x16x32_bf16 v[12:15], v[192:195], v[172:175], v[12:15]
  v_mfma_f32_16x16x32_bf16 v[16:19], v[196:199], v[160:163], v[16:19]
  ds_read_b64_tr_b16 v[208:209], v213 offset:12288
  ds_read_b64_tr_b16 v[210:211], v213 offset:13056
  v_mfma_f32_16x16x32_bf16 v[20:23], v[196:199], v[164:167], v[20:23]
  v_mfma_f32_16x16x32_bf16 v[24:27], v[196:199], v[168:171], v[24:27]
  v_mfma_f32_16x16x32_bf16 v[28:31], v[196:199], v[172:175], v[28:31]
  s_waitcnt lgkmcnt(4)
  v_mfma_f32_16x16x32_bf16 v[32:35], v[160:163], v[200:203], v[32:35]
  ds_read_b64_tr_b16 v[192:193], v214 offset:12288
  ds_read_b64_tr_b16 v[194:195], v214 offset:13056
  v_mfma_f32_16x16x32_bf16 v[36:39], v[164:167], v[200:203], v[36:39]
  s_mov_b32 m0, s75
  v_mfma_f32_16x16x32_bf16 v[40:43], v[168:171], v[200:203], v[40:43]
  buffer_load_dwordx4 v219, s[32:35], s70 offen lds
  s_add_u32 s70, s70, s72
  v_mfma_f32_16x16x32_bf16 v[44:47], v[172:175], v[200:203], v[44:47]
  s_waitcnt lgkmcnt(4)
  v_mfma_f32_16x16x32_bf16 v[48:51], v[160:163], v[204:207], v[48:51]
  ds_read_b64_tr_b16 v[196:197], v215 offset:28672
  ds_read_b64_tr_b16 v[198:199], v215 offset:29568
  v_mfma_f32_16x16x32_bf16 v[52:55], v[164:167], v[204:207], v[52:55]
  v_mfma_f32_16x16x32_bf16 v[56:59], v[168:171], v[204:207], v[56:59]
  v_mfma_f32_16x16x32_bf16 v[60:63], v[172:175], v[204:207], v[60:63]
  s_waitcnt lgkmcnt(4)
  v_mfma_f32_16x16x32_bf16 v[64:67], v[208:211], v[160:163], v[64:67]
  ds_read_b64_tr_b16 v[200:201], v215 offset:35840
  ds_read_b64_tr_b16 v[202:203], v215 offset:36736
  v_mfma_f32_16x16x32_bf16 v[68:71], v[208:211], v[164:167], v[68:71]
  v_mfma_f32_16x16x32_bf16 v[72:75], v[208:211], v[168:171], v[72:75]
  v_mfma_f32_16x16x32_bf16 v[76:79], v[208:211], v[172:175], v[76:79]
  s_waitcnt lgkmcnt(4)
  v_mfma_f32_16x16x32_bf16 v[80:83], v[192:195], v[160:163], v[80:83]
  ds_read_b64_tr_b16 v[204:205], v215 offset:28704
  ds_read_b64_tr_b16 v[206:207], v215 offset:29600
  v_mfma_f32_16x16x32_bf16 v[84:87], v[192:195], v[164:167], v[84:87]
  v_mfma_f32_16x16x32_bf16 v[88:91], v[192:195], v[168:171], v[88:91]
  v_mfma_f32_16x16x32_bf16 v[92:95], v[192:195], v[172:175], v[92:95]
  s_waitcnt lgkmcnt(4)
  v_mfma_f32_16x16x32_bf16 v[96:99], v[196:199], v[160:163], v[96:99]
  ds_read_b64_tr_b16 v[208:209], v215 offset:35872
  ds_read_b64_tr_b16 v[210:211], v215 offset:36768
  v_mfma_f32_16x16x32_bf16 v[100:103], v[196:199], v[164:167], v[100:103]
  v_mfma_f32_16x16x32_bf16 v[104:107], v[196:199], v[168:171], v[104:107]
  s_waitcnt vmcnt(4)
  v_mfma_f32_16x16x32_bf16 v[108:111], v[196:199], v[172:175], v[108:111]
  s_waitcnt lgkmcnt(4)
  s_barrier
  v_mfma_f32_16x16x32_bf16 v[112:115], v[200:203], v[160:163], v[112:115]
  ds_read_b64_tr_b16 v[192:193], v213 offset:18496
  ds_read_b64_tr_b16 v[194:195], v213 offset:19264
  v_mfma_f32_16x16x32_bf16 v[116:119], v[200:203], v[164:167], v[116:119]
  ds_read_b128 v[176:179], v212 offset:49152
  ds_read_b128 v[180:183], v212 offset:50176
  v_mfma_f32_16x16x32_bf16 v[120:123], v[200:203], v[168:171], v[120:123]
  v_mfma_f32_16x16x32_bf16 v[124:127], v[200:203], v[172:175], v[124:127]
  s_waitcnt lgkmcnt(6)
  v_mfma_f32_16x16x32_bf16 v[128:131], v[204:207], v[160:163], v[128:131]
  ds_read_b64_tr_b16 v[196:197], v214 offset:18496
  ds_read_b64_tr_b16 v[198:199], v214 offset:19264
  v_mfma_f32_16x16x32_bf16 v[132:135], v[204:207], v[164:167], v[132:135]
  ds_read_b128 v[184:187], v212 offset:51200
  ds_read_b128 v[188:191], v212 offset:52224
  v_mfma_f32_16x16x32_bf16 v[136:139], v[204:207], v[168:171], v[136:139]
  s_add_u32 m0, s73, 16384
  v_mfma_f32_16x16x32_bf16 v[140:143], v[204:207], v[172:175], v[140:143]
  buffer_load_dwordx4 v216, s[24:27], s69 offen sc1 lds
  s_waitcnt lgkmcnt(8)
  v_mfma_f32_16x16x32_bf16 v[144:147], v[208:211], v[160:163], v[144:147]
  ds_read_b64_tr_b16 v[200:201], v213 offset:18560
  ds_read_b64_tr_b16 v[202:203], v213 offset:19328
  v_mfma_f32_16x16x32_bf16 v[148:151], v[208:211], v[164:167], v[148:151]
  v_mfma_f32_16x16x32_bf16 v[152:155], v[208:211], v[168:171], v[152:155]
  buffer_load_dwordx4 v216, s[24:27], s69 offen offset:1024 sc1 lds
  s_add_u32 s69, s69, 2048
  v_mfma_f32_16x16x32_bf16 v[156:159], v[208:211], v[172:175], v[156:159]
  s_waitcnt lgkmcnt(2)
  v_mfma_f32_16x16x32_bf16 v[0:3], v[192:195], v[176:179], v[0:3]
  ds_read_b64_tr_b16 v[204:205], v214 offset:18560
  ds_read_b64_tr_b16 v[206:207], v214 offset:19328
  v_mfma_f32_16x16x32_bf16 v[4:7], v[192:195], v[180:183], v[4:7]
  s_add_u32 m0, s74, s68
  v_mfma_f32_16x16x32_bf16 v[8:11], v[192:195], v[184:187], v[8:11]
  buffer_load_dwordx4 v218, s[28:31], s70 offen lds
  v_mfma_f32_16x16x32_bf16 v[12:15], v[192:195], v[188:191], v[12:15]
  v_mfma_f32_16x16x32_bf16 v[16:19], v[196:199], v[176:179], v[16:19]
  ds_read_b64_tr_b16 v[208:209], v213 offset:18432
  ds_read_b64_tr_b16 v[210:211], v213 offset:19200
  v_mfma_f32_16x16x32_bf16 v[20:23], v[196:199], v[180:183], v[20:23]
  v_mfma_f32_16x16x32_bf16 v[24:27], v[196:199], v[184:187], v[24:27]
  v_mfma_f32_16x16x32_bf16 v[28:31], v[196:199], v[188:191], v[28:31]
  s_waitcnt lgkmcnt(4)
  v_mfma_f32_16x16x32_bf16 v[32:35], v[176:179], v[200:203], v[32:35]
  ds_read_b64_tr_b16 v[192:193], v214 offset:18432
  ds_read_b64_tr_b16 v[194:195], v214 offset:19200
  v_mfma_f32_16x16x32_bf16 v[36:39], v[180:183], v[200:203], v[36:39]
  s_add_u32 m0, s75, s68
  v_mfma_f32_16x16x32_bf16 v[40:43], v[184:187], v[200:203], v[40:43]
  buffer_load_dwordx4 v219, s[32:35], s70 offen lds
  s_add_u32 s70, s70, s72
  v_mfma_f32_16x16x32_bf16 v[44:47], v[188:191], v[200:203], v[44:47]
  s_waitcnt lgkmcnt(4)
  v_mfma_f32_16x16x32_bf16 v[48:51], v[176:179], v[204:207], v[48:51]
  ds_read_b64_tr_b16 v[196:197], v215 offset:43008
  ds_read_b64_tr_b16 v[198:199], v215 offset:43904
  v_mfma_f32_16x16x32_bf16 v[52:55], v[180:183], v[204:207], v[52:55]
  v_mfma_f32_16x16x32_bf16 v[56:59], v[184:187], v[204:207], v[56:59]
  v_mfma_f32_16x16x32_bf16 v[60:63], v[188:191], v[204:207], v[60:63]
  s_waitcnt lgkmcnt(4)
  v_mfma_f32_16x16x32_bf16 v[64:67], v[208:211], v[176:179], v[64:67]
  ds_read_b64_tr_b16 v[200:201], v215 offset:50176
  ds_read_b64_tr_b16 v[202:203], v215 offset:51072
  v_mfma_f32_16x16x32_bf16 v[68:71], v[208:211], v[180:183], v[68:71]
  v_mfma_f32_16x16x32_bf16 v[72:75], v[208:211], v[184:187], v[72:75]
  v_mfma_f32_16x16x32_bf16 v[76:79], v[208:211], v[188:191], v[76:79]
  s_waitcnt lgkmcnt(4)
  v_mfma_f32_16x16x32_bf16 v[80:83], v[192:195], v[176:179], v[80:83]
  ds_read_b64_tr_b16 v[204:205], v215 offset:43040
  ds_read_b64_tr_b16 v[206:207], v215 offset:43936
  v_mfma_f32_16x16x32_bf16 v[84:87], v[192:195], v[180:183], v[84:87]
  v_mfma_f32_16x16x32_bf16 v[88:91], v[192:195], v[184:187], v[88:91]
  v_mfma_f32_16x16x32_bf16 v[92:95], v[192:195], v[188:191], v[92:95]
  s_waitcnt lgkmcnt(4)
  v_mfma_f32_16x16x32_bf16 v[96:99], v[196:199], v[176:179], v[96:99]
  ds_read_b64_tr_b16 v[208:209], v215 offset:50208
  ds_read_b64_tr_b16 v[210:211], v215 offset:51104
  v_mfma_f32_16x16x32_bf16 v[100:103], v[196:199], v[180:183], v[100:103]
  v_mfma_f32_16x16x32_bf16 v[104:107], v[196:199], v[184:187], v[104:107]
  s_waitcnt vmcnt(4)
  v_mfma_f32_16x16x32_bf16 v[108:111], v[196:199], v[188:191], v[108:111]
  s_waitcnt lgkmcnt(4)
  s_barrier
  v_mfma_f32_16x16x32_bf16 v[112:115], v[200:203], v[176:179], v[112:115]
  ds_read_b64_tr_b16 v[192:193], v213 offset:64
  ds_read_b64_tr_b16 v[194:195], v213 offset:832
  v_mfma_f32_16x16x32_bf16 v[116:119], v[200:203], v[180:183], v[116:119]
  ds_read_b128 v[160:163], v212 offset:0
  ds_read_b128 v[164:167], v212 offset:1024
  v_mfma_f32_16x16x32_bf16 v[120:123], v[200:203], v[184:187], v[120:123]
  v_mfma_f32_16x16x32_bf16 v[124:127], v[200:203], v[188:191], v[124:127]
  s_waitcnt lgkmcnt(6)
  v_mfma_f32_16x16x32_bf16 v[128:131], v[204:207], v[176:179], v[128:131]
  ds_read_b64_tr_b16 v[196:197], v214 offset:64
  ds_read_b64_tr_b16 v[198:199], v214 offset:832
  v_mfma_f32_16x16x32_bf16 v[132:135], v[204:207], v[180:183], v[132:135]
  ds_read_b128 v[168:171], v212 offset:2048
  ds_read_b128 v[172:175], v212 offset:3072
  v_mfma_f32_16x16x32_bf16 v[136:139], v[204:207], v[184:187], v[136:139]
  s_add_u32 m0, s73, 32768
  v_mfma_f32_16x16x32_bf16 v[140:143], v[204:207], v[188:191], v[140:143]
  buffer_load_dwordx4 v216, s[24:27], s69 offen sc1 lds
  s_waitcnt lgkmcnt(8)
  v_mfma_f32_16x16x32_bf16 v[144:147], v[208:211], v[176:179], v[144:147]
  ds_read_b64_tr_b16 v[200:201], v213 offset:128
  ds_read_b64_tr_b16 v[202:203], v213 offset:896
  v_mfma_f32_16x16x32_bf16 v[148:151], v[208:211], v[180:183], v[148:151]
  v_mfma_f32_16x16x32_bf16 v[152:155], v[208:211], v[184:187], v[152:155]
  buffer_load_dwordx4 v216, s[24:27], s69 offen offset:1024 sc1 lds
  s_add_u32 s69, s69, 2048
  v_mfma_f32_16x16x32_bf16 v[156:159], v[208:211], v[188:191], v[156:159]
  s_add_u32 s64, s64, 1
  s_cmp_lt_u32 s64, 8
  s_cbranch_scc1 L_g0
  s_mov_b32 s10, 0xbfb8aa3b
  s_mov_b32 s11, 0xbfb8aa3b
  s_waitcnt lgkmcnt(0)
  s_barrier
  s_setprio 1
  s_add_u32 s24, s22, 0
  s_addc_u32 s25, s23, 0
  s_and_b32 s25, s25, 0xffff
  s_mov_b32 s26, 8388608
  s_mov_b32 s27, 0x20000
  v_and_b32 v224, 0x27, v221
  v_bfe_u32 v225, v221, 3, 1
  v_lshl_add_u32 v224, v225, 4, v224
  v_bfe_u32 v225, v221, 4, 1
  v_lshl_add_u32 v224, v225, 3, v224
  v_lshlrev_b32 v212, 4, v224
  v_and_b32 v224, 3, v221
  v_bfe_u32 v225, v221, 2, 1
  v_lshl_add_u32 v224, v225, 3, v224
  v_bfe_u32 v225, v221, 3, 1
  v_lshl_add_u32 v224, v225, 2, v224
  v_lshrrev_b32 v225, 4, v221
  v_lshl_add_u32 v224, v225, 5, v224
  v_lshlrev_b32 v213, 4, v224
  s_lshl_b32 s56, s49, 3
  s_lshl_b32 s57, s51, 1
  s_add_u32 s56, s56, s57
  s_lshl_b32 s56, s56, 11
  s_lshl_b32 s70, s50, 17
  s_add_u32 s74, s56, s70
  s_add_u32 s76, s74, 4194304
  s_lshl_b32 s58, s51, 13
  v_add_u32 v215, s58, v212
  v_and_b32 v216, 1024, v213
  v_add3_u32 v216, v216, v213, s58
  s_add_u32 s28, s22, 13631488
  s_addc_u32 s29, s23, 0
  s_and_b32 s29, s29, 0xffff
  s_mov_b32 s30, 14958592
  s_mov_b32 s31, 0x20000
  v_lshlrev_b32 v214, 4, v221
  s_lshl_b32 s56, s49, 3
  s_lshl_b32 s57, s51, 1
  s_add_u32 s56, s56, s57
  s_mul_i32 s58, s56, 233728
  s_mul_i32 s57, s50, 7168
  s_add_u32 s58, s58, s57
  s_add_u32 s59, s58, 233728
  s_lshl_b32 s75, s49, 1
  s_lshr_b32 s56, s51, 1
  s_add_u32 s75, s75, s56
  s_lshl_b32 s75, s75, 5
  s_add_u32 s75, s75, s50
  s_lshl_b32 s75, s75, 4
  s_and_b32 s56, s51, 1
  s_lshl_b32 s56, s56, 3
  s_add_u32 s75, s75, s56
  s_add_u32 s75, s75, 40960
  s_lshl_b32 s67, s50, 3
  s_add_u32 s67, s67, s49
  s_lshl_b32 s67, s67, 2
  s_add_u32 s67, s67, s51
  s_lshl_b32 s67, s67, 3
  s_add_u32 s67, s67, 16384
  v_cvt_pk_bf16_f32 v160, v0, v1
  v_cvt_pk_bf16_f32 v162, v4, v5
  v_cvt_pk_bf16_f32 v161, v2, v3
  v_cvt_pk_bf16_f32 v163, v6, v7
  s_nop 0
  v_permlane16_swap_b32 v160, v162
  v_permlane16_swap_b32 v161, v163
  buffer_store_dwordx4 v[160:163], v212, s[24:27], s74 offen offset:0 sc1
  ds_write_b128 v215, v[160:163] offset:0
  v_cvt_pk_bf16_f32 v164, v16, v17
  v_cvt_pk_bf16_f32 v166, v20, v21
  v_cvt_pk_bf16_f32 v165, v18, v19
  v_cvt_pk_bf16_f32 v167, v22, v23
  s_nop 0
  v_permlane16_swap_b32 v164, v166
  v_permlane16_swap_b32 v165, v167
  buffer_store_dwordx4 v[164:167], v212, s[24:27], s74 offen offset:1024 sc1
  ds_write_b128 v215, v[164:167] offset:2048
  v_cvt_pk_bf16_f32 v168, v8, v9
  v_cvt_pk_bf16_f32 v170, v12, v13
  v_cvt_pk_bf16_f32 v169, v10, v11
  v_cvt_pk_bf16_f32 v171, v14, v15
  s_nop 0
  v_permlane16_swap_b32 v168, v170
  v_permlane16_swap_b32 v169, v171
  buffer_store_dwordx4 v[168:171], v212, s[24:27], s74 offen offset:2048 sc1
  ds_write_b128 v215, v[168:171] offset:4096
  v_cvt_pk_bf16_f32 v172, v24, v25
  v_cvt_pk_bf16_f32 v174, v28, v29
  v_cvt_pk_bf16_f32 v173, v26, v27
  v_cvt_pk_bf16_f32 v175, v30, v31
  s_nop 0
  v_permlane16_swap_b32 v172, v174
  v_permlane16_swap_b32 v173, v175
  buffer_store_dwordx4 v[172:175], v212, s[24:27], s74 offen offset:3072 sc1
  ds_write_b128 v215, v[172:175] offset:6144
  v_cvt_pk_bf16_f32 v176, v32, v33
  v_cvt_pk_bf16_f32 v177, v34, v35
  v_cvt_pk_bf16_f32 v178, v36, v37
  v_cvt_pk_bf16_f32 v179, v38, v39
  buffer_store_dwordx4 v[176:179], v213, s[24:27], s76 offen offset:0 sc1
  ds_write_b128 v216, v[176:179] offset:1024
  v_cvt_pk_bf16_f32 v180, v48, v49
  v_cvt_pk_bf16_f32 v181, v50, v51
  v_cvt_pk_bf16_f32 v182, v52, v53
  v_cvt_pk_bf16_f32 v183, v54, v55
  buffer_store_dwordx4 v[180:183], v213, s[24:27], s76 offen offset:256 sc1
  ds_write_b128 v216, v[180:183] offset:1280
  v_cvt_pk_bf16_f32 v184, v40, v41
  v_cvt_pk_bf16_f32 v185, v42, v43
  v_cvt_pk_bf16_f32 v186, v44, v45
  v_cvt_pk_bf16_f32 v187, v46, v47
  buffer_store_dwordx4 v[184:187], v213, s[24:27], s76 offen offset:2048 sc1
  ds_write_b128 v216, v[184:187] offset:5120
  v_cvt_pk_bf16_f32 v188, v56, v57
  v_cvt_pk_bf16_f32 v189, v58, v59
  v_cvt_pk_bf16_f32 v190, v60, v61
  v_cvt_pk_bf16_f32 v191, v62, v63
  buffer_store_dwordx4 v[188:191], v213, s[24:27], s76 offen offset:2304 sc1
  ds_write_b128 v216, v[188:191] offset:5376
  s_mov_b32 s56, 0x3e8293ee
  s_mov_b32 s57, 0x3e8293ee
  v_pk_mul_f32 v[64:65], v[64:65], s[56:57]
  v_pk_mul_f32 v[66:67], v[66:67], s[56:57]
  v_pk_mul_f32 v[68:69], v[68:69], s[56:57]
  v_pk_mul_f32 v[70:71], v[70:71], s[56:57]
  v_cvt_pk_bf16_f32 v232, v64, v65
  v_cvt_pk_bf16_f32 v234, v68, v69
  v_cvt_pk_bf16_f32 v233, v66, v67
  v_cvt_pk_bf16_f32 v235, v70, v71
  s_nop 0
  v_permlane16_swap_b32 v232, v234
  v_permlane16_swap_b32 v233, v235
  v_pk_mul_f32 v[80:81], v[80:81], s[56:57]
  v_pk_mul_f32 v[82:83], v[82:83], s[56:57]
  v_pk_mul_f32 v[84:85], v[84:85], s[56:57]
  v_pk_mul_f32 v[86:87], v[86:87], s[56:57]
  v_cvt_pk_bf16_f32 v236, v80, v81
  v_cvt_pk_bf16_f32 v238, v84, v85
  v_cvt_pk_bf16_f32 v237, v82, v83
  v_cvt_pk_bf16_f32 v239, v86, v87
  s_nop 0
  v_permlane16_swap_b32 v236, v238
  v_permlane16_swap_b32 v237, v239
  v_pk_mul_f32 v[72:73], v[72:73], s[56:57]
  v_pk_mul_f32 v[74:75], v[74:75], s[56:57]
  v_pk_mul_f32 v[76:77], v[76:77], s[56:57]
  v_pk_mul_f32 v[78:79], v[78:79], s[56:57]
  v_cvt_pk_bf16_f32 v240, v72, v73
  v_cvt_pk_bf16_f32 v242, v76, v77
  v_cvt_pk_bf16_f32 v241, v74, v75
  v_cvt_pk_bf16_f32 v243, v78, v79
  s_nop 0
  v_permlane16_swap_b32 v240, v242
  v_permlane16_swap_b32 v241, v243
  v_pk_mul_f32 v[88:89], v[88:89], s[56:57]
  v_pk_mul_f32 v[90:91], v[90:91], s[56:57]
  v_pk_mul_f32 v[92:93], v[92:93], s[56:57]
  v_pk_mul_f32 v[94:95], v[94:95], s[56:57]
  v_cvt_pk_bf16_f32 v244, v88, v89
  v_cvt_pk_bf16_f32 v246, v92, v93
  v_cvt_pk_bf16_f32 v245, v90, v91
  v_cvt_pk_bf16_f32 v247, v94, v95
  s_nop 0
  v_permlane16_swap_b32 v244, v246
  v_permlane16_swap_b32 v245, v247
  v_pk_mul_f32 v[224:225], v[96:97], s[10:11]
  v_pk_mul_f32 v[226:227], v[98:99], s[10:11]
  v_pk_mul_f32 v[228:229], v[100:101], s[10:11]
  v_pk_mul_f32 v[230:231], v[102:103], s[10:11]
  v_exp_f32 v224, v224
  v_exp_f32 v225, v225
  v_exp_f32 v226, v226
  v_exp_f32 v227, v227
  v_exp_f32 v228, v228
  v_exp_f32 v229, v229
  v_exp_f32 v230, v230
  v_exp_f32 v231, v231
  v_pk_mul_f32 v[96:97], v[96:97], v[112:113]
  v_pk_mul_f32 v[98:99], v[98:99], v[114:115]
  v_pk_mul_f32 v[100:101], v[100:101], v[116:117]
  v_pk_mul_f32 v[102:103], v[102:103], v[118:119]
  v_pk_add_f32 v[224:225], v[224:225], 1.0 op_sel_hi:[1,0]
  v_pk_add_f32 v[226:227], v[226:227], 1.0 op_sel_hi:[1,0]
  v_pk_add_f32 v[228:229], v[228:229], 1.0 op_sel_hi:[1,0]
  v_pk_add_f32 v[230:231], v[230:231], 1.0 op_sel_hi:[1,0]
  v_rcp_f32 v224, v224
  v_rcp_f32 v225, v225
  v_rcp_f32 v226, v226
  v_rcp_f32 v227, v227
  v_rcp_f32 v228, v228
  v_rcp_f32 v229, v229
  v_rcp_f32 v230, v230
  v_rcp_f32 v231, v231
  s_nop 0
  v_pk_mul_f32 v[96:97], v[96:97], v[224:225]
  v_pk_mul_f32 v[98:99], v[98:99], v[226:227]
  v_pk_mul_f32 v[100:101], v[100:101], v[228:229]
  v_pk_mul_f32 v[102:103], v[102:103], v[230:231]
  v_cvt_pk_bf16_f32 v196, v96, v97
  v_cvt_pk_bf16_f32 v198, v100, v101
  v_cvt_pk_bf16_f32 v197, v98, v99
  v_cvt_pk_bf16_f32 v199, v102, v103
  s_nop 0
  v_permlane16_swap_b32 v196, v198
  v_permlane16_swap_b32 v197, v199
  v_pk_mul_f32 v[224:225], v[104:105], s[10:11]
  v_pk_mul_f32 v[226:227], v[106:107], s[10:11]
  v_pk_mul_f32 v[228:229], v[108:109], s[10:11]
  v_pk_mul_f32 v[230:231], v[110:111], s[10:11]
  v_exp_f32 v224, v224
  v_exp_f32 v225, v225
  v_exp_f32 v226, v226
  v_exp_f32 v227, v227
  v_exp_f32 v228, v228
  v_exp_f32 v229, v229
  v_exp_f32 v230, v230
  v_exp_f32 v231, v231
  v_pk_mul_f32 v[104:105], v[104:105], v[120:121]
  v_pk_mul_f32 v[106:107], v[106:107], v[122:123]
  v_pk_mul_f32 v[108:109], v[108:109], v[124:125]
  v_pk_mul_f32 v[110:111], v[110:111], v[126:127]
  v_pk_add_f32 v[224:225], v[224:225], 1.0 op_sel_hi:[1,0]
  v_pk_add_f32 v[226:227], v[226:227], 1.0 op_sel_hi:[1,0]
  v_pk_add_f32 v[228:229], v[228:229], 1.0 op_sel_hi:[1,0]
  v_pk_add_f32 v[230:231], v[230:231], 1.0 op_sel_hi:[1,0]
  v_rcp_f32 v224, v224
  v_rcp_f32 v225, v225
  v_rcp_f32 v226, v226
  v_rcp_f32 v227, v227
  v_rcp_f32 v228, v228
  v_rcp_f32 v229, v229
  v_rcp_f32 v230, v230
  v_rcp_f32 v231, v231
  s_nop 0
  v_pk_mul_f32 v[104:105], v[104:105], v[224:225]
  v_pk_mul_f32 v[106:107], v[106:107], v[226:227]
  v_pk_mul_f32 v[108:109], v[108:109], v[228:229]
  v_pk_mul_f32 v[110:111], v[110:111], v[230:231]
  v_cvt_pk_bf16_f32 v200, v104, v105
  v_cvt_pk_bf16_f32 v202, v108, v109
  v_cvt_pk_bf16_f32 v201, v106, v107
  v_cvt_pk_bf16_f32 v203, v110, v111
  s_nop 0
  v_permlane16_swap_b32 v200, v202
  v_permlane16_swap_b32 v201, v203
  s_waitcnt vmcnt(0)
  v_mov_b32 v222, s54
  v_mov_b32 v223, s55
  s_mov_b64 exec, 1
  buffer_store_dwordx2 v[222:223], off, s[44:47], s67 sc1
  s_mov_b64 exec, -1
  v_pk_mul_f32 v[224:225], v[128:129], s[10:11]
  v_pk_mul_f32 v[226:227], v[130:131], s[10:11]
  v_pk_mul_f32 v[228:229], v[132:133], s[10:11]
  v_pk_mul_f32 v[230:231], v[134:135], s[10:11]
  v_exp_f32 v224, v224
  v_exp_f32 v225, v225
  v_exp_f32 v226, v226
  v_exp_f32 v227, v227
  v_exp_f32 v228, v228
  v_exp_f32 v229, v229
  v_exp_f32 v230, v230
  v_exp_f32 v231, v231
  v_pk_mul_f32 v[128:129], v[128:129], v[144:145]
  v_pk_mul_f32 v[130:131], v[130:131], v[146:147]
  v_pk_mul_f32 v[132:133], v[132:133], v[148:149]
  v_pk_mul_f32 v[134:135], v[134:135], v[150:151]
  v_pk_add_f32 v[224:225], v[224:225], 1.0 op_sel_hi:[1,0]
  v_pk_add_f32 v[226:227], v[226:227], 1.0 op_sel_hi:[1,0]
  v_pk_add_f32 v[228:229], v[228:229], 1.0 op_sel_hi:[1,0]
  v_pk_add_f32 v[230:231], v[230:231], 1.0 op_sel_hi:[1,0]
  v_rcp_f32 v224, v224
  v_rcp_f32 v225, v225
  v_rcp_f32 v226, v226
  v_rcp_f32 v227, v227
  v_rcp_f32 v228, v228
  v_rcp_f32 v229, v229
  v_rcp_f32 v230, v230
  v_rcp_f32 v231, v231
  s_nop 0
  v_pk_mul_f32 v[128:129], v[128:129], v[224:225]
  v_pk_mul_f32 v[130:131], v[130:131], v[226:227]
  v_pk_mul_f32 v[132:133], v[132:133], v[228:229]
  v_pk_mul_f32 v[134:135], v[134:135], v[230:231]
  v_cvt_pk_bf16_f32 v204, v128, v129
  v_cvt_pk_bf16_f32 v206, v132, v133
  v_cvt_pk_bf16_f32 v205, v130, v131
  v_cvt_pk_bf16_f32 v207, v134, v135
  s_nop 0
  v_permlane16_swap_b32 v204, v206
  v_permlane16_swap_b32 v205, v207
  v_pk_mul_f32 v[224:225], v[136:137], s[10:11]
  v_pk_mul_f32 v[226:227], v[138:139], s[10:11]
  v_pk_mul_f32 v[228:229], v[140:141], s[10:11]
  v_pk_mul_f32 v[230:231], v[142:143], s[10:11]
  v_exp_f32 v224, v224
  v_exp_f32 v225, v225
  v_exp_f32 v226, v226
  v_exp_f32 v227, v227
  v_exp_f32 v228, v228
  v_exp_f32 v229, v229
  v_exp_f32 v230, v230
  v_exp_f32 v231, v231
  v_pk_mul_f32 v[136:137], v[136:137], v[152:153]
  v_pk_mul_f32 v[138:139], v[138:139], v[154:155]
  v_pk_mul_f32 v[140:141], v[140:141], v[156:157]
  v_pk_mul_f32 v[142:143], v[142:143], v[158:159]
  v_pk_add_f32 v[224:225], v[224:225], 1.0 op_sel_hi:[1,0]
  v_pk_add_f32 v[226:227], v[226:227], 1.0 op_sel_hi:[1,0]
  v_pk_add_f32 v[228:229], v[228:229], 1.0 op_sel_hi:[1,0]
  v_pk_add_f32 v[230:231], v[230:231], 1.0 op_sel_hi:[1,0]
  v_rcp_f32 v224, v224
  v_rcp_f32 v225, v225
  v_rcp_f32 v226, v226
  v_rcp_f32 v227, v227
  v_rcp_f32 v228, v228
  v_rcp_f32 v229, v229
  v_rcp_f32 v230, v230
  v_rcp_f32 v231, v231
  s_nop 0
  v_pk_mul_f32 v[136:137], v[136:137], v[224:225]
  v_pk_mul_f32 v[138:139], v[138:139], v[226:227]
  v_pk_mul_f32 v[140:141], v[140:141], v[228:229]
  v_pk_mul_f32 v[142:143], v[142:143], v[230:231]
  v_cvt_pk_bf16_f32 v208, v136, v137
  v_cvt_pk_bf16_f32 v210, v140, v141
  v_cvt_pk_bf16_f32 v209, v138, v139
  v_cvt_pk_bf16_f32 v211, v142, v143
  s_nop 0
  v_permlane16_swap_b32 v208, v210
  v_permlane16_swap_b32 v209, v211
  buffer_store_dwordx4 v[196:199], v214, s[28:31], s58 offen offset:0 sc1
  buffer_store_dwordx4 v[200:203], v214, s[28:31], s59 offen offset:0 sc1
  buffer_store_dwordx4 v[204:207], v214, s[28:31], s58 offen offset:1024 sc1
  buffer_store_dwordx4 v[208:211], v214, s[28:31], s59 offen offset:1024 sc1
  v_and_b32 v130, 31, v221
  v_lshlrev_b32 v130, 3, v130
  s_lshl_b32 s69, s50, 8
  s_add_u32 s69, s69, 16384
  v_lshlrev_b32 v128, 4, v221
  s_lshl_b32 s73, s51, 10
  s_add_u32 s56, s70, s73
  v_add_u32 v176, s56, v128
  v_add_u32 v177, 4096, v176
  v_add_u32 v178, 8192, v176
  v_add_u32 v179, 12288, v176
  v_add_u32 v180, 4193280, v176
  v_add_u32 v181, 4193280, v177
  v_add_u32 v182, 4193280, v178
  v_add_u32 v183, 4193280, v179
  s_lshl_b32 s73, s51, 11
  v_mov_b32 v135, 0x3f803f80
  v_and_b32 v134, 6, v221
  v_cmp_eq_u32 vcc, 0, v134
  v_cmp_eq_u32 s[56:57], 4, v134
  v_and_b32 v134, 1, v221
  s_nop 0
  v_cndmask_b32 v88, 0, v135, vcc
  v_cndmask_b32 v90, 0, v135, s[56:57]
  v_mul_u32_u24 v92, 0xaaaa, v134
  v_add_u32 v92, 0x4444, v92
  v_mov_b32 v89, v88
  v_mov_b32 v91, v90
  s_mov_b32 s76, s69
  s_lshl_b32 s69, s49, 14
  s_mov_b32 s64, 0
  v_mov_b32 v32, 0
  v_mov_b32 v33, 0
  v_mov_b32 v34, 0
  v_mov_b32 v35, 0
  v_mov_b32 v36, 0
  v_mov_b32 v37, 0
  v_mov_b32 v38, 0
  v_mov_b32 v39, 0
  v_mov_b32 v48, 0
  v_mov_b32 v49, 0
  v_mov_b32 v50, 0
  v_mov_b32 v51, 0
  v_mov_b32 v52, 0
  v_mov_b32 v53, 0
  v_mov_b32 v54, 0
  v_mov_b32 v55, 0
  v_mov_b32 v56, 0
  v_mov_b32 v57, 0
  v_mov_b32 v58, 0
  v_mov_b32 v59, 0
  v_mov_b32 v60, 0
  v_mov_b32 v61, 0
  v_mov_b32 v62, 0
  v_mov_b32 v63, 0
  v_mov_b32 v64, 0
  v_mov_b32 v65, 0
  v_mov_b32 v66, 0
  v_mov_b32 v67, 0
  v_mov_b32 v68, 0
  v_mov_b32 v69, 0
  v_mov_b32 v70, 0
  v_mov_b32 v71, 0
  v_mov_b32 v72, 0
  v_mov_b32 v73, 0
  v_mov_b32 v74, 0
  v_mov_b32 v75, 0
  v_mov_b32 v76, 0
  v_mov_b32 v77, 0
  v_mov_b32 v78, 0
  v_mov_b32 v79, 0
  v_mov_b32 v80, 0
  v_mov_b32 v81, 0
  v_mov_b32 v82, 0
  v_mov_b32 v83, 0
  v_mov_b32 v84, 0
  v_mov_b32 v85, 0
  v_mov_b32 v86, 0
  v_mov_b32 v87, 0
  v_mov_b32 v120, 0
  v_mov_b32 v121, 0
  v_mov_b32 v122, 0
  v_mov_b32 v123, 0
  v_mov_b32 v124, 0
  v_mov_b32 v125, 0
  v_mov_b32 v126, 0
  v_mov_b32 v127, 0
  s_waitcnt lgkmcnt(0)
  s_barrier
  ds_read_b128 v[96:99], v128 offset:0
  ds_read_b128 v[100:103], v128 offset:2048
  ds_read_b128 v[112:115], v128 offset:1024
  ds_read_b128 v[116:119], v128 offset:3072
  s_waitcnt lgkmcnt(0)
  v_mfma_f32_32x32x16_bf16 v[0:15], v[96:99], v[232:235], 0
  v_mfma_f32_32x32x16_bf16 v[0:15], v[100:103], v[236:239], v[0:15]
  s_nop 11
.p2align 6
L_att:
  v_mfma_f32_32x32x16_bf16 v[16:31], v[96:99], v[240:243], 0
  v_exp_f32 v0, v0
  v_exp_f32 v1, v1
  v_exp_f32 v2, v2
  v_mfma_f32_32x32x16_bf16 v[16:31], v[100:103], v[244:247], v[16:31]
  v_exp_f32 v3, v3
  v_exp_f32 v4, v4
  v_exp_f32 v5, v5
  v_mfma_f32_32x32x16_bf16 v[64:79], v[124:127], v[36:39], v[64:79]
  v_exp_f32 v6, v6
  v_exp_f32 v7, v7
  v_exp_f32 v8, v8
  v_smfmac_f32_16x16x64_bf16 v[84:87], v[88:91], v[32:39], v92
  ds_read_b128 v[104:107], v128 offset:4096
  ds_read_b128 v[108:111], v128 offset:6144
  v_cvt_pk_bf16_f32 v32, v0, v1
  v_cvt_pk_bf16_f32 v33, v2, v3
  v_cvt_pk_bf16_f32 v34, v4, v5
  v_cvt_pk_bf16_f32 v35, v6, v7
  v_exp_f32 v9, v9
  v_exp_f32 v10, v10
  s_waitcnt lgkmcnt(2)
  v_mfma_f32_32x32x16_bf16 v[48:63], v[112:115], v[32:35], v[48:63]
  ds_read_b128 v[120:123], v128 offset:5120
  ds_read_b128 v[124:127], v128 offset:7168
  v_exp_f32 v11, v11
  v_exp_f32 v12, v12
  v_exp_f32 v13, v13
  v_exp_f32 v14, v14
  v_exp_f32 v15, v15
  v_cvt_pk_bf16_f32 v36, v8, v9
  v_cvt_pk_bf16_f32 v37, v10, v11
  v_cvt_pk_bf16_f32 v38, v12, v13
  v_cvt_pk_bf16_f32 v39, v14, v15
  s_waitcnt lgkmcnt(2)
  v_mfma_f32_32x32x16_bf16 v[0:15], v[104:107], v[232:235], 0
  v_exp_f32 v16, v16
  v_exp_f32 v17, v17
  v_exp_f32 v18, v18
  v_mfma_f32_32x32x16_bf16 v[0:15], v[108:111], v[236:239], v[0:15]
  v_exp_f32 v19, v19
  v_exp_f32 v20, v20
  v_exp_f32 v21, v21
  v_mfma_f32_32x32x16_bf16 v[48:63], v[116:119], v[36:39], v[48:63]
  v_exp_f32 v22, v22
  v_exp_f32 v23, v23
  v_exp_f32 v24, v24
  v_smfmac_f32_16x16x64_bf16 v[80:83], v[88:91], v[32:39], v92
  v_cvt_pk_bf16_f32 v32, v16, v17
  v_cvt_pk_bf16_f32 v33, v18, v19
  v_cvt_pk_bf16_f32 v34, v20, v21
  v_cvt_pk_bf16_f32 v35, v22, v23
  v_exp_f32 v25, v25
  v_exp_f32 v26, v26
  v_mfma_f32_32x32x16_bf16 v[64:79], v[112:115], v[32:35], v[64:79]
  v_exp_f32 v27, v27
  v_exp_f32 v28, v28
  v_exp_f32 v29, v29
  v_exp_f32 v30, v30
  v_exp_f32 v31, v31
  v_cvt_pk_bf16_f32 v36, v24, v25
  v_cvt_pk_bf16_f32 v37, v26, v27
  v_cvt_pk_bf16_f32 v38, v28, v29
  v_cvt_pk_bf16_f32 v39, v30, v31
  s_cmp_eq_u32 s64, 0
  s_cbranch_scc1 L_att_early0
  s_waitcnt vmcnt(2)
L_att_early0_ret:
  s_barrier
  v_mfma_f32_32x32x16_bf16 v[16:31], v[104:107], v[240:243], 0
  v_exp_f32 v0, v0
  v_exp_f32 v1, v1
  v_exp_f32 v2, v2
  v_mfma_f32_32x32x16_bf16 v[16:31], v[108:111], v[244:247], v[16:31]
  v_exp_f32 v3, v3
  v_exp_f32 v4, v4
  v_exp_f32 v5, v5
  v_mfma_f32_32x32x16_bf16 v[64:79], v[116:119], v[36:39], v[64:79]
  v_exp_f32 v6, v6
  v_exp_f32 v7, v7
  v_exp_f32 v8, v8
  v_smfmac_f32_16x16x64_bf16 v[84:87], v[88:91], v[32:39], v92
  ds_read_b128 v[96:99], v128 offset:8192
  ds_read_b128 v[100:103], v128 offset:10240
  s_add_u32 m0, s73, 24576
  v_cvt_pk_bf16_f32 v32, v0, v1
  v_cvt_pk_bf16_f32 v33, v2, v3
  v_cvt_pk_bf16_f32 v34, v4, v5
  v_cvt_pk_bf16_f32 v35, v6, v7
  v_exp_f32 v9, v9
  v_exp_f32 v10, v10
  s_waitcnt lgkmcnt(2)
  v_mfma_f32_32x32x16_bf16 v[48:63], v[120:123], v[32:35], v[48:63]
  ds_read_b128 v[112:115], v128 offset:9216
  ds_read_b128 v[116:119], v128 offset:11264
  buffer_load_dwordx4 v179, s[24:27], s69 offen sc1 lds
  buffer_load_dwordx4 v183, s[24:27], s69 offen offset:1024 sc1 lds
  s_add_u32 s69, s69, 16384
  s_and_b32 s69, s69, 0x1ffff
  v_exp_f32 v11, v11
  v_exp_f32 v12, v12
  v_exp_f32 v13, v13
  v_exp_f32 v14, v14
  v_exp_f32 v15, v15
  v_cvt_pk_bf16_f32 v36, v8, v9
  v_cvt_pk_bf16_f32 v37, v10, v11
  v_cvt_pk_bf16_f32 v38, v12, v13
  v_cvt_pk_bf16_f32 v39, v14, v15
  s_waitcnt lgkmcnt(2)
  v_mfma_f32_32x32x16_bf16 v[0:15], v[96:99], v[232:235], 0
  v_exp_f32 v16, v16
  v_exp_f32 v17, v17
  v_exp_f32 v18, v18
  v_mfma_f32_32x32x16_bf16 v[0:15], v[100:103], v[236:239], v[0:15]
  v_exp_f32 v19, v19
  v_exp_f32 v20, v20
  v_exp_f32 v21, v21
  v_mfma_f32_32x32x16_bf16 v[48:63], v[124:127], v[36:39], v[48:63]
  v_exp_f32 v22, v22
  v_exp_f32 v23, v23
  v_exp_f32 v24, v24
  v_smfmac_f32_16x16x64_bf16 v[80:83], v[88:91], v[32:39], v92
  v_cvt_pk_bf16_f32 v32, v16, v17
  v_cvt_pk_bf16_f32 v33, v18, v19
  v_cvt_pk_bf16_f32 v34, v20, v21
  v_cvt_pk_bf16_f32 v35, v22, v23
  v_exp_f32 v25, v25
  v_exp_f32 v26, v26
  v_mfma_f32_32x32x16_bf16 v[64:79], v[120:123], v[32:35], v[64:79]
  v_exp_f32 v27, v27
  v_exp_f32 v28, v28
  v_exp_f32 v29, v29
  v_exp_f32 v30, v30
  v_exp_f32 v31, v31
  v_cvt_pk_bf16_f32 v36, v24, v25
  v_cvt_pk_bf16_f32 v37, v26, v27
  v_cvt_pk_bf16_f32 v38, v28, v29
  v_cvt_pk_bf16_f32 v39, v30, v31
  v_mfma_f32_32x32x16_bf16 v[16:31], v[96:99], v[240:243], 0
  v_exp_f32 v0, v0
  v_exp_f32 v1, v1
  v_exp_f32 v2, v2
  v_mfma_f32_32x32x16_bf16 v[16:31], v[100:103], v[244:247], v[16:31]
  v_exp_f32 v3, v3
  v_exp_f32 v4, v4
  v_exp_f32 v5, v5
  v_mfma_f32_32x32x16_bf16 v[64:79], v[124:127], v[36:39], v[64:79]
  v_exp_f32 v6, v6
  v_exp_f32 v7, v7
  v_exp_f32 v8, v8
  v_smfmac_f32_16x16x64_bf16 v[84:87], v[88:91], v[32:39], v92
  ds_read_b128 v[104:107], v128 offset:12288
  ds_read_b128 v[108:111], v128 offset:14336
  v_cvt_pk_bf16_f32 v32, v0, v1
  v_cvt_pk_bf16_f32 v33, v2, v3
  v_cvt_pk_bf16_f32 v34, v4, v5
  v_cvt_pk_bf16_f32 v35, v6, v7
  v_exp_f32 v9, v9
  v_exp_f32 v10, v10
  s_waitcnt lgkmcnt(2)
  v_mfma_f32_32x32x16_bf16 v[48:63], v[112:115], v[32:35], v[48:63]
  ds_read_b128 v[120:123], v128 offset:13312
  ds_read_b128 v[124:127], v128 offset:15360
  v_exp_f32 v11, v11
  v_exp_f32 v12, v12
  v_exp_f32 v13, v13
  v_exp_f32 v14, v14
  v_exp_f32 v15, v15
  v_cvt_pk_bf16_f32 v36, v8, v9
  v_cvt_pk_bf16_f32 v37, v10, v11
  v_cvt_pk_bf16_f32 v38, v12, v13
  v_cvt_pk_bf16_f32 v39, v14, v15
  s_waitcnt lgkmcnt(2)
  v_mfma_f32_32x32x16_bf16 v[0:15], v[104:107], v[232:235], 0
  v_exp_f32 v16, v16
  v_exp_f32 v17, v17
  v_exp_f32 v18, v18
  v_mfma_f32_32x32x16_bf16 v[0:15], v[108:111], v[236:239], v[0:15]
  v_exp_f32 v19, v19
  v_exp_f32 v20, v20
  v_exp_f32 v21, v21
  v_mfma_f32_32x32x16_bf16 v[48:63], v[116:119], v[36:39], v[48:63]
  v_exp_f32 v22, v22
  v_exp_f32 v23, v23
  v_exp_f32 v24, v24
  v_smfmac_f32_16x16x64_bf16 v[80:83], v[88:91], v[32:39], v92
  v_cvt_pk_bf16_f32 v32, v16, v17
  v_cvt_pk_bf16_f32 v33, v18, v19
  v_cvt_pk_bf16_f32 v34, v20, v21
  v_cvt_pk_bf16_f32 v35, v22, v23
  v_exp_f32 v25, v25
  v_exp_f32 v26, v26
  v_mfma_f32_32x32x16_bf16 v[64:79], v[112:115], v[32:35], v[64:79]
  v_exp_f32 v27, v27
  v_exp_f32 v28, v28
  v_exp_f32 v29, v29
  v_exp_f32 v30, v30
  v_exp_f32 v31, v31
  v_cvt_pk_bf16_f32 v36, v24, v25
  v_cvt_pk_bf16_f32 v37, v26, v27
  v_cvt_pk_bf16_f32 v38, v28, v29
  v_cvt_pk_bf16_f32 v39, v30, v31
  s_cmp_eq_u32 s64, 0
  s_cbranch_scc1 L_att_early1
  s_waitcnt vmcnt(2)
L_att_early1_ret:
  s_barrier
  v_mfma_f32_32x32x16_bf16 v[16:31], v[104:107], v[240:243], 0
  v_exp_f32 v0, v0
  v_exp_f32 v1, v1
  v_exp_f32 v2, v2
  v_mfma_f32_32x32x16_bf16 v[16:31], v[108:111], v[244:247], v[16:31]
  v_exp_f32 v3, v3
  v_exp_f32 v4, v4
  v_exp_f32 v5, v5
  v_mfma_f32_32x32x16_bf16 v[64:79], v[116:119], v[36:39], v[64:79]
  v_exp_f32 v6, v6
  v_exp_f32 v7, v7
  v_exp_f32 v8, v8
  v_smfmac_f32_16x16x64_bf16 v[84:87], v[88:91], v[32:39], v92
  ds_read_b128 v[96:99], v128 offset:16384
  ds_read_b128 v[100:103], v128 offset:18432
  s_add_u32 m0, s73, 0
  v_cvt_pk_bf16_f32 v32, v0, v1
  v_cvt_pk_bf16_f32 v33, v2, v3
  v_cvt_pk_bf16_f32 v34, v4, v5
  v_cvt_pk_bf16_f32 v35, v6, v7
  v_exp_f32 v9, v9
  v_exp_f32 v10, v10
  s_waitcnt lgkmcnt(2)
  v_mfma_f32_32x32x16_bf16 v[48:63], v[120:123], v[32:35], v[48:63]
  ds_read_b128 v[112:115], v128 offset:17408
  ds_read_b128 v[116:119], v128 offset:19456
  buffer_load_dwordx4 v176, s[24:27], s69 offen sc1 lds
  buffer_load_dwordx4 v180, s[24:27], s69 offen offset:1024 sc1 lds
  v_exp_f32 v11, v11
  v_exp_f32 v12, v12
  v_exp_f32 v13, v13
  v_exp_f32 v14, v14
  v_exp_f32 v15, v15
  v_cvt_pk_bf16_f32 v36, v8, v9
  v_cvt_pk_bf16_f32 v37, v10, v11
  v_cvt_pk_bf16_f32 v38, v12, v13
  v_cvt_pk_bf16_f32 v39, v14, v15
  s_waitcnt lgkmcnt(2)
  v_mfma_f32_32x32x16_bf16 v[0:15], v[96:99], v[232:235], 0
  v_exp_f32 v16, v16
  v_exp_f32 v17, v17
  v_exp_f32 v18, v18
  v_mfma_f32_32x32x16_bf16 v[0:15], v[100:103], v[236:239], v[0:15]
  v_exp_f32 v19, v19
  v_exp_f32 v20, v20
  v_exp_f32 v21, v21
  v_mfma_f32_32x32x16_bf16 v[48:63], v[124:127], v[36:39], v[48:63]
  v_exp_f32 v22, v22
  v_exp_f32 v23, v23
  v_exp_f32 v24, v24
  v_smfmac_f32_16x16x64_bf16 v[80:83], v[88:91], v[32:39], v92
  v_cvt_pk_bf16_f32 v32, v16, v17
  v_cvt_pk_bf16_f32 v33, v18, v19
  v_cvt_pk_bf16_f32 v34, v20, v21
  v_cvt_pk_bf16_f32 v35, v22, v23
  v_exp_f32 v25, v25
  v_exp_f32 v26, v26
  v_mfma_f32_32x32x16_bf16 v[64:79], v[120:123], v[32:35], v[64:79]
  v_exp_f32 v27, v27
  v_exp_f32 v28, v28
  v_exp_f32 v29, v29
  v_exp_f32 v30, v30
  v_exp_f32 v31, v31
  v_cvt_pk_bf16_f32 v36, v24, v25
  v_cvt_pk_bf16_f32 v37, v26, v27
  v_cvt_pk_bf16_f32 v38, v28, v29
  v_cvt_pk_bf16_f32 v39, v30, v31
  v_mfma_f32_32x32x16_bf16 v[16:31], v[96:99], v[240:243], 0
  v_exp_f32 v0, v0
  v_exp_f32 v1, v1
  v_exp_f32 v2, v2
  v_mfma_f32_32x32x16_bf16 v[16:31], v[100:103], v[244:247], v[16:31]
  v_exp_f32 v3, v3
  v_exp_f32 v4, v4
  v_exp_f32 v5, v5
  v_mfma_f32_32x32x16_bf16 v[64:79], v[124:127], v[36:39], v[64:79]
  v_exp_f32 v6, v6
  v_exp_f32 v7, v7
  v_exp_f32 v8, v8
  v_smfmac_f32_16x16x64_bf16 v[84:87], v[88:91], v[32:39], v92
  ds_read_b128 v[104:107], v128 offset:20480
  ds_read_b128 v[108:111], v128 offset:22528
  v_cvt_pk_bf16_f32 v32, v0, v1
  v_cvt_pk_bf16_f32 v33, v2, v3
  v_cvt_pk_bf16_f32 v34, v4, v5
  v_cvt_pk_bf16_f32 v35, v6, v7
  v_exp_f32 v9, v9
  v_exp_f32 v10, v10
  s_waitcnt lgkmcnt(2)
  v_mfma_f32_32x32x16_bf16 v[48:63], v[112:115], v[32:35], v[48:63]
  ds_read_b128 v[120:123], v128 offset:21504
  ds_read_b128 v[124:127], v128 offset:23552
  v_exp_f32 v11, v11
  v_exp_f32 v12, v12
  v_exp_f32 v13, v13
  v_exp_f32 v14, v14
  v_exp_f32 v15, v15
  v_cvt_pk_bf16_f32 v36, v8, v9
  v_cvt_pk_bf16_f32 v37, v10, v11
  v_cvt_pk_bf16_f32 v38, v12, v13
  v_cvt_pk_bf16_f32 v39, v14, v15
  s_waitcnt lgkmcnt(2)
  v_mfma_f32_32x32x16_bf16 v[0:15], v[104:107], v[232:235], 0
  v_exp_f32 v16, v16
  v_exp_f32 v17, v17
  v_exp_f32 v18, v18
  v_mfma_f32_32x32x16_bf16 v[0:15], v[108:111], v[236:239], v[0:15]
  v_exp_f32 v19, v19
  v_exp_f32 v20, v20
  v_exp_f32 v21, v21
  v_mfma_f32_32x32x16_bf16 v[48:63], v[116:119], v[36:39], v[48:63]
  v_exp_f32 v22, v22
  v_exp_f32 v23, v23
  v_exp_f32 v24, v24
  v_smfmac_f32_16x16x64_bf16 v[80:83], v[88:91], v[32:39], v92
  v_cvt_pk_bf16_f32 v32, v16, v17
  v_cvt_pk_bf16_f32 v33, v18, v19
  v_cvt_pk_bf16_f32 v34, v20, v21
  v_cvt_pk_bf16_f32 v35, v22, v23
  v_exp_f32 v25, v25
  v_exp_f32 v26, v26
  v_mfma_f32_32x32x16_bf16 v[64:79], v[112:115], v[32:35], v[64:79]
  v_exp_f32 v27, v27
  v_exp_f32 v28, v28
  v_exp_f32 v29, v29
  v_exp_f32 v30, v30
  v_exp_f32 v31, v31
  v_cvt_pk_bf16_f32 v36, v24, v25
  v_cvt_pk_bf16_f32 v37, v26, v27
  v_cvt_pk_bf16_f32 v38, v28, v29
  v_cvt_pk_bf16_f32 v39, v30, v31
  s_waitcnt vmcnt(2)
  s_barrier
  v_mfma_f32_32x32x16_bf16 v[16:31], v[104:107], v[240:243], 0
  v_exp_f32 v0, v0
  v_exp_f32 v1, v1
  v_exp_f32 v2, v2
  v_mfma_f32_32x32x16_bf16 v[16:31], v[108:111], v[244:247], v[16:31]
  v_exp_f32 v3, v3
  v_exp_f32 v4, v4
  v_exp_f32 v5, v5
  v_mfma_f32_32x32x16_bf16 v[64:79], v[116:119], v[36:39], v[64:79]
  v_exp_f32 v6, v6
  v_exp_f32 v7, v7
  v_exp_f32 v8, v8
  v_smfmac_f32_16x16x64_bf16 v[84:87], v[88:91], v[32:39], v92
  ds_read_b128 v[96:99], v128 offset:24576
  ds_read_b128 v[100:103], v128 offset:26624
  s_add_u32 m0, s73, 8192
  v_cvt_pk_bf16_f32 v32, v0, v1
  v_cvt_pk_bf16_f32 v33, v2, v3
  v_cvt_pk_bf16_f32 v34, v4, v5
  v_cvt_pk_bf16_f32 v35, v6, v7
  v_exp_f32 v9, v9
  v_exp_f32 v10, v10
  s_waitcnt lgkmcnt(2)
  v_mfma_f32_32x32x16_bf16 v[48:63], v[120:123], v[32:35], v[48:63]
  ds_read_b128 v[112:115], v128 offset:25600
  ds_read_b128 v[116:119], v128 offset:27648
  buffer_load_dwordx4 v177, s[24:27], s69 offen sc1 lds
  buffer_load_dwordx4 v181, s[24:27], s69 offen offset:1024 sc1 lds
  v_exp_f32 v11, v11
  v_exp_f32 v12, v12
  v_exp_f32 v13, v13
  v_exp_f32 v14, v14
  v_exp_f32 v15, v15
  v_cvt_pk_bf16_f32 v36, v8, v9
  v_cvt_pk_bf16_f32 v37, v10, v11
  v_cvt_pk_bf16_f32 v38, v12, v13
  v_cvt_pk_bf16_f32 v39, v14, v15
  s_waitcnt lgkmcnt(2)
  v_mfma_f32_32x32x16_bf16 v[0:15], v[96:99], v[232:235], 0
  v_exp_f32 v16, v16
  v_exp_f32 v17, v17
  v_exp_f32 v18, v18
  v_mfma_f32_32x32x16_bf16 v[0:15], v[100:103], v[236:239], v[0:15]
  v_exp_f32 v19, v19
  v_exp_f32 v20, v20
  v_exp_f32 v21, v21
  v_mfma_f32_32x32x16_bf16 v[48:63], v[124:127], v[36:39], v[48:63]
  v_exp_f32 v22, v22
  v_exp_f32 v23, v23
  v_exp_f32 v24, v24
  v_smfmac_f32_16x16x64_bf16 v[80:83], v[88:91], v[32:39], v92
  v_cvt_pk_bf16_f32 v32, v16, v17
  v_cvt_pk_bf16_f32 v33, v18, v19
  v_cvt_pk_bf16_f32 v34, v20, v21
  v_cvt_pk_bf16_f32 v35, v22, v23
  v_exp_f32 v25, v25
  v_exp_f32 v26, v26
  v_mfma_f32_32x32x16_bf16 v[64:79], v[120:123], v[32:35], v[64:79]
  v_exp_f32 v27, v27
  v_exp_f32 v28, v28
  v_exp_f32 v29, v29
  v_exp_f32 v30, v30
  v_exp_f32 v31, v31
  v_cvt_pk_bf16_f32 v36, v24, v25
  v_cvt_pk_bf16_f32 v37, v26, v27
  v_cvt_pk_bf16_f32 v38, v28, v29
  v_cvt_pk_bf16_f32 v39, v30, v31
  v_mfma_f32_32x32x16_bf16 v[16:31], v[96:99], v[240:243], 0
  v_exp_f32 v0, v0
  v_exp_f32 v1, v1
  v_exp_f32 v2, v2
  v_mfma_f32_32x32x16_bf16 v[16:31], v[100:103], v[244:247], v[16:31]
  v_exp_f32 v3, v3
  v_exp_f32 v4, v4
  v_exp_f32 v5, v5
  v_mfma_f32_32x32x16_bf16 v[64:79], v[124:127], v[36:39], v[64:79]
  v_exp_f32 v6, v6
  v_exp_f32 v7, v7
  v_exp_f32 v8, v8
  v_smfmac_f32_16x16x64_bf16 v[84:87], v[88:91], v[32:39], v92
  ds_read_b128 v[104:107], v128 offset:28672
  ds_read_b128 v[108:111], v128 offset:30720
  v_cvt_pk_bf16_f32 v32, v0, v1
  v_cvt_pk_bf16_f32 v33, v2, v3
  v_cvt_pk_bf16_f32 v34, v4, v5
  v_cvt_pk_bf16_f32 v35, v6, v7
  v_exp_f32 v9, v9
  v_exp_f32 v10, v10
  s_waitcnt lgkmcnt(2)
  v_mfma_f32_32x32x16_bf16 v[48:63], v[112:115], v[32:35], v[48:63]
  ds_read_b128 v[120:123], v128 offset:29696
  ds_read_b128 v[124:127], v128 offset:31744
  v_exp_f32 v11, v11
  v_exp_f32 v12, v12
  v_exp_f32 v13, v13
  v_exp_f32 v14, v14
  v_exp_f32 v15, v15
  v_cvt_pk_bf16_f32 v36, v8, v9
  v_cvt_pk_bf16_f32 v37, v10, v11
  v_cvt_pk_bf16_f32 v38, v12, v13
  v_cvt_pk_bf16_f32 v39, v14, v15
  s_waitcnt lgkmcnt(2)
  v_mfma_f32_32x32x16_bf16 v[0:15], v[104:107], v[232:235], 0
  v_exp_f32 v16, v16
  v_exp_f32 v17, v17
  v_exp_f32 v18, v18
  v_mfma_f32_32x32x16_bf16 v[0:15], v[108:111], v[236:239], v[0:15]
  v_exp_f32 v19, v19
  v_exp_f32 v20, v20
  v_exp_f32 v21, v21
  v_mfma_f32_32x32x16_bf16 v[48:63], v[116:119], v[36:39], v[48:63]
  v_exp_f32 v22, v22
  v_exp_f32 v23, v23
  v_exp_f32 v24, v24
  v_smfmac_f32_16x16x64_bf16 v[80:83], v[88:91], v[32:39], v92
  v_cvt_pk_bf16_f32 v32, v16, v17
  v_cvt_pk_bf16_f32 v33, v18, v19
  v_cvt_pk_bf16_f32 v34, v20, v21
  v_cvt_pk_bf16_f32 v35, v22, v23
  v_exp_f32 v25, v25
  v_exp_f32 v26, v26
  v_mfma_f32_32x32x16_bf16 v[64:79], v[112:115], v[32:35], v[64:79]
  v_exp_f32 v27, v27
  v_exp_f32 v28, v28
  v_exp_f32 v29, v29
  v_exp_f32 v30, v30
  v_exp_f32 v31, v31
  v_cvt_pk_bf16_f32 v36, v24, v25
  v_cvt_pk_bf16_f32 v37, v26, v27
  v_cvt_pk_bf16_f32 v38, v28, v29
  v_cvt_pk_bf16_f32 v39, v30, v31
  s_waitcnt vmcnt(2)
  s_barrier
  v_mfma_f32_32x32x16_bf16 v[16:31], v[104:107], v[240:243], 0
  v_exp_f32 v0, v0
  v_exp_f32 v1, v1
  v_exp_f32 v2, v2
  v_mfma_f32_32x32x16_bf16 v[16:31], v[108:111], v[244:247], v[16:31]
  v_exp_f32 v3, v3
  v_exp_f32 v4, v4
  v_exp_f32 v5, v5
  v_mfma_f32_32x32x16_bf16 v[64:79], v[116:119], v[36:39], v[64:79]
  v_exp_f32 v6, v6
  v_exp_f32 v7, v7
  v_exp_f32 v8, v8
  v_smfmac_f32_16x16x64_bf16 v[84:87], v[88:91], v[32:39], v92
  ds_read_b128 v[96:99], v128 offset:0
  ds_read_b128 v[100:103], v128 offset:2048
  s_add_u32 m0, s73, 16384
  v_cvt_pk_bf16_f32 v32, v0, v1
  v_cvt_pk_bf16_f32 v33, v2, v3
  v_cvt_pk_bf16_f32 v34, v4, v5
  v_cvt_pk_bf16_f32 v35, v6, v7
  v_exp_f32 v9, v9
  v_exp_f32 v10, v10
  s_waitcnt lgkmcnt(2)
  v_mfma_f32_32x32x16_bf16 v[48:63], v[120:123], v[32:35], v[48:63]
  ds_read_b128 v[112:115], v128 offset:1024
  ds_read_b128 v[116:119], v128 offset:3072
  buffer_load_dwordx4 v178, s[24:27], s69 offen sc1 lds
  buffer_load_dwordx4 v182, s[24:27], s69 offen offset:1024 sc1 lds
  v_exp_f32 v11, v11
  v_exp_f32 v12, v12
  v_exp_f32 v13, v13
  v_exp_f32 v14, v14
  v_exp_f32 v15, v15
  v_cvt_pk_bf16_f32 v36, v8, v9
  v_cvt_pk_bf16_f32 v37, v10, v11
  v_cvt_pk_bf16_f32 v38, v12, v13
  v_cvt_pk_bf16_f32 v39, v14, v15
  s_waitcnt lgkmcnt(2)
  v_mfma_f32_32x32x16_bf16 v[0:15], v[96:99], v[232:235], 0
  v_exp_f32 v16, v16
  v_exp_f32 v17, v17
  v_exp_f32 v18, v18
  v_mfma_f32_32x32x16_bf16 v[0:15], v[100:103], v[236:239], v[0:15]
  v_exp_f32 v19, v19
  v_exp_f32 v20, v20
  v_exp_f32 v21, v21
  v_mfma_f32_32x32x16_bf16 v[48:63], v[124:127], v[36:39], v[48:63]
  v_exp_f32 v22, v22
  v_exp_f32 v23, v23
  v_exp_f32 v24, v24
  v_smfmac_f32_16x16x64_bf16 v[80:83], v[88:91], v[32:39], v92
  v_cvt_pk_bf16_f32 v32, v16, v17
  v_cvt_pk_bf16_f32 v33, v18, v19
  v_cvt_pk_bf16_f32 v34, v20, v21
  v_cvt_pk_bf16_f32 v35, v22, v23
  v_exp_f32 v25, v25
  v_exp_f32 v26, v26
  v_mfma_f32_32x32x16_bf16 v[64:79], v[120:123], v[32:35], v[64:79]
  s_add_u32 s64, s64, 1
  s_cmp_lt_u32 s64, 8
  v_exp_f32 v27, v27
  v_exp_f32 v28, v28
  v_exp_f32 v29, v29
  v_exp_f32 v30, v30
  v_exp_f32 v31, v31
  v_cvt_pk_bf16_f32 v36, v24, v25
  v_cvt_pk_bf16_f32 v37, v26, v27
  v_cvt_pk_bf16_f32 v38, v28, v29
  v_cvt_pk_bf16_f32 v39, v30, v31
  s_cbranch_scc1 L_att
  s_nop 0
  v_mfma_f32_32x32x16_bf16 v[64:79], v[124:127], v[36:39], v[64:79]
  v_smfmac_f32_16x16x64_bf16 v[84:87], v[88:91], v[32:39], v92
  s_add_u32 s28, s22, 8388608
  s_addc_u32 s29, s23, 0
  s_and_b32 s29, s29, 0xffff
  s_mov_b32 s30, 4472832
  s_mov_b32 s31, 0x20000
  s_lshl_b32 s56, s49, 3
  s_lshl_b32 s57, s51, 1
  s_add_u32 s56, s56, s57
  s_mul_i32 s73, s56, 69888
  s_lshl_b32 s57, s50, 11
  s_add_u32 s73, s73, s57
  s_add_u32 s74, s73, 69888
  s_lshr_b32 s56, s56, 2
  s_lshl_b32 s56, s56, 5
  s_add_u32 s56, s56, s50
  s_lshl_b32 s56, s56, 1
  s_and_b32 s57, s51, 1
  s_add_u32 s56, s56, s57
  s_lshl_b32 s56, s56, 3
  s_add_u32 s75, s56, 524288
  v_lshlrev_b32 v128, 4, v221
  v_add_f32 v80, v80, v81
  v_add_f32 v84, v84, v85
  s_mov_b32 s64, 0
L_att_store:
  v_rcp_f32 v134, v80
  v_rcp_f32 v135, v84
  s_nop 0
  v_mul_f32 v48, v48, v134
  v_mul_f32 v49, v49, v134
  v_mul_f32 v50, v50, v134
  v_mul_f32 v51, v51, v134
  v_mul_f32 v52, v52, v134
  v_mul_f32 v53, v53, v134
  v_mul_f32 v54, v54, v134
  v_mul_f32 v55, v55, v134
  v_mul_f32 v56, v56, v134
  v_mul_f32 v57, v57, v134
  v_mul_f32 v58, v58, v134
  v_mul_f32 v59, v59, v134
  v_mul_f32 v60, v60, v134
  v_mul_f32 v61, v61, v134
  v_mul_f32 v62, v62, v134
  v_mul_f32 v63, v63, v134
  v_cvt_pk_bf16_f32 v0, v48, v49
  v_cvt_pk_bf16_f32 v1, v50, v51
  v_cvt_pk_bf16_f32 v2, v52, v53
  v_cvt_pk_bf16_f32 v3, v54, v55
  v_cvt_pk_bf16_f32 v4, v56, v57
  v_cvt_pk_bf16_f32 v5, v58, v59
  v_cvt_pk_bf16_f32 v6, v60, v61
  v_cvt_pk_bf16_f32 v7, v62, v63
  buffer_store_dwordx4 v[0:3], v128, s[28:31], s73 offen offset:0 sc1
  buffer_store_dwordx4 v[4:7], v128, s[28:31], s73 offen offset:1024 sc1
  v_mul_f32 v64, v64, v135
  v_mul_f32 v65, v65, v135
  v_mul_f32 v66, v66, v135
  v_mul_f32 v67, v67, v135
  v_mul_f32 v68, v68, v135
  v_mul_f32 v69, v69, v135
  v_mul_f32 v70, v70, v135
  v_mul_f32 v71, v71, v135
  v_mul_f32 v72, v72, v135
  v_mul_f32 v73, v73, v135
  v_mul_f32 v74, v74, v135
  v_mul_f32 v75, v75, v135
  v_mul_f32 v76, v76, v135
  v_mul_f32 v77, v77, v135
  v_mul_f32 v78, v78, v135
  v_mul_f32 v79, v79, v135
  v_cvt_pk_bf16_f32 v8, v64, v65
  v_cvt_pk_bf16_f32 v9, v66, v67
  v_cvt_pk_bf16_f32 v10, v68, v69
  v_cvt_pk_bf16_f32 v11, v70, v71
  v_cvt_pk_bf16_f32 v12, v72, v73
  v_cvt_pk_bf16_f32 v13, v74, v75
  v_cvt_pk_bf16_f32 v14, v76, v77
  v_cvt_pk_bf16_f32 v15, v78, v79
  buffer_store_dwordx4 v[8:11], v128, s[28:31], s74 offen offset:0 sc1
  buffer_store_dwordx4 v[12:15], v128, s[28:31], s74 offen offset:1024 sc1
  s_cmp_lg_u32 s64, 0
  s_cbranch_scc1 L_att_done
  v_sub_f32 v134, v48, v48
  v_sub_f32 v135, v49, v49
  v_fma_f32 v134, v50, 0, v134
  v_fma_f32 v135, v51, 0, v135
  v_fma_f32 v134, v52, 0, v134
  v_fma_f32 v135, v53, 0, v135
  v_fma_f32 v134, v54, 0, v134
  v_fma_f32 v135, v55, 0, v135
  v_fma_f32 v134, v56, 0, v134
  v_fma_f32 v135, v57, 0, v135
  v_fma_f32 v134, v58, 0, v134
  v_fma_f32 v135, v59, 0, v135
  v_fma_f32 v134, v60, 0, v134
  v_fma_f32 v135, v61, 0, v135
  v_fma_f32 v134, v62, 0, v134
  v_fma_f32 v135, v63, 0, v135
  v_fma_f32 v134, v64, 0, v134
  v_fma_f32 v135, v65, 0, v135
  v_fma_f32 v134, v66, 0, v134
  v_fma_f32 v135, v67, 0, v135
  v_fma_f32 v134, v68, 0, v134
  v_fma_f32 v135, v69, 0, v135
  v_fma_f32 v134, v70, 0, v134
  v_fma_f32 v135, v71, 0, v135
  v_fma_f32 v134, v72, 0, v134
  v_fma_f32 v135, v73, 0, v135
  v_fma_f32 v134, v74, 0, v134
  v_fma_f32 v135, v75, 0, v135
  v_fma_f32 v134, v76, 0, v134
  v_fma_f32 v135, v77, 0, v135
  v_fma_f32 v134, v78, 0, v134
  v_fma_f32 v135, v79, 0, v135
  v_cmp_u_f32 vcc, v134, v135
  v_mov_b32 v134, 0x1f800000
  v_mov_b32 v135, 0x5f800000
  v_cmp_nge_f32 s[56:57], v80, v134
  s_or_b64 vcc, vcc, s[56:57]
  v_cmp_nle_f32 s[56:57], v80, v135
  s_or_b64 vcc, vcc, s[56:57]
  v_cmp_nge_f32 s[56:57], v84, v134
  s_or_b64 vcc, vcc, s[56:57]
  v_cmp_nle_f32 s[56:57], v84, v135
  s_or_b64 vcc, vcc, s[56:57]
  s_cmp_lg_u64 vcc, 0
  s_cbranch_scc1 L_exact
L_att_done:
  s_mov_b32 s36, s4
  s_and_b32 s37, s5, 0xffff
  s_mov_b32 s38, 4194304
  s_mov_b32 s39, 0x20000
  s_lshr_b32 s67, s51, 1
  s_lshl_b32 s56, s52, 2
  s_and_b32 s57, s51, 1
  s_lshl_b32 s57, s57, 1
  s_add_u32 s56, s56, s57
  s_add_u32 s58, s56, s67
  s_mul_i32 s70, s58, 69888
  s_lshl_b32 s76, s52, 9
  s_add_u32 s76, s76, 524288
  v_lshlrev_b32 v222, 4, v221
  v_lshlrev_b32 v228, 3, v221
  v_and_b32 v232, 3, v221
  v_bfe_u32 v233, v221, 2, 2
  v_lshl_add_u32 v232, v233, 3, v232
  v_bfe_u32 v233, v221, 4, 1
  v_lshl_add_u32 v232, v233, 2, v232
  v_lshrrev_b32 v233, 5, v221
  v_lshlrev_b32 v233, 4, v233
  v_lshl_add_u32 v223, v232, 11, v233
  s_lshl_b32 s56, s58, 16
  s_lshl_b32 s57, s53, 7
  s_add_u32 s56, s56, s57
  v_add_u32 v223, s56, v223
  v_lshrrev_b32 v232, 5, v221
  v_lshlrev_b32 v232, 3, v232
  v_bfe_u32 v234, v221, 2, 2
  v_add_u32 v232, v232, v234
  v_and_b32 v233, 1, v221
  v_lshlrev_b32 v233, 4, v233
  v_bfe_u32 v234, v221, 1, 1
  v_lshl_add_u32 v233, v234, 3, v233
  v_bfe_u32 v234, v221, 4, 1
  v_lshl_add_u32 v233, v234, 5, v233
  v_bfe_u32 v234, v221, 3, 1
  v_lshl_add_u32 v233, v234, 6, v233
  v_lshl_add_u32 v224, v232, 7, v233
  v_add_u32 v224, 32768, v224
  v_xor_b32 v225, 64, v224
  v_add_u32 v226, 65536, v224
  v_add_u32 v227, 65536, v225
  s_lshl_b32 s56, s51, 13
  v_add_u32 v231, s56, v222
  s_barrier
  s_waitcnt vmcnt(0) lgkmcnt(0)
  v_mov_b32 v134, s54
  v_mov_b32 v135, s55
  s_mov_b64 exec, 1
  buffer_store_dwordx2 v[134:135], off, s[44:47], s75 sc1
  s_mov_b64 exec, -1
  buffer_load_dwordx4 v[236:239], v223, s[36:39], 0 offen offset:0
  buffer_load_dwordx4 v[240:243], v223, s[36:39], 0 offen offset:32
  buffer_load_dwordx4 v[244:247], v223, s[36:39], 0 offen offset:64
  buffer_load_dwordx4 v[248:251], v223, s[36:39], 0 offen offset:96
  s_barrier
  s_barrier
  buffer_load_dwordx2 v[232:233], v228, s[44:47], s76 offen sc1
  s_barrier
  s_mov_b32 s64, 0
  s_mov_b32 s78, 0
L_o_look:
  s_waitcnt vmcnt(0)
  v_cmp_eq_u64 vcc, s[54:55], v[232:233]
  s_cmp_eq_u64 vcc, -1
  s_cbranch_scc1 L_o_go
  s_add_u32 s78, s78, 1
  s_cmp_gt_u32 s78, 262144
  s_cbranch_scc1 L_o_go
  s_not_b64 exec, vcc
  buffer_load_dwordx2 v[232:233], v228, s[44:47], s76 offen sc1
  s_mov_b64 exec, -1
  s_cmp_ge_u32 s64, 3
  s_cbranch_scc1 L_o_look
  s_barrier
  s_add_u32 s64, s64, 1
  s_branch L_o_look
L_o_go:
  s_add_u32 s69, s70, 57344
  buffer_load_dwordx4 v[96:99], v222, s[28:31], s69 offen offset:0 sc1
  v_lshlrev_b32 v64, 16, v236
  v_and_b32 v65, 0xffff0000, v236
  v_lshlrev_b32 v66, 16, v237
  v_and_b32 v67, 0xffff0000, v237
  buffer_load_dwordx4 v[100:103], v222, s[28:31], s69 offen offset:1024 sc1
  v_lshlrev_b32 v68, 16, v238
  v_and_b32 v69, 0xffff0000, v238
  v_lshlrev_b32 v70, 16, v239
  v_and_b32 v71, 0xffff0000, v239
  buffer_load_dwordx4 v[104:107], v222, s[28:31], s69 offen offset:2048 sc1
  v_lshlrev_b32 v72, 16, v240
  v_and_b32 v73, 0xffff0000, v240
  v_lshlrev_b32 v74, 16, v241
  v_and_b32 v75, 0xffff0000, v241
  buffer_load_dwordx4 v[108:111], v222, s[28:31], s69 offen offset:3072 sc1
  v_lshlrev_b32 v76, 16, v242
  v_and_b32 v77, 0xffff0000, v242
  v_lshlrev_b32 v78, 16, v243
  v_and_b32 v79, 0xffff0000, v243
  v_lshlrev_b32 v80, 16, v244
  v_and_b32 v81, 0xffff0000, v244
  v_lshlrev_b32 v82, 16, v245
  v_and_b32 v83, 0xffff0000, v245
  v_lshlrev_b32 v84, 16, v246
  v_and_b32 v85, 0xffff0000, v246
  v_lshlrev_b32 v86, 16, v247
  v_and_b32 v87, 0xffff0000, v247
  v_lshlrev_b32 v88, 16, v248
  v_and_b32 v89, 0xffff0000, v248
  v_lshlrev_b32 v90, 16, v249
  v_and_b32 v91, 0xffff0000, v249
  v_lshlrev_b32 v92, 16, v250
  v_and_b32 v93, 0xffff0000, v250
  v_lshlrev_b32 v94, 16, v251
  v_and_b32 v95, 0xffff0000, v251
  s_cmp_ge_u32 s64, 1
  s_cbranch_scc1 L_nb1
  s_barrier
L_nb1:
  ds_read_b64_tr_b16 v[200:201], v226 offset:49152
  ds_read_b64_tr_b16 v[202:203], v226 offset:49664
  ds_read_b64_tr_b16 v[204:205], v227 offset:49152
  ds_read_b64_tr_b16 v[206:207], v227 offset:49664
  s_waitcnt vmcnt(3)
  s_waitcnt lgkmcnt(0)
  v_mfma_f32_32x32x16_bf16 v[0:15], v[200:203], v[96:99], 0
  ds_read_b64_tr_b16 v[208:209], v226 offset:51200
  ds_read_b64_tr_b16 v[210:211], v226 offset:51712
  ds_read_b64_tr_b16 v[212:213], v227 offset:51200
  ds_read_b64_tr_b16 v[214:215], v227 offset:51712
  s_add_u32 s69, s70, 61440
  buffer_load_dwordx4 v[112:115], v222, s[28:31], s69 offen offset:0 sc1
  v_mfma_f32_32x32x16_bf16 v[16:31], v[204:207], v[96:99], 0
  buffer_load_dwordx4 v[116:119], v222, s[28:31], s69 offen offset:1024 sc1
  s_waitcnt vmcnt(4)
  s_waitcnt lgkmcnt(0)
  v_mfma_f32_32x32x16_bf16 v[0:15], v[208:211], v[100:103], v[0:15]
  ds_read_b64_tr_b16 v[200:201], v226 offset:53248
  ds_read_b64_tr_b16 v[202:203], v226 offset:53760
  ds_read_b64_tr_b16 v[204:205], v227 offset:53248
  ds_read_b64_tr_b16 v[206:207], v227 offset:53760
  buffer_load_dwordx4 v[120:123], v222, s[28:31], s69 offen offset:2048 sc1
  v_mfma_f32_32x32x16_bf16 v[16:31], v[212:215], v[100:103], v[16:31]
  buffer_load_dwordx4 v[124:127], v222, s[28:31], s69 offen offset:3072 sc1
  s_waitcnt vmcnt(5)
  s_waitcnt lgkmcnt(0)
  v_mfma_f32_32x32x16_bf16 v[0:15], v[200:203], v[104:107], v[0:15]
  ds_read_b64_tr_b16 v[208:209], v226 offset:55296
  ds_read_b64_tr_b16 v[210:211], v226 offset:55808
  ds_read_b64_tr_b16 v[212:213], v227 offset:55296
  ds_read_b64_tr_b16 v[214:215], v227 offset:55808
  s_add_u32 s69, s70, 0
  buffer_load_dwordx4 v[128:131], v222, s[28:31], s69 offen offset:0 sc1
  v_mfma_f32_32x32x16_bf16 v[16:31], v[204:207], v[104:107], v[16:31]
  buffer_load_dwordx4 v[132:135], v222, s[28:31], s69 offen offset:1024 sc1
  s_waitcnt vmcnt(6)
  s_waitcnt lgkmcnt(0)
  v_mfma_f32_32x32x16_bf16 v[0:15], v[208:211], v[108:111], v[0:15]
  ds_read_b64_tr_b16 v[200:201], v226 offset:57344
  ds_read_b64_tr_b16 v[202:203], v226 offset:57856
  ds_read_b64_tr_b16 v[204:205], v227 offset:57344
  ds_read_b64_tr_b16 v[206:207], v227 offset:57856
  buffer_load_dwordx4 v[136:139], v222, s[28:31], s69 offen offset:2048 sc1
  v_mfma_f32_32x32x16_bf16 v[16:31], v[212:215], v[108:111], v[16:31]
  buffer_load_dwordx4 v[140:143], v222, s[28:31], s69 offen offset:3072 sc1
  s_waitcnt vmcnt(7)
  s_waitcnt lgkmcnt(0)
  v_mfma_f32_32x32x16_bf16 v[0:15], v[200:203], v[112:115], v[0:15]
  ds_read_b64_tr_b16 v[208:209], v226 offset:59392
  ds_read_b64_tr_b16 v[210:211], v226 offset:59904
  ds_read_b64_tr_b16 v[212:213], v227 offset:59392
  ds_read_b64_tr_b16 v[214:215], v227 offset:59904
  s_add_u32 s69, s70, 4096
  buffer_load_dwordx4 v[96:99], v222, s[28:31], s69 offen offset:0 sc1
  v_mfma_f32_32x32x16_bf16 v[16:31], v[204:207], v[112:115], v[16:31]
  buffer_load_dwordx4 v[100:103], v222, s[28:31], s69 offen offset:1024 sc1
  s_cmp_ge_u32 s64, 2
  s_cbranch_scc1 L_nb2
  s_barrier
L_nb2:
  s_waitcnt vmcnt(8)
  s_waitcnt lgkmcnt(0)
  v_mfma_f32_32x32x16_bf16 v[0:15], v[208:211], v[116:119], v[0:15]
  ds_read_b64_tr_b16 v[200:201], v226 offset:61440
  ds_read_b64_tr_b16 v[202:203], v226 offset:61952
  ds_read_b64_tr_b16 v[204:205], v227 offset:61440
  ds_read_b64_tr_b16 v[206:207], v227 offset:61952
  buffer_load_dwordx4 v[104:107], v222, s[28:31], s69 offen offset:2048 sc1
  v_mfma_f32_32x32x16_bf16 v[16:31], v[212:215], v[116:119], v[16:31]
  buffer_load_dwordx4 v[108:111], v222, s[28:31], s69 offen offset:3072 sc1
  s_waitcnt vmcnt(9)
  s_waitcnt lgkmcnt(0)
  v_mfma_f32_32x32x16_bf16 v[0:15], v[200:203], v[120:123], v[0:15]
  ds_read_b64_tr_b16 v[208:209], v226 offset:63488
  ds_read_b64_tr_b16 v[210:211], v226 offset:64000
  ds_read_b64_tr_b16 v[212:213], v227 offset:63488
  ds_read_b64_tr_b16 v[214:215], v227 offset:64000
  s_add_u32 s69, s70, 8192
  buffer_load_dwordx4 v[112:115], v222, s[28:31], s69 offen offset:0 sc1
  v_mfma_f32_32x32x16_bf16 v[16:31], v[204:207], v[120:123], v[16:31]
  buffer_load_dwordx4 v[116:119], v222, s[28:31], s69 offen offset:1024 sc1
  s_waitcnt vmcnt(10)
  s_waitcnt lgkmcnt(0)
  v_mfma_f32_32x32x16_bf16 v[0:15], v[208:211], v[124:127], v[0:15]
  ds_read_b64_tr_b16 v[200:201], v224 offset:0
  ds_read_b64_tr_b16 v[202:203], v224 offset:512
  ds_read_b64_tr_b16 v[204:205], v225 offset:0
  ds_read_b64_tr_b16 v[206:207], v225 offset:512
  buffer_load_dwordx4 v[120:123], v222, s[28:31], s69 offen offset:2048 sc1
  v_mfma_f32_32x32x16_bf16 v[16:31], v[212:215], v[124:127], v[16:31]
  buffer_load_dwordx4 v[124:127], v222, s[28:31], s69 offen offset:3072 sc1
  s_waitcnt vmcnt(11)
  s_waitcnt lgkmcnt(0)
  v_mfma_f32_32x32x16_bf16 v[0:15], v[200:203], v[128:131], v[0:15]
  ds_read_b64_tr_b16 v[208:209], v224 offset:2048
  ds_read_b64_tr_b16 v[210:211], v224 offset:2560
  ds_read_b64_tr_b16 v[212:213], v225 offset:2048
  ds_read_b64_tr_b16 v[214:215], v225 offset:2560
  v_mfma_f32_32x32x16_bf16 v[16:31], v[204:207], v[128:131], v[16:31]
  s_add_u32 s69, s70, 12288
  buffer_load_dwordx4 v[128:131], v222, s[28:31], s69 offen offset:0 sc1
  s_waitcnt vmcnt(11)
  s_waitcnt lgkmcnt(0)
  v_mfma_f32_32x32x16_bf16 v[0:15], v[208:211], v[132:135], v[0:15]
  ds_read_b64_tr_b16 v[200:201], v224 offset:4096
  ds_read_b64_tr_b16 v[202:203], v224 offset:4608
  ds_read_b64_tr_b16 v[204:205], v225 offset:4096
  ds_read_b64_tr_b16 v[206:207], v225 offset:4608
  v_mfma_f32_32x32x16_bf16 v[16:31], v[212:215], v[132:135], v[16:31]
  buffer_load_dwordx4 v[132:135], v222, s[28:31], s69 offen offset:1024 sc1
  s_waitcnt vmcnt(11)
  s_waitcnt lgkmcnt(0)
  v_mfma_f32_32x32x16_bf16 v[0:15], v[200:203], v[136:139], v[0:15]
  ds_read_b64_tr_b16 v[208:209], v224 offset:6144
  ds_read_b64_tr_b16 v[210:211], v224 offset:6656
  ds_read_b64_tr_b16 v[212:213], v225 offset:6144
  ds_read_b64_tr_b16 v[214:215], v225 offset:6656
  v_mfma_f32_32x32x16_bf16 v[16:31], v[204:207], v[136:139], v[16:31]
  buffer_load_dwordx4 v[136:139], v222, s[28:31], s69 offen offset:2048 sc1
  s_cmp_ge_u32 s64, 3
  s_cbranch_scc1 L_nb3
  s_barrier
L_nb3:
  s_waitcnt vmcnt(11)
  s_waitcnt lgkmcnt(0)
  v_mfma_f32_32x32x16_bf16 v[0:15], v[208:211], v[140:143], v[0:15]
  ds_read_b64_tr_b16 v[200:201], v224 offset:8192
  ds_read_b64_tr_b16 v[202:203], v224 offset:8704
  ds_read_b64_tr_b16 v[204:205], v225 offset:8192
  ds_read_b64_tr_b16 v[206:207], v225 offset:8704
  v_mfma_f32_32x32x16_bf16 v[16:31], v[212:215], v[140:143], v[16:31]
  buffer_load_dwordx4 v[140:143], v222, s[28:31], s69 offen offset:3072 sc1
  s_waitcnt vmcnt(11)
  s_waitcnt lgkmcnt(0)
  v_mfma_f32_32x32x16_bf16 v[0:15], v[200:203], v[96:99], v[0:15]
  ds_read_b64_tr_b16 v[208:209], v224 offset:10240
  ds_read_b64_tr_b16 v[210:211], v224 offset:10752
  ds_read_b64_tr_b16 v[212:213], v225 offset:10240
  ds_read_b64_tr_b16 v[214:215], v225 offset:10752
  v_mfma_f32_32x32x16_bf16 v[16:31], v[204:207], v[96:99], v[16:31]
  s_add_u32 s69, s70, 16384
  buffer_load_dwordx4 v[96:99], v222, s[28:31], s69 offen offset:0 sc1
  s_waitcnt vmcnt(11)
  s_waitcnt lgkmcnt(0)
  v_mfma_f32_32x32x16_bf16 v[0:15], v[208:211], v[100:103], v[0:15]
  ds_read_b64_tr_b16 v[200:201], v224 offset:12288
  ds_read_b64_tr_b16 v[202:203], v224 offset:12800
  ds_read_b64_tr_b16 v[204:205], v225 offset:12288
  ds_read_b64_tr_b16 v[206:207], v225 offset:12800
  v_mfma_f32_32x32x16_bf16 v[16:31], v[212:215], v[100:103], v[16:31]
  buffer_load_dwordx4 v[100:103], v222, s[28:31], s69 offen offset:1024 sc1
  s_waitcnt vmcnt(11)
  s_waitcnt lgkmcnt(0)
  v_mfma_f32_32x32x16_bf16 v[0:15], v[200:203], v[104:107], v[0:15]
  ds_read_b64_tr_b16 v[208:209], v224 offset:14336
  ds_read_b64_tr_b16 v[210:211], v224 offset:14848
  ds_read_b64_tr_b16 v[212:213], v225 offset:14336
  ds_read_b64_tr_b16 v[214:215], v225 offset:14848
  v_mfma_f32_32x32x16_bf16 v[16:31], v[204:207], v[104:107], v[16:31]
  buffer_load_dwordx4 v[104:107], v222, s[28:31], s69 offen offset:2048 sc1
  s_waitcnt vmcnt(11)
  s_waitcnt lgkmcnt(0)
  v_mfma_f32_32x32x16_bf16 v[0:15], v[208:211], v[108:111], v[0:15]
  ds_read_b64_tr_b16 v[200:201], v224 offset:16384
  ds_read_b64_tr_b16 v[202:203], v224 offset:16896
  ds_read_b64_tr_b16 v[204:205], v225 offset:16384
  ds_read_b64_tr_b16 v[206:207], v225 offset:16896
  v_mfma_f32_32x32x16_bf16 v[16:31], v[212:215], v[108:111], v[16:31]
  buffer_load_dwordx4 v[108:111], v222, s[28:31], s69 offen offset:3072 sc1
  s_waitcnt vmcnt(11)
  s_waitcnt lgkmcnt(0)
  v_mfma_f32_32x32x16_bf16 v[0:15], v[200:203], v[112:115], v[0:15]
  ds_read_b64_tr_b16 v[208:209], v224 offset:18432
  ds_read_b64_tr_b16 v[210:211], v224 offset:18944
  ds_read_b64_tr_b16 v[212:213], v225 offset:18432
  ds_read_b64_tr_b16 v[214:215], v225 offset:18944
  v_mfma_f32_32x32x16_bf16 v[16:31], v[204:207], v[112:115], v[16:31]
  s_add_u32 s69, s70, 20480
  buffer_load_dwordx4 v[112:115], v222, s[28:31], s69 offen offset:0 sc1
  s_waitcnt vmcnt(11)
  s_waitcnt lgkmcnt(0)
  v_mfma_f32_32x32x16_bf16 v[0:15], v[208:211], v[116:119], v[0:15]
  ds_read_b64_tr_b16 v[200:201], v224 offset:20480
  ds_read_b64_tr_b16 v[202:203], v224 offset:20992
  ds_read_b64_tr_b16 v[204:205], v225 offset:20480
  ds_read_b64_tr_b16 v[206:207], v225 offset:20992
  v_mfma_f32_32x32x16_bf16 v[16:31], v[212:215], v[116:119], v[16:31]
  buffer_load_dwordx4 v[116:119], v222, s[28:31], s69 offen offset:1024 sc1
  s_waitcnt vmcnt(11)
  s_waitcnt lgkmcnt(0)
  v_mfma_f32_32x32x16_bf16 v[0:15], v[200:203], v[120:123], v[0:15]
  ds_read_b64_tr_b16 v[208:209], v224 offset:22528
  ds_read_b64_tr_b16 v[210:211], v224 offset:23040
  ds_read_b64_tr_b16 v[212:213], v225 offset:22528
  ds_read_b64_tr_b16 v[214:215], v225 offset:23040
  v_mfma_f32_32x32x16_bf16 v[16:31], v[204:207], v[120:123], v[16:31]
  buffer_load_dwordx4 v[120:123], v222, s[28:31], s69 offen offset:2048 sc1
  s_waitcnt vmcnt(11)
  s_waitcnt lgkmcnt(0)
  v_mfma_f32_32x32x16_bf16 v[0:15], v[208:211], v[124:127], v[0:15]
  ds_read_b64_tr_b16 v[200:201], v224 offset:24576
  ds_read_b64_tr_b16 v[202:203], v224 offset:25088
  ds_read_b64_tr_b16 v[204:205], v225 offset:24576
  ds_read_b64_tr_b16 v[206:207], v225 offset:25088
  v_mfma_f32_32x32x16_bf16 v[16:31], v[212:215], v[124:127], v[16:31]
  buffer_load_dwordx4 v[124:127], v222, s[28:31], s69 offen offset:3072 sc1
  s_waitcnt vmcnt(11)
  s_waitcnt lgkmcnt(0)
  v_mfma_f32_32x32x16_bf16 v[0:15], v[200:203], v[128:131], v[0:15]
  ds_read_b64_tr_b16 v[208:209], v224 offset:26624
  ds_read_b64_tr_b16 v[210:211], v224 offset:27136
  ds_read_b64_tr_b16 v[212:213], v225 offset:26624
  ds_read_b64_tr_b16 v[214:215], v225 offset:27136
  v_mfma_f32_32x32x16_bf16 v[16:31], v[204:207], v[128:131], v[16:31]
  s_add_u32 s69, s70, 24576
  buffer_load_dwordx4 v[128:131], v222, s[28:31], s69 offen offset:0 sc1
  s_waitcnt vmcnt(11)
  s_waitcnt lgkmcnt(0)
  v_mfma_f32_32x32x16_bf16 v[0:15], v[208:211], v[132:135], v[0:15]
  ds_read_b64_tr_b16 v[200:201], v224 offset:28672
  ds_read_b64_tr_b16 v[202:203], v224 offset:29184
  ds_read_b64_tr_b16 v[204:205], v225 offset:28672
  ds_read_b64_tr_b16 v[206:207], v225 offset:29184
  v_mfma_f32_32x32x16_bf16 v[16:31], v[212:215], v[132:135], v[16:31]
  buffer_load_dwordx4 v[132:135], v222, s[28:31], s69 offen offset:1024 sc1
  s_waitcnt vmcnt(11)
  s_waitcnt lgkmcnt(0)
  v_mfma_f32_32x32x16_bf16 v[0:15], v[200:203], v[136:139], v[0:15]
  ds_read_b64_tr_b16 v[208:209], v224 offset:30720
  ds_read_b64_tr_b16 v[210:211], v224 offset:31232
  ds_read_b64_tr_b16 v[212:213], v225 offset:30720
  ds_read_b64_tr_b16 v[214:215], v225 offset:31232
  v_mfma_f32_32x32x16_bf16 v[16:31], v[204:207], v[136:139], v[16:31]
  buffer_load_dwordx4 v[136:139], v222, s[28:31], s69 offen offset:2048 sc1
  s_waitcnt vmcnt(11)
  s_waitcnt lgkmcnt(0)
  v_mfma_f32_32x32x16_bf16 v[0:15], v[208:211], v[140:143], v[0:15]
  ds_read_b64_tr_b16 v[200:201], v224 offset:32768
  ds_read_b64_tr_b16 v[202:203], v224 offset:33280
  ds_read_b64_tr_b16 v[204:205], v225 offset:32768
  ds_read_b64_tr_b16 v[206:207], v225 offset:33280
  v_mfma_f32_32x32x16_bf16 v[16:31], v[212:215], v[140:143], v[16:31]
  buffer_load_dwordx4 v[140:143], v222, s[28:31], s69 offen offset:3072 sc1
  s_waitcnt vmcnt(11)
  s_waitcnt lgkmcnt(0)
  v_mfma_f32_32x32x16_bf16 v[0:15], v[200:203], v[96:99], v[0:15]
  ds_read_b64_tr_b16 v[208:209], v224 offset:34816
  ds_read_b64_tr_b16 v[210:211], v224 offset:35328
  ds_read_b64_tr_b16 v[212:213], v225 offset:34816
  ds_read_b64_tr_b16 v[214:215], v225 offset:35328
  v_mfma_f32_32x32x16_bf16 v[16:31], v[204:207], v[96:99], v[16:31]
  s_add_u32 s69, s70, 28672
  buffer_load_dwordx4 v[96:99], v222, s[28:31], s69 offen offset:0 sc1
  s_waitcnt vmcnt(11)
  s_waitcnt lgkmcnt(0)
  v_mfma_f32_32x32x16_bf16 v[0:15], v[208:211], v[100:103], v[0:15]
  ds_read_b64_tr_b16 v[200:201], v224 offset:36864
  ds_read_b64_tr_b16 v[202:203], v224 offset:37376
  ds_read_b64_tr_b16 v[204:205], v225 offset:36864
  ds_read_b64_tr_b16 v[206:207], v225 offset:37376
  v_mfma_f32_32x32x16_bf16 v[16:31], v[212:215], v[100:103], v[16:31]
  buffer_load_dwordx4 v[100:103], v222, s[28:31], s69 offen offset:1024 sc1
  s_waitcnt vmcnt(11)
  s_waitcnt lgkmcnt(0)
  v_mfma_f32_32x32x16_bf16 v[0:15], v[200:203], v[104:107], v[0:15]
  ds_read_b64_tr_b16 v[208:209], v224 offset:38912
  ds_read_b64_tr_b16 v[210:211], v224 offset:39424
  ds_read_b64_tr_b16 v[212:213], v225 offset:38912
  ds_read_b64_tr_b16 v[214:215], v225 offset:39424
  v_mfma_f32_32x32x16_bf16 v[16:31], v[204:207], v[104:107], v[16:31]
  buffer_load_dwordx4 v[104:107], v222, s[28:31], s69 offen offset:2048 sc1
  s_waitcnt vmcnt(11)
  s_waitcnt lgkmcnt(0)
  v_mfma_f32_32x32x16_bf16 v[0:15], v[208:211], v[108:111], v[0:15]
  ds_read_b64_tr_b16 v[200:201], v224 offset:40960
  ds_read_b64_tr_b16 v[202:203], v224 offset:41472
  ds_read_b64_tr_b16 v[204:205], v225 offset:40960
  ds_read_b64_tr_b16 v[206:207], v225 offset:41472
  v_mfma_f32_32x32x16_bf16 v[16:31], v[212:215], v[108:111], v[16:31]
  buffer_load_dwordx4 v[108:111], v222, s[28:31], s69 offen offset:3072 sc1
  s_waitcnt vmcnt(11)
  s_waitcnt lgkmcnt(0)
  v_mfma_f32_32x32x16_bf16 v[0:15], v[200:203], v[112:115], v[0:15]
  ds_read_b64_tr_b16 v[208:209], v224 offset:43008
  ds_read_b64_tr_b16 v[210:211], v224 offset:43520
  ds_read_b64_tr_b16 v[212:213], v225 offset:43008
  ds_read_b64_tr_b16 v[214:215], v225 offset:43520
  v_mfma_f32_32x32x16_bf16 v[16:31], v[204:207], v[112:115], v[16:31]
  s_add_u32 s69, s70, 32768
  buffer_load_dwordx4 v[112:115], v222, s[28:31], s69 offen offset:0 sc1
  s_waitcnt vmcnt(11)
  s_waitcnt lgkmcnt(0)
  v_mfma_f32_32x32x16_bf16 v[0:15], v[208:211], v[116:119], v[0:15]
  ds_read_b64_tr_b16 v[200:201], v224 offset:45056
  ds_read_b64_tr_b16 v[202:203], v224 offset:45568
  ds_read_b64_tr_b16 v[204:205], v225 offset:45056
  ds_read_b64_tr_b16 v[206:207], v225 offset:45568
  v_mfma_f32_32x32x16_bf16 v[16:31], v[212:215], v[116:119], v[16:31]
  buffer_load_dwordx4 v[116:119], v222, s[28:31], s69 offen offset:1024 sc1
  s_waitcnt vmcnt(11)
  s_waitcnt lgkmcnt(0)
  v_mfma_f32_32x32x16_bf16 v[0:15], v[200:203], v[120:123], v[0:15]
  ds_read_b64_tr_b16 v[208:209], v224 offset:47104
  ds_read_b64_tr_b16 v[210:211], v224 offset:47616
  ds_read_b64_tr_b16 v[212:213], v225 offset:47104
  ds_read_b64_tr_b16 v[214:215], v225 offset:47616
  v_mfma_f32_32x32x16_bf16 v[16:31], v[204:207], v[120:123], v[16:31]
  buffer_load_dwordx4 v[120:123], v222, s[28:31], s69 offen offset:2048 sc1
  s_waitcnt vmcnt(11)
  s_waitcnt lgkmcnt(0)
  v_mfma_f32_32x32x16_bf16 v[0:15], v[208:211], v[124:127], v[0:15]
  ds_read_b64_tr_b16 v[200:201], v224 offset:49152
  ds_read_b64_tr_b16 v[202:203], v224 offset:49664
  ds_read_b64_tr_b16 v[204:205], v225 offset:49152
  ds_read_b64_tr_b16 v[206:207], v225 offset:49664
  v_mfma_f32_32x32x16_bf16 v[16:31], v[212:215], v[124:127], v[16:31]
  buffer_load_dwordx4 v[124:127], v222, s[28:31], s69 offen offset:3072 sc1
  s_waitcnt vmcnt(11)
  s_waitcnt lgkmcnt(0)
  v_mfma_f32_32x32x16_bf16 v[0:15], v[200:203], v[128:131], v[0:15]
  ds_read_b64_tr_b16 v[208:209], v224 offset:51200
  ds_read_b64_tr_b16 v[210:211], v224 offset:51712
  ds_read_b64_tr_b16 v[212:213], v225 offset:51200
  ds_read_b64_tr_b16 v[214:215], v225 offset:51712
  v_mfma_f32_32x32x16_bf16 v[16:31], v[204:207], v[128:131], v[16:31]
  s_add_u32 s69, s70, 36864
  buffer_load_dwordx4 v[128:131], v222, s[28:31], s69 offen offset:0 sc1
  s_waitcnt vmcnt(11)
  s_waitcnt lgkmcnt(0)
  v_mfma_f32_32x32x16_bf16 v[0:15], v[208:211], v[132:135], v[0:15]
  ds_read_b64_tr_b16 v[200:201], v224 offset:53248
  ds_read_b64_tr_b16 v[202:203], v224 offset:53760
  ds_read_b64_tr_b16 v[204:205], v225 offset:53248
  ds_read_b64_tr_b16 v[206:207], v225 offset:53760
  v_mfma_f32_32x32x16_bf16 v[16:31], v[212:215], v[132:135], v[16:31]
  buffer_load_dwordx4 v[132:135], v222, s[28:31], s69 offen offset:1024 sc1
  s_waitcnt vmcnt(11)
  s_waitcnt lgkmcnt(0)
  v_mfma_f32_32x32x16_bf16 v[0:15], v[200:203], v[136:139], v[0:15]
  ds_read_b64_tr_b16 v[208:209], v224 offset:55296
  ds_read_b64_tr_b16 v[210:211], v224 offset:55808
  ds_read_b64_tr_b16 v[212:213], v225 offset:55296
  ds_read_b64_tr_b16 v[214:215], v225 offset:55808
  v_mfma_f32_32x32x16_bf16 v[16:31], v[204:207], v[136:139], v[16:31]
  buffer_load_dwordx4 v[136:139], v222, s[28:31], s69 offen offset:2048 sc1
  s_waitcnt vmcnt(11)
  s_waitcnt lgkmcnt(0)
  v_mfma_f32_32x32x16_bf16 v[0:15], v[208:211], v[140:143], v[0:15]
  ds_read_b64_tr_b16 v[200:201], v224 offset:57344
  ds_read_b64_tr_b16 v[202:203], v224 offset:57856
  ds_read_b64_tr_b16 v[204:205], v225 offset:57344
  ds_read_b64_tr_b16 v[206:207], v225 offset:57856
  v_mfma_f32_32x32x16_bf16 v[16:31], v[212:215], v[140:143], v[16:31]
  buffer_load_dwordx4 v[140:143], v222, s[28:31], s69 offen offset:3072 sc1
  s_waitcnt vmcnt(11)
  s_waitcnt lgkmcnt(0)
  v_mfma_f32_32x32x16_bf16 v[0:15], v[200:203], v[96:99], v[0:15]
  ds_read_b64_tr_b16 v[208:209], v224 offset:59392
  ds_read_b64_tr_b16 v[210:211], v224 offset:59904
  ds_read_b64_tr_b16 v[212:213], v225 offset:59392
  ds_read_b64_tr_b16 v[214:215], v225 offset:59904
  v_mfma_f32_32x32x16_bf16 v[16:31], v[204:207], v[96:99], v[16:31]
  s_add_u32 s69, s70, 40960
  buffer_load_dwordx4 v[96:99], v222, s[28:31], s69 offen offset:0 sc1
  s_waitcnt vmcnt(11)
  s_waitcnt lgkmcnt(0)
  v_mfma_f32_32x32x16_bf16 v[0:15], v[208:211], v[100:103], v[0:15]
  ds_read_b64_tr_b16 v[200:201], v224 offset:61440
  ds_read_b64_tr_b16 v[202:203], v224 offset:61952
  ds_read_b64_tr_b16 v[204:205], v225 offset:61440
  ds_read_b64_tr_b16 v[206:207], v225 offset:61952
  v_mfma_f32_32x32x16_bf16 v[16:31], v[212:215], v[100:103], v[16:31]
  buffer_load_dwordx4 v[100:103], v222, s[28:31], s69 offen offset:1024 sc1
  s_waitcnt vmcnt(11)
  s_waitcnt lgkmcnt(0)
  v_mfma_f32_32x32x16_bf16 v[0:15], v[200:203], v[104:107], v[0:15]
  ds_read_b64_tr_b16 v[208:209], v224 offset:63488
  ds_read_b64_tr_b16 v[210:211], v224 offset:64000
  ds_read_b64_tr_b16 v[212:213], v225 offset:63488
  ds_read_b64_tr_b16 v[214:215], v225 offset:64000
  v_mfma_f32_32x32x16_bf16 v[16:31], v[204:207], v[104:107], v[16:31]
  buffer_load_dwordx4 v[104:107], v222, s[28:31], s69 offen offset:2048 sc1
  s_waitcnt vmcnt(11)
  s_waitcnt lgkmcnt(0)
  v_mfma_f32_32x32x16_bf16 v[0:15], v[208:211], v[108:111], v[0:15]
  ds_read_b64_tr_b16 v[200:201], v226 offset:0
  ds_read_b64_tr_b16 v[202:203], v226 offset:512
  ds_read_b64_tr_b16 v[204:205], v227 offset:0
  ds_read_b64_tr_b16 v[206:207], v227 offset:512
  v_mfma_f32_32x32x16_bf16 v[16:31], v[212:215], v[108:111], v[16:31]
  buffer_load_dwordx4 v[108:111], v222, s[28:31], s69 offen offset:3072 sc1
  s_waitcnt vmcnt(11)
  s_waitcnt lgkmcnt(0)
  v_mfma_f32_32x32x16_bf16 v[0:15], v[200:203], v[112:115], v[0:15]
  ds_read_b64_tr_b16 v[208:209], v226 offset:2048
  ds_read_b64_tr_b16 v[210:211], v226 offset:2560
  ds_read_b64_tr_b16 v[212:213], v227 offset:2048
  ds_read_b64_tr_b16 v[214:215], v227 offset:2560
  v_mfma_f32_32x32x16_bf16 v[16:31], v[204:207], v[112:115], v[16:31]
  s_add_u32 s69, s70, 45056
  buffer_load_dwordx4 v[112:115], v222, s[28:31], s69 offen offset:0 sc1
  s_waitcnt vmcnt(11)
  s_waitcnt lgkmcnt(0)
  v_mfma_f32_32x32x16_bf16 v[0:15], v[208:211], v[116:119], v[0:15]
  ds_read_b64_tr_b16 v[200:201], v226 offset:4096
  ds_read_b64_tr_b16 v[202:203], v226 offset:4608
  ds_read_b64_tr_b16 v[204:205], v227 offset:4096
  ds_read_b64_tr_b16 v[206:207], v227 offset:4608
  v_mfma_f32_32x32x16_bf16 v[16:31], v[212:215], v[116:119], v[16:31]
  buffer_load_dwordx4 v[116:119], v222, s[28:31], s69 offen offset:1024 sc1
  s_waitcnt vmcnt(11)
  s_waitcnt lgkmcnt(0)
  v_mfma_f32_32x32x16_bf16 v[0:15], v[200:203], v[120:123], v[0:15]
  ds_read_b64_tr_b16 v[208:209], v226 offset:6144
  ds_read_b64_tr_b16 v[210:211], v226 offset:6656
  ds_read_b64_tr_b16 v[212:213], v227 offset:6144
  ds_read_b64_tr_b16 v[214:215], v227 offset:6656
  v_mfma_f32_32x32x16_bf16 v[16:31], v[204:207], v[120:123], v[16:31]
  buffer_load_dwordx4 v[120:123], v222, s[28:31], s69 offen offset:2048 sc1
  s_waitcnt vmcnt(11)
  s_waitcnt lgkmcnt(0)
  v_mfma_f32_32x32x16_bf16 v[0:15], v[208:211], v[124:127], v[0:15]
  ds_read_b64_tr_b16 v[200:201], v226 offset:8192
  ds_read_b64_tr_b16 v[202:203], v226 offset:8704
  ds_read_b64_tr_b16 v[204:205], v227 offset:8192
  ds_read_b64_tr_b16 v[206:207], v227 offset:8704
  v_mfma_f32_32x32x16_bf16 v[16:31], v[212:215], v[124:127], v[16:31]
  buffer_load_dwordx4 v[124:127], v222, s[28:31], s69 offen offset:3072 sc1
  s_waitcnt vmcnt(11)
  s_waitcnt lgkmcnt(0)
  v_mfma_f32_32x32x16_bf16 v[0:15], v[200:203], v[128:131], v[0:15]
  ds_read_b64_tr_b16 v[208:209], v226 offset:10240
  ds_read_b64_tr_b16 v[210:211], v226 offset:10752
  ds_read_b64_tr_b16 v[212:213], v227 offset:10240
  ds_read_b64_tr_b16 v[214:215], v227 offset:10752
  v_mfma_f32_32x32x16_bf16 v[16:31], v[204:207], v[128:131], v[16:31]
  s_add_u32 s69, s70, 49152
  buffer_load_dwordx4 v[128:131], v222, s[28:31], s69 offen offset:0 sc1
  s_waitcnt vmcnt(11)
  s_waitcnt lgkmcnt(0)
  v_mfma_f32_32x32x16_bf16 v[0:15], v[208:211], v[132:135], v[0:15]
  ds_read_b64_tr_b16 v[200:201], v226 offset:12288
  ds_read_b64_tr_b16 v[202:203], v226 offset:12800
  ds_read_b64_tr_b16 v[204:205], v227 offset:12288
  ds_read_b64_tr_b16 v[206:207], v227 offset:12800
  v_mfma_f32_32x32x16_bf16 v[16:31], v[212:215], v[132:135], v[16:31]
  buffer_load_dwordx4 v[132:135], v222, s[28:31], s69 offen offset:1024 sc1
  s_waitcnt vmcnt(11)
  s_waitcnt lgkmcnt(0)
  v_mfma_f32_32x32x16_bf16 v[0:15], v[200:203], v[136:139], v[0:15]
  ds_read_b64_tr_b16 v[208:209], v226 offset:14336
  ds_read_b64_tr_b16 v[210:211], v226 offset:14848
  ds_read_b64_tr_b16 v[212:213], v227 offset:14336
  ds_read_b64_tr_b16 v[214:215], v227 offset:14848
  v_mfma_f32_32x32x16_bf16 v[16:31], v[204:207], v[136:139], v[16:31]
  buffer_load_dwordx4 v[136:139], v222, s[28:31], s69 offen offset:2048 sc1
  s_waitcnt vmcnt(11)
  s_waitcnt lgkmcnt(0)
  v_mfma_f32_32x32x16_bf16 v[0:15], v[208:211], v[140:143], v[0:15]
  ds_read_b64_tr_b16 v[200:201], v226 offset:16384
  ds_read_b64_tr_b16 v[202:203], v226 offset:16896
  ds_read_b64_tr_b16 v[204:205], v227 offset:16384
  ds_read_b64_tr_b16 v[206:207], v227 offset:16896
  v_mfma_f32_32x32x16_bf16 v[16:31], v[212:215], v[140:143], v[16:31]
  buffer_load_dwordx4 v[140:143], v222, s[28:31], s69 offen offset:3072 sc1
  s_waitcnt vmcnt(11)
  s_waitcnt lgkmcnt(0)
  v_mfma_f32_32x32x16_bf16 v[0:15], v[200:203], v[96:99], v[0:15]
  ds_read_b64_tr_b16 v[208:209], v226 offset:18432
  ds_read_b64_tr_b16 v[210:211], v226 offset:18944
  ds_read_b64_tr_b16 v[212:213], v227 offset:18432
  ds_read_b64_tr_b16 v[214:215], v227 offset:18944
  v_mfma_f32_32x32x16_bf16 v[16:31], v[204:207], v[96:99], v[16:31]
  s_add_u32 s69, s70, 53248
  buffer_load_dwordx4 v[96:99], v222, s[28:31], s69 offen offset:0 sc1
  s_waitcnt vmcnt(11)
  s_waitcnt lgkmcnt(0)
  v_mfma_f32_32x32x16_bf16 v[0:15], v[208:211], v[100:103], v[0:15]
  ds_read_b64_tr_b16 v[200:201], v226 offset:20480
  ds_read_b64_tr_b16 v[202:203], v226 offset:20992
  ds_read_b64_tr_b16 v[204:205], v227 offset:20480
  ds_read_b64_tr_b16 v[206:207], v227 offset:20992
  v_mfma_f32_32x32x16_bf16 v[16:31], v[212:215], v[100:103], v[16:31]
  buffer_load_dwordx4 v[100:103], v222, s[28:31], s69 offen offset:1024 sc1
  s_waitcnt vmcnt(11)
  s_waitcnt lgkmcnt(0)
  v_mfma_f32_32x32x16_bf16 v[0:15], v[200:203], v[104:107], v[0:15]
  ds_read_b64_tr_b16 v[208:209], v226 offset:22528
  ds_read_b64_tr_b16 v[210:211], v226 offset:23040
  ds_read_b64_tr_b16 v[212:213], v227 offset:22528
  ds_read_b64_tr_b16 v[214:215], v227 offset:23040
  v_mfma_f32_32x32x16_bf16 v[16:31], v[204:207], v[104:107], v[16:31]
  buffer_load_dwordx4 v[104:107], v222, s[28:31], s69 offen offset:2048 sc1
  s_waitcnt vmcnt(11)
  s_waitcnt lgkmcnt(0)
  v_mfma_f32_32x32x16_bf16 v[0:15], v[208:211], v[108:111], v[0:15]
  ds_read_b64_tr_b16 v[200:201], v226 offset:24576
  ds_read_b64_tr_b16 v[202:203], v226 offset:25088
  ds_read_b64_tr_b16 v[204:205], v227 offset:24576
  ds_read_b64_tr_b16 v[206:207], v227 offset:25088
  v_mfma_f32_32x32x16_bf16 v[16:31], v[212:215], v[108:111], v[16:31]
  buffer_load_dwordx4 v[108:111], v222, s[28:31], s69 offen offset:3072 sc1
  s_waitcnt vmcnt(11)
  s_waitcnt lgkmcnt(0)
  v_mfma_f32_32x32x16_bf16 v[0:15], v[200:203], v[112:115], v[0:15]
  ds_read_b64_tr_b16 v[208:209], v226 offset:26624
  ds_read_b64_tr_b16 v[210:211], v226 offset:27136
  ds_read_b64_tr_b16 v[212:213], v227 offset:26624
  ds_read_b64_tr_b16 v[214:215], v227 offset:27136
  v_mfma_f32_32x32x16_bf16 v[16:31], v[204:207], v[112:115], v[16:31]
  s_waitcnt vmcnt(10)
  s_waitcnt lgkmcnt(0)
  v_mfma_f32_32x32x16_bf16 v[0:15], v[208:211], v[116:119], v[0:15]
  ds_read_b64_tr_b16 v[200:201], v226 offset:28672
  ds_read_b64_tr_b16 v[202:203], v226 offset:29184
  ds_read_b64_tr_b16 v[204:205], v227 offset:28672
  ds_read_b64_tr_b16 v[206:207], v227 offset:29184
  v_mfma_f32_32x32x16_bf16 v[16:31], v[212:215], v[116:119], v[16:31]
  s_waitcnt vmcnt(9)
  s_waitcnt lgkmcnt(0)
  v_mfma_f32_32x32x16_bf16 v[0:15], v[200:203], v[120:123], v[0:15]
  ds_read_b64_tr_b16 v[208:209], v226 offset:30720
  ds_read_b64_tr_b16 v[210:211], v226 offset:31232
  ds_read_b64_tr_b16 v[212:213], v227 offset:30720
  ds_read_b64_tr_b16 v[214:215], v227 offset:31232
  v_mfma_f32_32x32x16_bf16 v[16:31], v[204:207], v[120:123], v[16:31]
  s_barrier
  s_waitcnt vmcnt(8)
  s_waitcnt lgkmcnt(0)
  v_mfma_f32_32x32x16_bf16 v[0:15], v[208:211], v[124:127], v[0:15]
  ds_read_b64_tr_b16 v[200:201], v226 offset:32768
  ds_read_b64_tr_b16 v[202:203], v226 offset:33280
  ds_read_b64_tr_b16 v[204:205], v227 offset:32768
  ds_read_b64_tr_b16 v[206:207], v227 offset:33280
  v_mfma_f32_32x32x16_bf16 v[16:31], v[212:215], v[124:127], v[16:31]
  s_waitcnt vmcnt(7)
  s_waitcnt lgkmcnt(0)
  v_mfma_f32_32x32x16_bf16 v[0:15], v[200:203], v[128:131], v[0:15]
  ds_read_b64_tr_b16 v[208:209], v226 offset:34816
  ds_read_b64_tr_b16 v[210:211], v226 offset:35328
  ds_read_b64_tr_b16 v[212:213], v227 offset:34816
  ds_read_b64_tr_b16 v[214:215], v227 offset:35328
  v_mfma_f32_32x32x16_bf16 v[16:31], v[204:207], v[128:131], v[16:31]
  s_waitcnt vmcnt(6)
  s_waitcnt lgkmcnt(0)
  v_mfma_f32_32x32x16_bf16 v[0:15], v[208:211], v[132:135], v[0:15]
  ds_read_b64_tr_b16 v[200:201], v226 offset:36864
  ds_read_b64_tr_b16 v[202:203], v226 offset:37376
  ds_read_b64_tr_b16 v[204:205], v227 offset:36864
  ds_read_b64_tr_b16 v[206:207], v227 offset:37376
  v_mfma_f32_32x32x16_bf16 v[16:31], v[212:215], v[132:135], v[16:31]
  s_waitcnt vmcnt(5)
  s_waitcnt lgkmcnt(0)
  v_mfma_f32_32x32x16_bf16 v[0:15], v[200:203], v[136:139], v[0:15]
  ds_read_b64_tr_b16 v[208:209], v226 offset:38912
  ds_read_b64_tr_b16 v[210:211], v226 offset:39424
  ds_read_b64_tr_b16 v[212:213], v227 offset:38912
  ds_read_b64_tr_b16 v[214:215], v227 offset:39424
  v_mfma_f32_32x32x16_bf16 v[16:31], v[204:207], v[136:139], v[16:31]
  s_waitcnt vmcnt(4)
  s_waitcnt lgkmcnt(0)
  v_mfma_f32_32x32x16_bf16 v[0:15], v[208:211], v[140:143], v[0:15]
  ds_read_b64_tr_b16 v[200:201], v226 offset:40960
  ds_read_b64_tr_b16 v[202:203], v226 offset:41472
  ds_read_b64_tr_b16 v[204:205], v227 offset:40960
  ds_read_b64_tr_b16 v[206:207], v227 offset:41472
  v_mfma_f32_32x32x16_bf16 v[16:31], v[212:215], v[140:143], v[16:31]
  s_barrier
  s_waitcnt vmcnt(3)
  s_waitcnt lgkmcnt(0)
  v_mfma_f32_32x32x16_bf16 v[0:15], v[200:203], v[96:99], v[0:15]
  ds_read_b64_tr_b16 v[208:209], v226 offset:43008
  ds_read_b64_tr_b16 v[210:211], v226 offset:43520
  ds_read_b64_tr_b16 v[212:213], v227 offset:43008
  ds_read_b64_tr_b16 v[214:215], v227 offset:43520
  v_mfma_f32_32x32x16_bf16 v[16:31], v[204:207], v[96:99], v[16:31]
  ds_read_b128 v[32:35], v231 offset:0
  ds_read_b128 v[36:39], v231 offset:1024
  s_waitcnt vmcnt(2)
  s_waitcnt lgkmcnt(0)
  v_mfma_f32_32x32x16_bf16 v[0:15], v[208:211], v[100:103], v[0:15]
  ds_read_b64_tr_b16 v[200:201], v226 offset:45056
  ds_read_b64_tr_b16 v[202:203], v226 offset:45568
  ds_read_b64_tr_b16 v[204:205], v227 offset:45056
  ds_read_b64_tr_b16 v[206:207], v227 offset:45568
  v_mfma_f32_32x32x16_bf16 v[16:31], v[212:215], v[100:103], v[16:31]
  ds_read_b128 v[40:43], v231 offset:2048
  ds_read_b128 v[44:47], v231 offset:3072
  s_waitcnt vmcnt(1)
  s_waitcnt lgkmcnt(0)
  v_mfma_f32_32x32x16_bf16 v[0:15], v[200:203], v[104:107], v[0:15]
  ds_read_b64_tr_b16 v[208:209], v226 offset:47104
  ds_read_b64_tr_b16 v[210:211], v226 offset:47616
  ds_read_b64_tr_b16 v[212:213], v227 offset:47104
  ds_read_b64_tr_b16 v[214:215], v227 offset:47616
  v_mfma_f32_32x32x16_bf16 v[16:31], v[204:207], v[104:107], v[16:31]
  ds_read_b128 v[48:51], v231 offset:4096
  ds_read_b128 v[52:55], v231 offset:5120
  s_waitcnt vmcnt(0)
  s_waitcnt lgkmcnt(0)
  v_mfma_f32_32x32x16_bf16 v[0:15], v[208:211], v[108:111], v[0:15]
  v_mfma_f32_32x32x16_bf16 v[16:31], v[212:215], v[108:111], v[16:31]
  ds_read_b128 v[56:59], v231 offset:6144
  ds_read_b128 v[60:63], v231 offset:7168
  s_mov_b32 s28, s18
  s_and_b32 s29, s19, 0xffff
  s_mov_b32 s30, 4194304
  s_mov_b32 s31, 0x20000
  s_nop 6
  s_waitcnt lgkmcnt(0)
  v_fmac_f32 v64, v0, v32
  v_fmac_f32 v65, v1, v33
  v_fmac_f32 v66, v2, v34
  v_fmac_f32 v67, v3, v35
  v_fmac_f32 v68, v4, v36
  v_fmac_f32 v69, v5, v37
  v_fmac_f32 v70, v6, v38
  v_fmac_f32 v71, v7, v39
  v_cvt_pk_bf16_f32 v236, v64, v65
  v_cvt_pk_bf16_f32 v237, v66, v67
  v_cvt_pk_bf16_f32 v238, v68, v69
  v_cvt_pk_bf16_f32 v239, v70, v71
  buffer_store_dwordx4 v[236:239], v223, s[28:31], 0 offen offset:0 sc1
  v_fmac_f32 v72, v8, v40
  v_fmac_f32 v73, v9, v41
  v_fmac_f32 v74, v10, v42
  v_fmac_f32 v75, v11, v43
  v_fmac_f32 v76, v12, v44
  v_fmac_f32 v77, v13, v45
  v_fmac_f32 v78, v14, v46
  v_fmac_f32 v79, v15, v47
  v_cvt_pk_bf16_f32 v240, v72, v73
  v_cvt_pk_bf16_f32 v241, v74, v75
  v_cvt_pk_bf16_f32 v242, v76, v77
  v_cvt_pk_bf16_f32 v243, v78, v79
  buffer_store_dwordx4 v[240:243], v223, s[28:31], 0 offen offset:32 sc1
  v_fmac_f32 v80, v16, v48
  v_fmac_f32 v81, v17, v49
  v_fmac_f32 v82, v18, v50
  v_fmac_f32 v83, v19, v51
  v_fmac_f32 v84, v20, v52
  v_fmac_f32 v85, v21, v53
  v_fmac_f32 v86, v22, v54
  v_fmac_f32 v87, v23, v55
  v_cvt_pk_bf16_f32 v244, v80, v81
  v_cvt_pk_bf16_f32 v245, v82, v83
  v_cvt_pk_bf16_f32 v246, v84, v85
  v_cvt_pk_bf16_f32 v247, v86, v87
  buffer_store_dwordx4 v[244:247], v223, s[28:31], 0 offen offset:64 sc1
  v_fmac_f32 v88, v24, v56
  v_fmac_f32 v89, v25, v57
  v_fmac_f32 v90, v26, v58
  v_fmac_f32 v91, v27, v59
  v_fmac_f32 v92, v28, v60
  v_fmac_f32 v93, v29, v61
  v_fmac_f32 v94, v30, v62
  v_fmac_f32 v95, v31, v63
  v_cvt_pk_bf16_f32 v248, v88, v89
  v_cvt_pk_bf16_f32 v249, v90, v91
  v_cvt_pk_bf16_f32 v250, v92, v93
  v_cvt_pk_bf16_f32 v251, v94, v95
  buffer_store_dwordx4 v[248:251], v223, s[28:31], 0 offen offset:96 sc1
  s_endpgm
L_att_early0:
  buffer_load_dwordx2 v[134:135], v130, s[44:47], s76 offen sc1
  s_mov_b32 s26, 0
  s_add_u32 s73, s73, 196608
  s_branch L_att_early0_ret
L_att_early1:
  s_mov_b32 s26, 8388608
  s_sub_u32 s73, s73, 196608
  s_waitcnt vmcnt(2)
  v_cmp_eq_u64 vcc, s[54:55], v[134:135]
  s_cmp_eq_u64 vcc, -1
  s_cbranch_scc1 L_kv_ok
  s_mov_b32 s78, 0
  s_mov_b64 vcc, 0
L_pollkv:
  s_not_b64 exec, vcc
  buffer_load_dwordx2 v[134:135], v130, s[44:47], s76 offen sc1
  s_mov_b64 exec, -1
  s_add_u32 s78, s78, 1
  s_cmp_gt_u32 s78, 262144
  s_cbranch_scc1 L_pollkv_done
  s_waitcnt vmcnt(0)
  v_cmp_eq_u64 vcc, s[54:55], v[134:135]
  s_cmp_eq_u64 vcc, -1
  s_cbranch_scc0 L_pollkv
L_pollkv_done:
L_kv_ok:
  v_mov_b32 v134, s54
  v_mov_b32 v135, s55
  s_mov_b64 exec, 1
  buffer_store_dwordx2 v[134:135], off, s[44:47], s75 sc1
  s_mov_b64 exec, -1
  s_branch L_att_early1_ret
L_exact:
  s_waitcnt vmcnt(0) lgkmcnt(0)
  s_add_u32 s24, s22, 0
  s_addc_u32 s25, s23, 0
  s_and_b32 s25, s25, 0xffff
  s_mov_b32 s26, 8388608
  s_mov_b32 s27, 0x20000
  v_add_u32 v176, s70, v128
  v_mov_b32 v132, 0xff800000
  v_mov_b32 v133, 0xff800000
  s_mov_b32 s69, 0
L_exact_max:
  buffer_load_dwordx4 v[96:99], v176, s[24:27], s69 offen sc1
  buffer_load_dwordx4 v[100:103], v176, s[24:27], s69 offen offset:1024 sc1
  s_waitcnt vmcnt(0)
  v_mfma_f32_32x32x16_bf16 v[0:15], v[96:99], v[232:235], 0
  v_mfma_f32_32x32x16_bf16 v[0:15], v[100:103], v[236:239], v[0:15]
  v_mfma_f32_32x32x16_bf16 v[16:31], v[96:99], v[240:243], 0
  v_mfma_f32_32x32x16_bf16 v[16:31], v[100:103], v[244:247], v[16:31]
  s_nop 15
  v_max3_f32 v132, v132, v0, v1
  v_max3_f32 v132, v132, v2, v3
  v_max3_f32 v132, v132, v4, v5
  v_max3_f32 v132, v132, v6, v7
  v_max3_f32 v132, v132, v8, v9
  v_max3_f32 v132, v132, v10, v11
  v_max3_f32 v132, v132, v12, v13
  v_max3_f32 v132, v132, v14, v15
  v_max3_f32 v133, v133, v16, v17
  v_max3_f32 v133, v133, v18, v19
  v_max3_f32 v133, v133, v20, v21
  v_max3_f32 v133, v133, v22, v23
  v_max3_f32 v133, v133, v24, v25
  v_max3_f32 v133, v133, v26, v27
  v_max3_f32 v133, v133, v28, v29
  v_max3_f32 v133, v133, v30, v31
  s_add_u32 s69, s69, 2048
  s_cmp_lt_u32 s69, 131072
  s_cbranch_scc1 L_exact_max
  v_mov_b32 v134, v132
  s_nop 1
  v_permlane32_swap_b32 v132, v134
  s_nop 1
  v_max_f32 v132, v132, v134
  v_sub_f32 v140, 0, v132
  v_sub_f32 v141, 0, v132
  v_sub_f32 v142, 0, v132
  v_sub_f32 v143, 0, v132
  v_sub_f32 v144, 0, v132
  v_sub_f32 v145, 0, v132
  v_sub_f32 v146, 0, v132
  v_sub_f32 v147, 0, v132
  v_sub_f32 v148, 0, v132
  v_sub_f32 v149, 0, v132
  v_sub_f32 v150, 0, v132
  v_sub_f32 v151, 0, v132
  v_sub_f32 v152, 0, v132
  v_sub_f32 v153, 0, v132
  v_sub_f32 v154, 0, v132
  v_sub_f32 v155, 0, v132
  v_mov_b32 v134, v133
  s_nop 1
  v_permlane32_swap_b32 v133, v134
  s_nop 1
  v_max_f32 v133, v133, v134
  v_sub_f32 v156, 0, v133
  v_sub_f32 v157, 0, v133
  v_sub_f32 v158, 0, v133
  v_sub_f32 v159, 0, v133
  v_sub_f32 v160, 0, v133
  v_sub_f32 v161, 0, v133
  v_sub_f32 v162, 0, v133
  v_sub_f32 v163, 0, v133
  v_sub_f32 v164, 0, v133
  v_sub_f32 v165, 0, v133
  v_sub_f32 v166, 0, v133
  v_sub_f32 v167, 0, v133
  v_sub_f32 v168, 0, v133
  v_sub_f32 v169, 0, v133
  v_sub_f32 v170, 0, v133
  v_sub_f32 v171, 0, v133
  v_mov_b32 v48, 0
  v_mov_b32 v49, 0
  v_mov_b32 v50, 0
  v_mov_b32 v51, 0
  v_mov_b32 v52, 0
  v_mov_b32 v53, 0
  v_mov_b32 v54, 0
  v_mov_b32 v55, 0
  v_mov_b32 v56, 0
  v_mov_b32 v57, 0
  v_mov_b32 v58, 0
  v_mov_b32 v59, 0
  v_mov_b32 v60, 0
  v_mov_b32 v61, 0
  v_mov_b32 v62, 0
  v_mov_b32 v63, 0
  v_mov_b32 v64, 0
  v_mov_b32 v65, 0
  v_mov_b32 v66, 0
  v_mov_b32 v67, 0
  v_mov_b32 v68, 0
  v_mov_b32 v69, 0
  v_mov_b32 v70, 0
  v_mov_b32 v71, 0
  v_mov_b32 v72, 0
  v_mov_b32 v73, 0
  v_mov_b32 v74, 0
  v_mov_b32 v75, 0
  v_mov_b32 v76, 0
  v_mov_b32 v77, 0
  v_mov_b32 v78, 0
  v_mov_b32 v79, 0
  v_mov_b32 v80, 0
  v_mov_b32 v81, 0
  v_mov_b32 v82, 0
  v_mov_b32 v83, 0
  v_mov_b32 v84, 0
  v_mov_b32 v85, 0
  v_mov_b32 v86, 0
  v_mov_b32 v87, 0
  s_mov_b32 s69, 0
  s_mov_b32 s71, 4194304
L_exact_sum:
  buffer_load_dwordx4 v[96:99], v176, s[24:27], s69 offen sc1
  buffer_load_dwordx4 v[100:103], v176, s[24:27], s69 offen offset:1024 sc1
  buffer_load_dwordx4 v[112:115], v176, s[24:27], s71 offen sc1
  buffer_load_dwordx4 v[116:119], v176, s[24:27], s71 offen offset:1024 sc1
  s_waitcnt vmcnt(0)
  v_mfma_f32_32x32x16_bf16 v[0:15], v[96:99], v[232:235], v[140:155]
  v_mfma_f32_32x32x16_bf16 v[0:15], v[100:103], v[236:239], v[0:15]
  s_nop 15
  v_exp_f32 v0, v0
  v_exp_f32 v1, v1
  v_exp_f32 v2, v2
  v_exp_f32 v3, v3
  v_exp_f32 v4, v4
  v_exp_f32 v5, v5
  v_exp_f32 v6, v6
  v_exp_f32 v7, v7
  v_exp_f32 v8, v8
  v_exp_f32 v9, v9
  v_exp_f32 v10, v10
  v_exp_f32 v11, v11
  v_exp_f32 v12, v12
  v_exp_f32 v13, v13
  v_exp_f32 v14, v14
  v_exp_f32 v15, v15
  s_nop 0
  v_cvt_pk_bf16_f32 v32, v0, v1
  v_cvt_pk_bf16_f32 v33, v2, v3
  v_cvt_pk_bf16_f32 v34, v4, v5
  v_cvt_pk_bf16_f32 v35, v6, v7
  v_cvt_pk_bf16_f32 v36, v8, v9
  v_cvt_pk_bf16_f32 v37, v10, v11
  v_cvt_pk_bf16_f32 v38, v12, v13
  v_cvt_pk_bf16_f32 v39, v14, v15
  s_nop 1
  v_mfma_f32_32x32x16_bf16 v[48:63], v[112:115], v[32:35], v[48:63]
  v_mfma_f32_32x32x16_bf16 v[48:63], v[116:119], v[36:39], v[48:63]
  v_smfmac_f32_16x16x64_bf16 v[80:83], v[88:91], v[32:39], v92
  v_mfma_f32_32x32x16_bf16 v[16:31], v[96:99], v[240:243], v[156:171]
  v_mfma_f32_32x32x16_bf16 v[16:31], v[100:103], v[244:247], v[16:31]
  s_nop 15
  v_exp_f32 v16, v16
  v_exp_f32 v17, v17
  v_exp_f32 v18, v18
  v_exp_f32 v19, v19
  v_exp_f32 v20, v20
  v_exp_f32 v21, v21
  v_exp_f32 v22, v22
  v_exp_f32 v23, v23
  v_exp_f32 v24, v24
  v_exp_f32 v25, v25
  v_exp_f32 v26, v26
  v_exp_f32 v27, v27
  v_exp_f32 v28, v28
  v_exp_f32 v29, v29
  v_exp_f32 v30, v30
  v_exp_f32 v31, v31
  s_nop 0
  v_cvt_pk_bf16_f32 v32, v16, v17
  v_cvt_pk_bf16_f32 v33, v18, v19
  v_cvt_pk_bf16_f32 v34, v20, v21
  v_cvt_pk_bf16_f32 v35, v22, v23
  v_cvt_pk_bf16_f32 v36, v24, v25
  v_cvt_pk_bf16_f32 v37, v26, v27
  v_cvt_pk_bf16_f32 v38, v28, v29
  v_cvt_pk_bf16_f32 v39, v30, v31
  s_nop 1
  v_mfma_f32_32x32x16_bf16 v[64:79], v[112:115], v[32:35], v[64:79]
  v_mfma_f32_32x32x16_bf16 v[64:79], v[116:119], v[36:39], v[64:79]
  v_smfmac_f32_16x16x64_bf16 v[84:87], v[88:91], v[32:39], v92
  s_add_u32 s69, s69, 2048
  s_add_u32 s71, s71, 2048
  s_cmp_lt_u32 s69, 131072
  s_cbranch_scc1 L_exact_sum
  s_nop 15
  v_add_f32 v80, v80, v81
  v_add_f32 v84, v84, v85
  s_mov_b32 s64, 1
  s_branch L_att_store
L_g0_stop:
  s_mov_b32 s26, 0
  s_mov_b32 s30, 0
  s_mov_b32 s34, 0
  s_mov_b32 s38, 0
  s_mov_b32 s73, 196608
  s_mov_b32 s74, 196608
  s_mov_b32 s75, 196608
  s_mov_b32 s76, 196608
  s_branch L_g0_stop_ret
L_role1:
  v_min_u32 v226, 27, v221
  v_lshlrev_b32 v226, 7, v226
  s_cmp_eq_u32 s51, 0
  s_cselect_b32 s40, s12, s14
  s_cselect_b32 s41, s13, s15
  s_and_b32 s41, s41, 0xffff
  s_cmp_lt_u32 s51, 2
  s_cselect_b32 s42, 7340032, 0
  s_add_u32 s79, s2, 256
  s_mul_i32 s79, s79, 3584
  ds_read_b64_tr_b16 v[192:193], v213 offset:64
  ds_read_b64_tr_b16 v[194:195], v213 offset:960
  ds_read_b128 v[160:163], v212 offset:0
  ds_read_b128 v[164:167], v212 offset:1024
  ds_read_b64_tr_b16 v[196:197], v213 offset:7232
  ds_read_b64_tr_b16 v[198:199], v213 offset:8128
  ds_read_b128 v[168:171], v212 offset:2048
  ds_read_b128 v[172:175], v212 offset:3072
  ds_read_b64_tr_b16 v[200:201], v214 offset:96
  ds_read_b64_tr_b16 v[202:203], v214 offset:992
.p2align 6
L_g1:
  s_waitcnt lgkmcnt(2)
  v_mfma_f32_16x16x32_bf16 v[0:3], v[192:195], v[160:163], v[0:3]
  ds_read_b64_tr_b16 v[204:205], v214 offset:7264
  ds_read_b64_tr_b16 v[206:207], v214 offset:8160
  v_mfma_f32_16x16x32_bf16 v[4:7], v[192:195], v[164:167], v[4:7]
  s_lshl1_add_u32 m0, s68, s74
  v_mfma_f32_16x16x32_bf16 v[8:11], v[192:195], v[168:171], v[8:11]
  buffer_load_dwordx4 v218, s[28:31], s70 offen lds
  v_mfma_f32_16x16x32_bf16 v[12:15], v[192:195], v[172:175], v[12:15]
  v_mfma_f32_16x16x32_bf16 v[16:19], v[196:199], v[160:163], v[16:19]
  ds_read_b64_tr_b16 v[208:209], v215 offset:128
  ds_read_b64_tr_b16 v[210:211], v215 offset:1024
  v_mfma_f32_16x16x32_bf16 v[20:23], v[196:199], v[164:167], v[20:23]
  v_mfma_f32_16x16x32_bf16 v[24:27], v[196:199], v[168:171], v[24:27]
  v_mfma_f32_16x16x32_bf16 v[28:31], v[196:199], v[172:175], v[28:31]
  s_waitcnt lgkmcnt(4)
  v_mfma_f32_16x16x32_bf16 v[32:35], v[200:203], v[160:163], v[32:35]
  ds_read_b64_tr_b16 v[192:193], v215 offset:7296
  ds_read_b64_tr_b16 v[194:195], v215 offset:8192
  v_mfma_f32_16x16x32_bf16 v[36:39], v[200:203], v[164:167], v[36:39]
  s_lshl1_add_u32 m0, s68, s75
  v_mfma_f32_16x16x32_bf16 v[40:43], v[200:203], v[168:171], v[40:43]
  buffer_load_dwordx4 v219, s[32:35], s70 offen lds
  s_add_u32 s70, s70, s72
  v_mfma_f32_16x16x32_bf16 v[44:47], v[200:203], v[172:175], v[44:47]
  s_waitcnt lgkmcnt(4)
  v_mfma_f32_16x16x32_bf16 v[48:51], v[204:207], v[160:163], v[48:51]
  ds_read_b64_tr_b16 v[196:197], v215 offset:160
  ds_read_b64_tr_b16 v[198:199], v215 offset:1056
  v_mfma_f32_16x16x32_bf16 v[52:55], v[204:207], v[164:167], v[52:55]
  v_mfma_f32_16x16x32_bf16 v[56:59], v[204:207], v[168:171], v[56:59]
  v_mfma_f32_16x16x32_bf16 v[60:63], v[204:207], v[172:175], v[60:63]
  s_waitcnt lgkmcnt(4)
  v_mfma_f32_16x16x32_bf16 v[64:67], v[208:211], v[160:163], v[64:67]
  ds_read_b64_tr_b16 v[200:201], v215 offset:7328
  ds_read_b64_tr_b16 v[202:203], v215 offset:8224
  v_mfma_f32_16x16x32_bf16 v[68:71], v[208:211], v[164:167], v[68:71]
  s_add_u32 m0, s76, 12288
  v_mfma_f32_16x16x32_bf16 v[72:75], v[208:211], v[168:171], v[72:75]
  buffer_load_dwordx4 v220, s[36:39], s71 offen lds
  s_add_u32 s71, s71, 196608
  v_mfma_f32_16x16x32_bf16 v[76:79], v[208:211], v[172:175], v[76:79]
  s_waitcnt lgkmcnt(4)
  v_mfma_f32_16x16x32_bf16 v[80:83], v[192:195], v[160:163], v[80:83]
  ds_read_b64_tr_b16 v[204:205], v215 offset:192
  ds_read_b64_tr_b16 v[206:207], v215 offset:1088
  v_mfma_f32_16x16x32_bf16 v[84:87], v[192:195], v[164:167], v[84:87]
  buffer_load_dword v225, v226, s[40:43], s79 offen
  s_add_u32 s79, s79, 917504
  v_mfma_f32_16x16x32_bf16 v[88:91], v[192:195], v[168:171], v[88:91]
  v_mfma_f32_16x16x32_bf16 v[92:95], v[192:195], v[172:175], v[92:95]
  s_waitcnt lgkmcnt(4)
  v_mfma_f32_16x16x32_bf16 v[96:99], v[196:199], v[160:163], v[96:99]
  ds_read_b64_tr_b16 v[208:209], v215 offset:7360
  ds_read_b64_tr_b16 v[210:211], v215 offset:8256
  v_mfma_f32_16x16x32_bf16 v[100:103], v[196:199], v[164:167], v[100:103]
  v_mfma_f32_16x16x32_bf16 v[104:107], v[196:199], v[168:171], v[104:107]
  s_waitcnt vmcnt(6)
  v_mfma_f32_16x16x32_bf16 v[108:111], v[196:199], v[172:175], v[108:111]
  s_waitcnt lgkmcnt(4)
  s_barrier
  v_mfma_f32_16x16x32_bf16 v[112:115], v[200:203], v[160:163], v[112:115]
  ds_read_b64_tr_b16 v[192:193], v213 offset:14400
  ds_read_b64_tr_b16 v[194:195], v213 offset:15296
  v_mfma_f32_16x16x32_bf16 v[116:119], v[200:203], v[164:167], v[116:119]
  ds_read_b128 v[176:179], v212 offset:16384
  ds_read_b128 v[180:183], v212 offset:17408
  v_mfma_f32_16x16x32_bf16 v[120:123], v[200:203], v[168:171], v[120:123]
  v_mfma_f32_16x16x32_bf16 v[124:127], v[200:203], v[172:175], v[124:127]
  s_waitcnt lgkmcnt(6)
  v_mfma_f32_16x16x32_bf16 v[128:131], v[204:207], v[160:163], v[128:131]
  ds_read_b64_tr_b16 v[196:197], v213 offset:21568
  ds_read_b64_tr_b16 v[198:199], v213 offset:22464
  v_mfma_f32_16x16x32_bf16 v[132:135], v[204:207], v[164:167], v[132:135]
  ds_read_b128 v[184:187], v212 offset:18432
  ds_read_b128 v[188:191], v212 offset:19456
  v_mfma_f32_16x16x32_bf16 v[136:139], v[204:207], v[168:171], v[136:139]
  s_add_u32 m0, s73, 49152
  v_mfma_f32_16x16x32_bf16 v[140:143], v[204:207], v[172:175], v[140:143]
  buffer_load_dwordx4 v216, s[24:27], s69 offen sc1 lds
  s_waitcnt lgkmcnt(8)
  v_mfma_f32_16x16x32_bf16 v[144:147], v[208:211], v[160:163], v[144:147]
  ds_read_b64_tr_b16 v[200:201], v214 offset:14432
  ds_read_b64_tr_b16 v[202:203], v214 offset:15328
  v_mfma_f32_16x16x32_bf16 v[148:151], v[208:211], v[164:167], v[148:151]
  v_mfma_f32_16x16x32_bf16 v[152:155], v[208:211], v[168:171], v[152:155]
  buffer_load_dwordx4 v216, s[24:27], s69 offen offset:1024 sc1 lds
  s_add_u32 s69, s69, 2048
  v_mfma_f32_16x16x32_bf16 v[156:159], v[208:211], v[172:175], v[156:159]
  s_waitcnt lgkmcnt(2)
  v_mfma_f32_16x16x32_bf16 v[0:3], v[192:195], v[176:179], v[0:3]
  ds_read_b64_tr_b16 v[204:205], v214 offset:21600
  ds_read_b64_tr_b16 v[206:207], v214 offset:22496
  v_mfma_f32_16x16x32_bf16 v[4:7], v[192:195], v[180:183], v[4:7]
  s_add_u32 m0, s74, s67
  v_mfma_f32_16x16x32_bf16 v[8:11], v[192:195], v[184:187], v[8:11]
  buffer_load_dwordx4 v218, s[28:31], s70 offen lds
  v_mfma_f32_16x16x32_bf16 v[12:15], v[192:195], v[188:191], v[12:15]
  v_mfma_f32_16x16x32_bf16 v[16:19], v[196:199], v[176:179], v[16:19]
  ds_read_b64_tr_b16 v[208:209], v215 offset:14464
  ds_read_b64_tr_b16 v[210:211], v215 offset:15360
  v_mfma_f32_16x16x32_bf16 v[20:23], v[196:199], v[180:183], v[20:23]
  v_mfma_f32_16x16x32_bf16 v[24:27], v[196:199], v[184:187], v[24:27]
  v_mfma_f32_16x16x32_bf16 v[28:31], v[196:199], v[188:191], v[28:31]
  s_waitcnt lgkmcnt(4)
  v_mfma_f32_16x16x32_bf16 v[32:35], v[200:203], v[176:179], v[32:35]
  ds_read_b64_tr_b16 v[192:193], v215 offset:21632
  ds_read_b64_tr_b16 v[194:195], v215 offset:22528
  v_mfma_f32_16x16x32_bf16 v[36:39], v[200:203], v[180:183], v[36:39]
  s_add_u32 m0, s75, s67
  v_mfma_f32_16x16x32_bf16 v[40:43], v[200:203], v[184:187], v[40:43]
  buffer_load_dwordx4 v219, s[32:35], s70 offen lds
  s_add_u32 s70, s70, s72
  v_mfma_f32_16x16x32_bf16 v[44:47], v[200:203], v[188:191], v[44:47]
  s_waitcnt lgkmcnt(4)
  v_mfma_f32_16x16x32_bf16 v[48:51], v[204:207], v[176:179], v[48:51]
  ds_read_b64_tr_b16 v[196:197], v215 offset:14496
  ds_read_b64_tr_b16 v[198:199], v215 offset:15392
  v_mfma_f32_16x16x32_bf16 v[52:55], v[204:207], v[180:183], v[52:55]
  v_mfma_f32_16x16x32_bf16 v[56:59], v[204:207], v[184:187], v[56:59]
  v_mfma_f32_16x16x32_bf16 v[60:63], v[204:207], v[188:191], v[60:63]
  s_waitcnt lgkmcnt(4)
  v_mfma_f32_16x16x32_bf16 v[64:67], v[208:211], v[176:179], v[64:67]
  ds_read_b64_tr_b16 v[200:201], v215 offset:21664
  ds_read_b64_tr_b16 v[202:203], v215 offset:22560
  v_mfma_f32_16x16x32_bf16 v[68:71], v[208:211], v[180:183], v[68:71]
  s_add_u32 m0, s76, 18432
  v_mfma_f32_16x16x32_bf16 v[72:75], v[208:211], v[184:187], v[72:75]
  buffer_load_dwordx4 v220, s[36:39], s71 offen lds
  s_add_u32 s71, s71, 196608
  v_mfma_f32_16x16x32_bf16 v[76:79], v[208:211], v[188:191], v[76:79]
  s_waitcnt lgkmcnt(4)
  v_mfma_f32_16x16x32_bf16 v[80:83], v[192:195], v[176:179], v[80:83]
  ds_read_b64_tr_b16 v[204:205], v215 offset:14528
  ds_read_b64_tr_b16 v[206:207], v215 offset:15424
  v_mfma_f32_16x16x32_bf16 v[84:87], v[192:195], v[180:183], v[84:87]
  v_mfma_f32_16x16x32_bf16 v[88:91], v[192:195], v[184:187], v[88:91]
  v_mfma_f32_16x16x32_bf16 v[92:95], v[192:195], v[188:191], v[92:95]
  s_waitcnt lgkmcnt(4)
  v_mfma_f32_16x16x32_bf16 v[96:99], v[196:199], v[176:179], v[96:99]
  ds_read_b64_tr_b16 v[208:209], v215 offset:21696
  ds_read_b64_tr_b16 v[210:211], v215 offset:22592
  v_mfma_f32_16x16x32_bf16 v[100:103], v[196:199], v[180:183], v[100:103]
  s_cmp_eq_u32 s64, 7
  s_cbranch_scc1 L_g1_stop
L_g1_stop_ret:
  v_mfma_f32_16x16x32_bf16 v[104:107], v[196:199], v[184:187], v[104:107]
  s_waitcnt vmcnt(6)
  v_mfma_f32_16x16x32_bf16 v[108:111], v[196:199], v[188:191], v[108:111]
  s_waitcnt lgkmcnt(4)
  s_barrier
  v_mfma_f32_16x16x32_bf16 v[112:115], v[200:203], v[176:179], v[112:115]
  ds_read_b64_tr_b16 v[192:193], v213 offset:28736
  ds_read_b64_tr_b16 v[194:195], v213 offset:29632
  v_mfma_f32_16x16x32_bf16 v[116:119], v[200:203], v[180:183], v[116:119]
  ds_read_b128 v[160:163], v212 offset:32768
  ds_read_b128 v[164:167], v212 offset:33792
  v_mfma_f32_16x16x32_bf16 v[120:123], v[200:203], v[184:187], v[120:123]
  v_mfma_f32_16x16x32_bf16 v[124:127], v[200:203], v[188:191], v[124:127]
  s_waitcnt lgkmcnt(6)
  v_mfma_f32_16x16x32_bf16 v[128:131], v[204:207], v[176:179], v[128:131]
  ds_read_b64_tr_b16 v[196:197], v213 offset:35904
  ds_read_b64_tr_b16 v[198:199], v213 offset:36800
  v_mfma_f32_16x16x32_bf16 v[132:135], v[204:207], v[180:183], v[132:135]
  ds_read_b128 v[168:171], v212 offset:34816
  ds_read_b128 v[172:175], v212 offset:35840
  v_mfma_f32_16x16x32_bf16 v[136:139], v[204:207], v[184:187], v[136:139]
  s_add_u32 m0, s73, 0
  v_mfma_f32_16x16x32_bf16 v[140:143], v[204:207], v[188:191], v[140:143]
  buffer_load_dwordx4 v216, s[24:27], s69 offen sc1 lds
  s_waitcnt lgkmcnt(8)
  v_mfma_f32_16x16x32_bf16 v[144:147], v[208:211], v[176:179], v[144:147]
  ds_read_b64_tr_b16 v[200:201], v214 offset:28768
  ds_read_b64_tr_b16 v[202:203], v214 offset:29664
  v_mfma_f32_16x16x32_bf16 v[148:151], v[208:211], v[180:183], v[148:151]
  v_mfma_f32_16x16x32_bf16 v[152:155], v[208:211], v[184:187], v[152:155]
  buffer_load_dwordx4 v216, s[24:27], s69 offen offset:1024 sc1 lds
  s_add_u32 s69, s69, 2048
  v_mfma_f32_16x16x32_bf16 v[156:159], v[208:211], v[188:191], v[156:159]
  s_waitcnt lgkmcnt(2)
  v_mfma_f32_16x16x32_bf16 v[0:3], v[192:195], v[160:163], v[0:3]
  ds_read_b64_tr_b16 v[204:205], v214 offset:35936
  ds_read_b64_tr_b16 v[206:207], v214 offset:36832
  v_mfma_f32_16x16x32_bf16 v[4:7], v[192:195], v[164:167], v[4:7]
  s_mov_b32 m0, s74
  v_mfma_f32_16x16x32_bf16 v[8:11], v[192:195], v[168:171], v[8:11]
  buffer_load_dwordx4 v218, s[28:31], s70 offen lds
  v_mfma_f32_16x16x32_bf16 v[12:15], v[192:195], v[172:175], v[12:15]
  v_mfma_f32_16x16x32_bf16 v[16:19], v[196:199], v[160:163], v[16:19]
  ds_read_b64_tr_b16 v[208:209], v215 offset:28800
  ds_read_b64_tr_b16 v[210:211], v215 offset:29696
  v_mfma_f32_16x16x32_bf16 v[20:23], v[196:199], v[164:167], v[20:23]
  v_mfma_f32_16x16x32_bf16 v[24:27], v[196:199], v[168:171], v[24:27]
  v_mfma_f32_16x16x32_bf16 v[28:31], v[196:199], v[172:175], v[28:31]
  s_waitcnt lgkmcnt(4)
  v_mfma_f32_16x16x32_bf16 v[32:35], v[200:203], v[160:163], v[32:35]
  ds_read_b64_tr_b16 v[192:193], v215 offset:35968
  ds_read_b64_tr_b16 v[194:195], v215 offset:36864
  v_mfma_f32_16x16x32_bf16 v[36:39], v[200:203], v[164:167], v[36:39]
  s_mov_b32 m0, s75
  v_mfma_f32_16x16x32_bf16 v[40:43], v[200:203], v[168:171], v[40:43]
  buffer_load_dwordx4 v219, s[32:35], s70 offen lds
  s_add_u32 s70, s70, s72
  v_mfma_f32_16x16x32_bf16 v[44:47], v[200:203], v[172:175], v[44:47]
  s_waitcnt lgkmcnt(4)
  v_mfma_f32_16x16x32_bf16 v[48:51], v[204:207], v[160:163], v[48:51]
  ds_read_b64_tr_b16 v[196:197], v215 offset:28832
  ds_read_b64_tr_b16 v[198:199], v215 offset:29728
  v_mfma_f32_16x16x32_bf16 v[52:55], v[204:207], v[164:167], v[52:55]
  v_mfma_f32_16x16x32_bf16 v[56:59], v[204:207], v[168:171], v[56:59]
  v_mfma_f32_16x16x32_bf16 v[60:63], v[204:207], v[172:175], v[60:63]
  s_waitcnt lgkmcnt(4)
  v_mfma_f32_16x16x32_bf16 v[64:67], v[208:211], v[160:163], v[64:67]
  ds_read_b64_tr_b16 v[200:201], v215 offset:36000
  ds_read_b64_tr_b16 v[202:203], v215 offset:36896
  v_mfma_f32_16x16x32_bf16 v[68:71], v[208:211], v[164:167], v[68:71]
  s_add_u32 m0, s76, 0
  v_mfma_f32_16x16x32_bf16 v[72:75], v[208:211], v[168:171], v[72:75]
  buffer_load_dwordx4 v220, s[36:39], s71 offen lds
  s_add_u32 s71, s71, 196608
  v_mfma_f32_16x16x32_bf16 v[76:79], v[208:211], v[172:175], v[76:79]
  s_waitcnt lgkmcnt(4)
  v_mfma_f32_16x16x32_bf16 v[80:83], v[192:195], v[160:163], v[80:83]
  ds_read_b64_tr_b16 v[204:205], v215 offset:28864
  ds_read_b64_tr_b16 v[206:207], v215 offset:29760
  v_mfma_f32_16x16x32_bf16 v[84:87], v[192:195], v[164:167], v[84:87]
  v_mfma_f32_16x16x32_bf16 v[88:91], v[192:195], v[168:171], v[88:91]
  v_mfma_f32_16x16x32_bf16 v[92:95], v[192:195], v[172:175], v[92:95]
  s_waitcnt lgkmcnt(4)
  v_mfma_f32_16x16x32_bf16 v[96:99], v[196:199], v[160:163], v[96:99]
  ds_read_b64_tr_b16 v[208:209], v215 offset:36032
  ds_read_b64_tr_b16 v[210:211], v215 offset:36928
  v_mfma_f32_16x16x32_bf16 v[100:103], v[196:199], v[164:167], v[100:103]
  v_mfma_f32_16x16x32_bf16 v[104:107], v[196:199], v[168:171], v[104:107]
  s_waitcnt vmcnt(5)
  v_mfma_f32_16x16x32_bf16 v[108:111], v[196:199], v[172:175], v[108:111]
  s_waitcnt lgkmcnt(4)
  s_barrier
  v_mfma_f32_16x16x32_bf16 v[112:115], v[200:203], v[160:163], v[112:115]
  ds_read_b64_tr_b16 v[192:193], v213 offset:43072
  ds_read_b64_tr_b16 v[194:195], v213 offset:43968
  v_mfma_f32_16x16x32_bf16 v[116:119], v[200:203], v[164:167], v[116:119]
  ds_read_b128 v[176:179], v212 offset:49152
  ds_read_b128 v[180:183], v212 offset:50176
  v_mfma_f32_16x16x32_bf16 v[120:123], v[200:203], v[168:171], v[120:123]
  v_mfma_f32_16x16x32_bf16 v[124:127], v[200:203], v[172:175], v[124:127]
  s_waitcnt lgkmcnt(6)
  v_mfma_f32_16x16x32_bf16 v[128:131], v[204:207], v[160:163], v[128:131]
  ds_read_b64_tr_b16 v[196:197], v213 offset:50240
  ds_read_b64_tr_b16 v[198:199], v213 offset:51136
  v_mfma_f32_16x16x32_bf16 v[132:135], v[204:207], v[164:167], v[132:135]
  ds_read_b128 v[184:187], v212 offset:51200
  ds_read_b128 v[188:191], v212 offset:52224
  v_mfma_f32_16x16x32_bf16 v[136:139], v[204:207], v[168:171], v[136:139]
  s_add_u32 m0, s73, 16384
  v_mfma_f32_16x16x32_bf16 v[140:143], v[204:207], v[172:175], v[140:143]
  buffer_load_dwordx4 v216, s[24:27], s69 offen sc1 lds
  s_waitcnt lgkmcnt(8)
  v_mfma_f32_16x16x32_bf16 v[144:147], v[208:211], v[160:163], v[144:147]
  ds_read_b64_tr_b16 v[200:201], v214 offset:43104
  ds_read_b64_tr_b16 v[202:203], v214 offset:44000
  v_mfma_f32_16x16x32_bf16 v[148:151], v[208:211], v[164:167], v[148:151]
  v_mfma_f32_16x16x32_bf16 v[152:155], v[208:211], v[168:171], v[152:155]
  buffer_load_dwordx4 v216, s[24:27], s69 offen offset:1024 sc1 lds
  s_add_u32 s69, s69, 2048
  v_mfma_f32_16x16x32_bf16 v[156:159], v[208:211], v[172:175], v[156:159]
  s_waitcnt lgkmcnt(2)
  v_mfma_f32_16x16x32_bf16 v[0:3], v[192:195], v[176:179], v[0:3]
  ds_read_b64_tr_b16 v[204:205], v214 offset:50272
  ds_read_b64_tr_b16 v[206:207], v214 offset:51168
  v_mfma_f32_16x16x32_bf16 v[4:7], v[192:195], v[180:183], v[4:7]
  s_add_u32 m0, s74, s68
  v_mfma_f32_16x16x32_bf16 v[8:11], v[192:195], v[184:187], v[8:11]
  buffer_load_dwordx4 v218, s[28:31], s70 offen lds
  v_mfma_f32_16x16x32_bf16 v[12:15], v[192:195], v[188:191], v[12:15]
  v_mfma_f32_16x16x32_bf16 v[16:19], v[196:199], v[176:179], v[16:19]
  ds_read_b64_tr_b16 v[208:209], v215 offset:43136
  ds_read_b64_tr_b16 v[210:211], v215 offset:44032
  v_mfma_f32_16x16x32_bf16 v[20:23], v[196:199], v[180:183], v[20:23]
  v_mfma_f32_16x16x32_bf16 v[24:27], v[196:199], v[184:187], v[24:27]
  v_mfma_f32_16x16x32_bf16 v[28:31], v[196:199], v[188:191], v[28:31]
  s_waitcnt lgkmcnt(4)
  v_mfma_f32_16x16x32_bf16 v[32:35], v[200:203], v[176:179], v[32:35]
  ds_read_b64_tr_b16 v[192:193], v215 offset:50304
  ds_read_b64_tr_b16 v[194:195], v215 offset:51200
  v_mfma_f32_16x16x32_bf16 v[36:39], v[200:203], v[180:183], v[36:39]
  s_add_u32 m0, s75, s68
  v_mfma_f32_16x16x32_bf16 v[40:43], v[200:203], v[184:187], v[40:43]
  buffer_load_dwordx4 v219, s[32:35], s70 offen lds
  s_add_u32 s70, s70, s72
  v_mfma_f32_16x16x32_bf16 v[44:47], v[200:203], v[188:191], v[44:47]
  s_waitcnt lgkmcnt(4)
  v_mfma_f32_16x16x32_bf16 v[48:51], v[204:207], v[176:179], v[48:51]
  ds_read_b64_tr_b16 v[196:197], v215 offset:43168
  ds_read_b64_tr_b16 v[198:199], v215 offset:44064
  v_mfma_f32_16x16x32_bf16 v[52:55], v[204:207], v[180:183], v[52:55]
  v_mfma_f32_16x16x32_bf16 v[56:59], v[204:207], v[184:187], v[56:59]
  v_mfma_f32_16x16x32_bf16 v[60:63], v[204:207], v[188:191], v[60:63]
  s_waitcnt lgkmcnt(4)
  v_mfma_f32_16x16x32_bf16 v[64:67], v[208:211], v[176:179], v[64:67]
  ds_read_b64_tr_b16 v[200:201], v215 offset:50336
  ds_read_b64_tr_b16 v[202:203], v215 offset:51232
  v_mfma_f32_16x16x32_bf16 v[68:71], v[208:211], v[180:183], v[68:71]
  s_add_u32 m0, s76, 6144
  v_mfma_f32_16x16x32_bf16 v[72:75], v[208:211], v[184:187], v[72:75]
  buffer_load_dwordx4 v220, s[36:39], s71 offen lds
  s_add_u32 s71, s71, 196608
  v_mfma_f32_16x16x32_bf16 v[76:79], v[208:211], v[188:191], v[76:79]
  s_waitcnt lgkmcnt(4)
  v_mfma_f32_16x16x32_bf16 v[80:83], v[192:195], v[176:179], v[80:83]
  ds_read_b64_tr_b16 v[204:205], v215 offset:43200
  ds_read_b64_tr_b16 v[206:207], v215 offset:44096
  v_mfma_f32_16x16x32_bf16 v[84:87], v[192:195], v[180:183], v[84:87]
  v_mfma_f32_16x16x32_bf16 v[88:91], v[192:195], v[184:187], v[88:91]
  v_mfma_f32_16x16x32_bf16 v[92:95], v[192:195], v[188:191], v[92:95]
  s_waitcnt lgkmcnt(4)
  v_mfma_f32_16x16x32_bf16 v[96:99], v[196:199], v[176:179], v[96:99]
  ds_read_b64_tr_b16 v[208:209], v215 offset:50368
  ds_read_b64_tr_b16 v[210:211], v215 offset:51264
  v_mfma_f32_16x16x32_bf16 v[100:103], v[196:199], v[180:183], v[100:103]
  v_mfma_f32_16x16x32_bf16 v[104:107], v[196:199], v[184:187], v[104:107]
  s_waitcnt vmcnt(5)
  v_mfma_f32_16x16x32_bf16 v[108:111], v[196:199], v[188:191], v[108:111]
  s_waitcnt lgkmcnt(4)
  s_barrier
  v_mfma_f32_16x16x32_bf16 v[112:115], v[200:203], v[176:179], v[112:115]
  ds_read_b64_tr_b16 v[192:193], v213 offset:64
  ds_read_b64_tr_b16 v[194:195], v213 offset:960
  v_mfma_f32_16x16x32_bf16 v[116:119], v[200:203], v[180:183], v[116:119]
  ds_read_b128 v[160:163], v212 offset:0
  ds_read_b128 v[164:167], v212 offset:1024
  v_mfma_f32_16x16x32_bf16 v[120:123], v[200:203], v[184:187], v[120:123]
  v_mfma_f32_16x16x32_bf16 v[124:127], v[200:203], v[188:191], v[124:127]
  s_waitcnt lgkmcnt(6)
  v_mfma_f32_16x16x32_bf16 v[128:131], v[204:207], v[176:179], v[128:131]
  ds_read_b64_tr_b16 v[196:197], v213 offset:7232
  ds_read_b64_tr_b16 v[198:199], v213 offset:8128
  v_mfma_f32_16x16x32_bf16 v[132:135], v[204:207], v[180:183], v[132:135]
  ds_read_b128 v[168:171], v212 offset:2048
  ds_read_b128 v[172:175], v212 offset:3072
  v_mfma_f32_16x16x32_bf16 v[136:139], v[204:207], v[184:187], v[136:139]
  s_add_u32 m0, s73, 32768
  v_mfma_f32_16x16x32_bf16 v[140:143], v[204:207], v[188:191], v[140:143]
  buffer_load_dwordx4 v216, s[24:27], s69 offen sc1 lds
  s_waitcnt lgkmcnt(8)
  v_mfma_f32_16x16x32_bf16 v[144:147], v[208:211], v[176:179], v[144:147]
  ds_read_b64_tr_b16 v[200:201], v214 offset:96
  ds_read_b64_tr_b16 v[202:203], v214 offset:992
  v_mfma_f32_16x16x32_bf16 v[148:151], v[208:211], v[180:183], v[148:151]
  v_mfma_f32_16x16x32_bf16 v[152:155], v[208:211], v[184:187], v[152:155]
  buffer_load_dwordx4 v216, s[24:27], s69 offen offset:1024 sc1 lds
  s_add_u32 s69, s69, 2048
  v_mfma_f32_16x16x32_bf16 v[156:159], v[208:211], v[188:191], v[156:159]
  s_cmp_eq_u32 s64, s77
  s_cbranch_scc1 L_touch
L_touch_ret:
  s_add_u32 s64, s64, 1
  s_cmp_lt_u32 s64, 8
  s_cbranch_scc1 L_g1
  s_mov_b32 s10, 0xbfb8aa3b
  s_mov_b32 s11, 0xbfb8aa3b
  s_waitcnt lgkmcnt(0)
  s_barrier
  s_mov_b32 s32, s16
  s_and_b32 s33, s17, 0xffff
  s_mov_b32 s34, 7340032
  s_mov_b32 s35, 0x20000
  s_mov_b32 s36, s8
  s_and_b32 s37, s9, 0xffff
  s_mov_b32 s38, 2097152
  s_mov_b32 s39, 0x20000
  v_mov_b32 v247, v221
  v_lshrrev_b32 v224, 4, v221
  v_lshlrev_b32 v225, 2, v224
  v_xor_b32 v225, v225, v221
  v_and_b32 v225, 15, v225
  v_lshlrev_b32 v225, 4, v225
  v_lshl_add_u32 v245, v224, 11, v225
  s_lshl_b32 s57, s66, 8
  v_add_u32 v245, s57, v245
  v_lshrrev_b32 v224, 3, v221
  v_bfe_u32 v225, v221, 4, 1
  v_lshlrev_b32 v225, 2, v225
  v_xor_b32 v225, v225, v221
  v_and_b32 v225, 7, v225
  v_lshlrev_b32 v225, 4, v225
  v_lshl_add_u32 v254, v224, 11, v225
  s_lshl_b32 s56, s51, 16
  s_lshl_b32 s57, s53, 7
  s_add_u32 s56, s56, s57
  v_add_u32 v254, s56, v254
  s_lshl_b32 s74, s51, 12
  s_add_u32 s74, s74, 32768
  s_lshr_b32 s76, s51, 1
  s_mul_i32 s56, s65, 112
  s_mul_i32 s57, s76, 7
  s_add_u32 s72, s56, s57
  s_and_b32 s57, s51, 1
  s_add_u32 s72, s72, s57
  s_lshl_b32 s72, s72, 15
  s_mul_i32 s57, s51, 7
  s_add_u32 s68, s56, s57
  s_lshl_b32 s68, s68, 15
  s_mov_b32 s79, 147456
  s_add_u32 s28, s22, 13631488
  s_addc_u32 s29, s23, 0
  s_and_b32 s29, s29, 0xffff
  s_mov_b32 s30, 14958592
  s_mov_b32 s31, 0x20000
  v_lshlrev_b32 v244, 4, v221
  s_lshl_b32 s56, s49, 3
  s_lshl_b32 s57, s51, 1
  s_add_u32 s56, s56, s57
  s_mul_i32 s58, s56, 233728
  s_mul_i32 s57, s50, 7168
  s_add_u32 s58, s58, s57
  s_add_u32 s59, s58, 233728
  s_lshl_b32 s77, s49, 1
  s_lshr_b32 s56, s51, 1
  s_add_u32 s77, s77, s56
  s_lshl_b32 s77, s77, 5
  s_add_u32 s77, s77, s50
  s_lshl_b32 s77, s77, 4
  s_and_b32 s56, s51, 1
  s_lshl_b32 s56, s56, 3
  s_add_u32 s77, s77, s56
  s_add_u32 s77, s77, 49152
  v_lshrrev_b32 v248, 5, v247
  v_lshlrev_b32 v248, 3, v248
  v_bfe_u32 v250, v247, 2, 2
  v_add_u32 v248, v248, v250
  v_and_b32 v249, 1, v247
  v_lshlrev_b32 v249, 4, v249
  v_bfe_u32 v251, v247, 1, 1
  v_lshl_add_u32 v249, v251, 3, v249
  v_bfe_u32 v251, v247, 4, 1
  v_lshl_add_u32 v249, v251, 5, v249
  s_lshl_b32 s56, s65, 1
  v_xor_b32 v250, s56, v250
  v_lshl_add_u32 v249, v250, 6, v249
  v_lshl_add_u32 v216, v248, 8, v249
  s_lshl_b32 s56, s76, 13
  s_add_u32 s56, s56, 32768
  v_add_u32 v216, s56, v216
  v_xor_b32 v217, 64, v216
  v_xor_b32 v218, 128, v216
  v_xor_b32 v219, 192, v216
  v_add_u32 v220, 65536, v216
  v_add_u32 v221, 65536, v217
  v_add_u32 v222, 65536, v218
  v_add_u32 v223, 65536, v219
  s_lshl_b32 s56, s52, 2
  s_and_b32 s57, s51, 1
  s_lshl_b32 s57, s57, 1
  s_add_u32 s56, s56, s57
  s_add_u32 s75, s56, s76
  s_xor_b32 s67, s75, 1
  s_mul_i32 s56, s65, 114688
  s_mul_i32 s57, s76, 7168
  s_add_u32 s56, s56, s57
  s_mul_i32 s49, s75, 233728
  s_add_u32 s49, s49, s56
  s_sub_u32 s50, s67, s75
  s_mul_i32 s50, s50, 233728
  s_lshl_b32 s73, s52, 9
  s_lshl_b32 s56, s65, 8
  s_add_u32 s73, s73, s56
  s_add_u32 s73, s73, 40960
  v_and_b32 v252, 31, v247
  v_lshlrev_b32 v252, 3, v252
  s_add_u32 s24, s22, 13631488
  s_addc_u32 s25, s23, 0
  s_and_b32 s25, s25, 0xffff
  s_mov_b32 s26, 14958592
  s_mov_b32 s27, 0x20000
  v_pk_mul_f32 v[204:205], v[0:1], s[10:11]
  v_pk_mul_f32 v[206:207], v[2:3], s[10:11]
  v_pk_mul_f32 v[208:209], v[4:5], s[10:11]
  v_pk_mul_f32 v[210:211], v[6:7], s[10:11]
  v_exp_f32 v204, v204
  v_exp_f32 v205, v205
  v_exp_f32 v206, v206
  v_exp_f32 v207, v207
  v_exp_f32 v208, v208
  v_exp_f32 v209, v209
  v_exp_f32 v210, v210
  v_exp_f32 v211, v211
  v_pk_mul_f32 v[0:1], v[0:1], v[16:17]
  v_pk_mul_f32 v[2:3], v[2:3], v[18:19]
  v_pk_mul_f32 v[4:5], v[4:5], v[20:21]
  v_pk_mul_f32 v[6:7], v[6:7], v[22:23]
  v_pk_add_f32 v[204:205], v[204:205], 1.0 op_sel_hi:[1,0]
  v_pk_add_f32 v[206:207], v[206:207], 1.0 op_sel_hi:[1,0]
  v_pk_add_f32 v[208:209], v[208:209], 1.0 op_sel_hi:[1,0]
  v_pk_add_f32 v[210:211], v[210:211], 1.0 op_sel_hi:[1,0]
  v_rcp_f32 v204, v204
  v_rcp_f32 v205, v205
  v_rcp_f32 v206, v206
  v_rcp_f32 v207, v207
  v_rcp_f32 v208, v208
  v_rcp_f32 v209, v209
  v_rcp_f32 v210, v210
  v_rcp_f32 v211, v211
  s_nop 0
  v_pk_mul_f32 v[0:1], v[0:1], v[204:205]
  v_pk_mul_f32 v[2:3], v[2:3], v[206:207]
  v_pk_mul_f32 v[4:5], v[4:5], v[208:209]
  v_pk_mul_f32 v[6:7], v[6:7], v[210:211]
  v_cvt_pk_bf16_f32 v184, v0, v1
  v_cvt_pk_bf16_f32 v186, v4, v5
  v_cvt_pk_bf16_f32 v185, v2, v3
  v_cvt_pk_bf16_f32 v187, v6, v7
  s_nop 0
  v_permlane16_swap_b32 v184, v186
  v_permlane16_swap_b32 v185, v187
  v_pk_mul_f32 v[204:205], v[8:9], s[10:11]
  v_pk_mul_f32 v[206:207], v[10:11], s[10:11]
  v_pk_mul_f32 v[208:209], v[12:13], s[10:11]
  v_pk_mul_f32 v[210:211], v[14:15], s[10:11]
  v_exp_f32 v204, v204
  v_exp_f32 v205, v205
  v_exp_f32 v206, v206
  v_exp_f32 v207, v207
  v_exp_f32 v208, v208
  v_exp_f32 v209, v209
  v_exp_f32 v210, v210
  v_exp_f32 v211, v211
  v_pk_mul_f32 v[8:9], v[8:9], v[24:25]
  v_pk_mul_f32 v[10:11], v[10:11], v[26:27]
  v_pk_mul_f32 v[12:13], v[12:13], v[28:29]
  v_pk_mul_f32 v[14:15], v[14:15], v[30:31]
  v_pk_add_f32 v[204:205], v[204:205], 1.0 op_sel_hi:[1,0]
  v_pk_add_f32 v[206:207], v[206:207], 1.0 op_sel_hi:[1,0]
  v_pk_add_f32 v[208:209], v[208:209], 1.0 op_sel_hi:[1,0]
  v_pk_add_f32 v[210:211], v[210:211], 1.0 op_sel_hi:[1,0]
  v_rcp_f32 v204, v204
  v_rcp_f32 v205, v205
  v_rcp_f32 v206, v206
  v_rcp_f32 v207, v207
  v_rcp_f32 v208, v208
  v_rcp_f32 v209, v209
  v_rcp_f32 v210, v210
  v_rcp_f32 v211, v211
  s_nop 0
  v_pk_mul_f32 v[8:9], v[8:9], v[204:205]
  v_pk_mul_f32 v[10:11], v[10:11], v[206:207]
  v_pk_mul_f32 v[12:13], v[12:13], v[208:209]
  v_pk_mul_f32 v[14:15], v[14:15], v[210:211]
  v_cvt_pk_bf16_f32 v188, v8, v9
  v_cvt_pk_bf16_f32 v190, v12, v13
  v_cvt_pk_bf16_f32 v189, v10, v11
  v_cvt_pk_bf16_f32 v191, v14, v15
  s_nop 0
  v_permlane16_swap_b32 v188, v190
  v_permlane16_swap_b32 v189, v191
  v_pk_mul_f32 v[204:205], v[32:33], s[10:11]
  v_pk_mul_f32 v[206:207], v[34:35], s[10:11]
  v_pk_mul_f32 v[208:209], v[36:37], s[10:11]
  v_pk_mul_f32 v[210:211], v[38:39], s[10:11]
  v_exp_f32 v204, v204
  v_exp_f32 v205, v205
  v_exp_f32 v206, v206
  v_exp_f32 v207, v207
  v_exp_f32 v208, v208
  v_exp_f32 v209, v209
  v_exp_f32 v210, v210
  v_exp_f32 v211, v211
  v_pk_mul_f32 v[32:33], v[32:33], v[48:49]
  v_pk_mul_f32 v[34:35], v[34:35], v[50:51]
  v_pk_mul_f32 v[36:37], v[36:37], v[52:53]
  v_pk_mul_f32 v[38:39], v[38:39], v[54:55]
  v_pk_add_f32 v[204:205], v[204:205], 1.0 op_sel_hi:[1,0]
  v_pk_add_f32 v[206:207], v[206:207], 1.0 op_sel_hi:[1,0]
  v_pk_add_f32 v[208:209], v[208:209], 1.0 op_sel_hi:[1,0]
  v_pk_add_f32 v[210:211], v[210:211], 1.0 op_sel_hi:[1,0]
  v_rcp_f32 v204, v204
  v_rcp_f32 v205, v205
  v_rcp_f32 v206, v206
  v_rcp_f32 v207, v207
  v_rcp_f32 v208, v208
  v_rcp_f32 v209, v209
  v_rcp_f32 v210, v210
  v_rcp_f32 v211, v211
  s_nop 0
  v_pk_mul_f32 v[32:33], v[32:33], v[204:205]
  v_pk_mul_f32 v[34:35], v[34:35], v[206:207]
  v_pk_mul_f32 v[36:37], v[36:37], v[208:209]
  v_pk_mul_f32 v[38:39], v[38:39], v[210:211]
  v_cvt_pk_bf16_f32 v192, v32, v33
  v_cvt_pk_bf16_f32 v194, v36, v37
  v_cvt_pk_bf16_f32 v193, v34, v35
  v_cvt_pk_bf16_f32 v195, v38, v39
  s_nop 0
  v_permlane16_swap_b32 v192, v194
  v_permlane16_swap_b32 v193, v195
  v_pk_mul_f32 v[204:205], v[40:41], s[10:11]
  v_pk_mul_f32 v[206:207], v[42:43], s[10:11]
  v_pk_mul_f32 v[208:209], v[44:45], s[10:11]
  v_pk_mul_f32 v[210:211], v[46:47], s[10:11]
  v_exp_f32 v204, v204
  v_exp_f32 v205, v205
  v_exp_f32 v206, v206
  v_exp_f32 v207, v207
  v_exp_f32 v208, v208
  v_exp_f32 v209, v209
  v_exp_f32 v210, v210
  v_exp_f32 v211, v211
  v_pk_mul_f32 v[40:41], v[40:41], v[56:57]
  v_pk_mul_f32 v[42:43], v[42:43], v[58:59]
  v_pk_mul_f32 v[44:45], v[44:45], v[60:61]
  v_pk_mul_f32 v[46:47], v[46:47], v[62:63]
  v_pk_add_f32 v[204:205], v[204:205], 1.0 op_sel_hi:[1,0]
  v_pk_add_f32 v[206:207], v[206:207], 1.0 op_sel_hi:[1,0]
  v_pk_add_f32 v[208:209], v[208:209], 1.0 op_sel_hi:[1,0]
  v_pk_add_f32 v[210:211], v[210:211], 1.0 op_sel_hi:[1,0]
  v_rcp_f32 v204, v204
  v_rcp_f32 v205, v205
  v_rcp_f32 v206, v206
  v_rcp_f32 v207, v207
  v_rcp_f32 v208, v208
  v_rcp_f32 v209, v209
  v_rcp_f32 v210, v210
  v_rcp_f32 v211, v211
  s_nop 0
  v_pk_mul_f32 v[40:41], v[40:41], v[204:205]
  v_pk_mul_f32 v[42:43], v[42:43], v[206:207]
  v_pk_mul_f32 v[44:45], v[44:45], v[208:209]
  v_pk_mul_f32 v[46:47], v[46:47], v[210:211]
  v_cvt_pk_bf16_f32 v196, v40, v41
  v_cvt_pk_bf16_f32 v198, v44, v45
  v_cvt_pk_bf16_f32 v197, v42, v43
  v_cvt_pk_bf16_f32 v199, v46, v47
  s_nop 0
  v_permlane16_swap_b32 v196, v198
  v_permlane16_swap_b32 v197, v199
  s_barrier
  v_pk_mul_f32 v[204:205], v[64:65], s[10:11]
  v_pk_mul_f32 v[206:207], v[66:67], s[10:11]
  v_pk_mul_f32 v[208:209], v[68:69], s[10:11]
  v_pk_mul_f32 v[210:211], v[70:71], s[10:11]
  v_exp_f32 v204, v204
  v_exp_f32 v205, v205
  v_exp_f32 v206, v206
  v_exp_f32 v207, v207
  v_exp_f32 v208, v208
  v_exp_f32 v209, v209
  v_exp_f32 v210, v210
  v_exp_f32 v211, v211
  v_pk_mul_f32 v[64:65], v[64:65], v[80:81]
  v_pk_mul_f32 v[66:67], v[66:67], v[82:83]
  v_pk_mul_f32 v[68:69], v[68:69], v[84:85]
  v_pk_mul_f32 v[70:71], v[70:71], v[86:87]
  v_pk_add_f32 v[204:205], v[204:205], 1.0 op_sel_hi:[1,0]
  v_pk_add_f32 v[206:207], v[206:207], 1.0 op_sel_hi:[1,0]
  v_pk_add_f32 v[208:209], v[208:209], 1.0 op_sel_hi:[1,0]
  v_pk_add_f32 v[210:211], v[210:211], 1.0 op_sel_hi:[1,0]
  v_rcp_f32 v204, v204
  v_rcp_f32 v205, v205
  v_rcp_f32 v206, v206
  v_rcp_f32 v207, v207
  v_rcp_f32 v208, v208
  v_rcp_f32 v209, v209
  v_rcp_f32 v210, v210
  v_rcp_f32 v211, v211
  s_nop 0
  v_pk_mul_f32 v[64:65], v[64:65], v[204:205]
  v_pk_mul_f32 v[66:67], v[66:67], v[206:207]
  v_pk_mul_f32 v[68:69], v[68:69], v[208:209]
  v_pk_mul_f32 v[70:71], v[70:71], v[210:211]
  v_cvt_pk_bf16_f32 v200, v64, v65
  v_cvt_pk_bf16_f32 v202, v68, v69
  v_cvt_pk_bf16_f32 v201, v66, v67
  v_cvt_pk_bf16_f32 v203, v70, v71
  s_nop 0
  v_permlane16_swap_b32 v200, v202
  v_permlane16_swap_b32 v201, v203
  v_pk_mul_f32 v[204:205], v[72:73], s[10:11]
  v_pk_mul_f32 v[206:207], v[74:75], s[10:11]
  v_pk_mul_f32 v[208:209], v[76:77], s[10:11]
  v_pk_mul_f32 v[210:211], v[78:79], s[10:11]
  v_exp_f32 v204, v204
  v_exp_f32 v205, v205
  v_exp_f32 v206, v206
  v_exp_f32 v207, v207
  v_exp_f32 v208, v208
  v_exp_f32 v209, v209
  v_exp_f32 v210, v210
  v_exp_f32 v211, v211
  v_pk_mul_f32 v[72:73], v[72:73], v[88:89]
  v_pk_mul_f32 v[74:75], v[74:75], v[90:91]
  v_pk_mul_f32 v[76:77], v[76:77], v[92:93]
  v_pk_mul_f32 v[78:79], v[78:79], v[94:95]
  v_pk_add_f32 v[204:205], v[204:205], 1.0 op_sel_hi:[1,0]
  v_pk_add_f32 v[206:207], v[206:207], 1.0 op_sel_hi:[1,0]
  v_pk_add_f32 v[208:209], v[208:209], 1.0 op_sel_hi:[1,0]
  v_pk_add_f32 v[210:211], v[210:211], 1.0 op_sel_hi:[1,0]
  v_rcp_f32 v204, v204
  v_rcp_f32 v205, v205
  v_rcp_f32 v206, v206
  v_rcp_f32 v207, v207
  v_rcp_f32 v208, v208
  v_rcp_f32 v209, v209
  v_rcp_f32 v210, v210
  v_rcp_f32 v211, v211
  s_nop 0
  v_pk_mul_f32 v[72:73], v[72:73], v[204:205]
  v_pk_mul_f32 v[74:75], v[74:75], v[206:207]
  v_pk_mul_f32 v[76:77], v[76:77], v[208:209]
  v_pk_mul_f32 v[78:79], v[78:79], v[210:211]
  v_cvt_pk_bf16_f32 v224, v72, v73
  v_cvt_pk_bf16_f32 v226, v76, v77
  v_cvt_pk_bf16_f32 v225, v74, v75
  v_cvt_pk_bf16_f32 v227, v78, v79
  s_nop 0
  v_permlane16_swap_b32 v224, v226
  v_permlane16_swap_b32 v225, v227
  v_pk_mul_f32 v[204:205], v[96:97], s[10:11]
  v_pk_mul_f32 v[206:207], v[98:99], s[10:11]
  v_pk_mul_f32 v[208:209], v[100:101], s[10:11]
  v_pk_mul_f32 v[210:211], v[102:103], s[10:11]
  v_exp_f32 v204, v204
  v_exp_f32 v205, v205
  v_exp_f32 v206, v206
  v_exp_f32 v207, v207
  v_exp_f32 v208, v208
  v_exp_f32 v209, v209
  v_exp_f32 v210, v210
  v_exp_f32 v211, v211
  v_pk_mul_f32 v[96:97], v[96:97], v[112:113]
  v_pk_mul_f32 v[98:99], v[98:99], v[114:115]
  v_pk_mul_f32 v[100:101], v[100:101], v[116:117]
  v_pk_mul_f32 v[102:103], v[102:103], v[118:119]
  v_pk_add_f32 v[204:205], v[204:205], 1.0 op_sel_hi:[1,0]
  v_pk_add_f32 v[206:207], v[206:207], 1.0 op_sel_hi:[1,0]
  v_pk_add_f32 v[208:209], v[208:209], 1.0 op_sel_hi:[1,0]
  v_pk_add_f32 v[210:211], v[210:211], 1.0 op_sel_hi:[1,0]
  v_rcp_f32 v204, v204
  v_rcp_f32 v205, v205
  v_rcp_f32 v206, v206
  v_rcp_f32 v207, v207
  v_rcp_f32 v208, v208
  v_rcp_f32 v209, v209
  v_rcp_f32 v210, v210
  v_rcp_f32 v211, v211
  s_nop 0
  v_pk_mul_f32 v[96:97], v[96:97], v[204:205]
  v_pk_mul_f32 v[98:99], v[98:99], v[206:207]
  v_pk_mul_f32 v[100:101], v[100:101], v[208:209]
  v_pk_mul_f32 v[102:103], v[102:103], v[210:211]
  v_cvt_pk_bf16_f32 v228, v96, v97
  v_cvt_pk_bf16_f32 v230, v100, v101
  v_cvt_pk_bf16_f32 v229, v98, v99
  v_cvt_pk_bf16_f32 v231, v102, v103
  s_nop 0
  v_permlane16_swap_b32 v228, v230
  v_permlane16_swap_b32 v229, v231
  s_barrier
  v_pk_mul_f32 v[204:205], v[104:105], s[10:11]
  v_pk_mul_f32 v[206:207], v[106:107], s[10:11]
  v_pk_mul_f32 v[208:209], v[108:109], s[10:11]
  v_pk_mul_f32 v[210:211], v[110:111], s[10:11]
  v_exp_f32 v204, v204
  v_exp_f32 v205, v205
  v_exp_f32 v206, v206
  v_exp_f32 v207, v207
  v_exp_f32 v208, v208
  v_exp_f32 v209, v209
  v_exp_f32 v210, v210
  v_exp_f32 v211, v211
  v_pk_mul_f32 v[104:105], v[104:105], v[120:121]
  v_pk_mul_f32 v[106:107], v[106:107], v[122:123]
  v_pk_mul_f32 v[108:109], v[108:109], v[124:125]
  v_pk_mul_f32 v[110:111], v[110:111], v[126:127]
  v_pk_add_f32 v[204:205], v[204:205], 1.0 op_sel_hi:[1,0]
  v_pk_add_f32 v[206:207], v[206:207], 1.0 op_sel_hi:[1,0]
  v_pk_add_f32 v[208:209], v[208:209], 1.0 op_sel_hi:[1,0]
  v_pk_add_f32 v[210:211], v[210:211], 1.0 op_sel_hi:[1,0]
  v_rcp_f32 v204, v204
  v_rcp_f32 v205, v205
  v_rcp_f32 v206, v206
  v_rcp_f32 v207, v207
  v_rcp_f32 v208, v208
  v_rcp_f32 v209, v209
  v_rcp_f32 v210, v210
  v_rcp_f32 v211, v211
  s_nop 0
  v_pk_mul_f32 v[104:105], v[104:105], v[204:205]
  v_pk_mul_f32 v[106:107], v[106:107], v[206:207]
  v_pk_mul_f32 v[108:109], v[108:109], v[208:209]
  v_pk_mul_f32 v[110:111], v[110:111], v[210:211]
  v_cvt_pk_bf16_f32 v232, v104, v105
  v_cvt_pk_bf16_f32 v234, v108, v109
  v_cvt_pk_bf16_f32 v233, v106, v107
  v_cvt_pk_bf16_f32 v235, v110, v111
  s_nop 0
  v_permlane16_swap_b32 v232, v234
  v_permlane16_swap_b32 v233, v235
  v_pk_mul_f32 v[204:205], v[128:129], s[10:11]
  v_pk_mul_f32 v[206:207], v[130:131], s[10:11]
  v_pk_mul_f32 v[208:209], v[132:133], s[10:11]
  v_pk_mul_f32 v[210:211], v[134:135], s[10:11]
  v_exp_f32 v204, v204
  v_exp_f32 v205, v205
  v_exp_f32 v206, v206
  v_exp_f32 v207, v207
  v_exp_f32 v208, v208
  v_exp_f32 v209, v209
  v_exp_f32 v210, v210
  v_exp_f32 v211, v211
  v_pk_mul_f32 v[128:129], v[128:129], v[144:145]
  v_pk_mul_f32 v[130:131], v[130:131], v[146:147]
  v_pk_mul_f32 v[132:133], v[132:133], v[148:149]
  v_pk_mul_f32 v[134:135], v[134:135], v[150:151]
  v_pk_add_f32 v[204:205], v[204:205], 1.0 op_sel_hi:[1,0]
  v_pk_add_f32 v[206:207], v[206:207], 1.0 op_sel_hi:[1,0]
  v_pk_add_f32 v[208:209], v[208:209], 1.0 op_sel_hi:[1,0]
  v_pk_add_f32 v[210:211], v[210:211], 1.0 op_sel_hi:[1,0]
  v_rcp_f32 v204, v204
  v_rcp_f32 v205, v205
  v_rcp_f32 v206, v206
  v_rcp_f32 v207, v207
  v_rcp_f32 v208, v208
  v_rcp_f32 v209, v209
  v_rcp_f32 v210, v210
  v_rcp_f32 v211, v211
  s_nop 0
  v_pk_mul_f32 v[128:129], v[128:129], v[204:205]
  v_pk_mul_f32 v[130:131], v[130:131], v[206:207]
  v_pk_mul_f32 v[132:133], v[132:133], v[208:209]
  v_pk_mul_f32 v[134:135], v[134:135], v[210:211]
  v_cvt_pk_bf16_f32 v236, v128, v129
  v_cvt_pk_bf16_f32 v238, v132, v133
  v_cvt_pk_bf16_f32 v237, v130, v131
  v_cvt_pk_bf16_f32 v239, v134, v135
  s_nop 0
  v_permlane16_swap_b32 v236, v238
  v_permlane16_swap_b32 v237, v239
  v_pk_mul_f32 v[204:205], v[136:137], s[10:11]
  v_pk_mul_f32 v[206:207], v[138:139], s[10:11]
  v_pk_mul_f32 v[208:209], v[140:141], s[10:11]
  v_pk_mul_f32 v[210:211], v[142:143], s[10:11]
  v_exp_f32 v204, v204
  v_exp_f32 v205, v205
  v_exp_f32 v206, v206
  v_exp_f32 v207, v207
  v_exp_f32 v208, v208
  v_exp_f32 v209, v209
  v_exp_f32 v210, v210
  v_exp_f32 v211, v211
  v_pk_mul_f32 v[136:137], v[136:137], v[152:153]
  v_pk_mul_f32 v[138:139], v[138:139], v[154:155]
  v_pk_mul_f32 v[140:141], v[140:141], v[156:157]
  v_pk_mul_f32 v[142:143], v[142:143], v[158:159]
  v_pk_add_f32 v[204:205], v[204:205], 1.0 op_sel_hi:[1,0]
  v_pk_add_f32 v[206:207], v[206:207], 1.0 op_sel_hi:[1,0]
  v_pk_add_f32 v[208:209], v[208:209], 1.0 op_sel_hi:[1,0]
  v_pk_add_f32 v[210:211], v[210:211], 1.0 op_sel_hi:[1,0]
  v_rcp_f32 v204, v204
  v_rcp_f32 v205, v205
  v_rcp_f32 v206, v206
  v_rcp_f32 v207, v207
  v_rcp_f32 v208, v208
  v_rcp_f32 v209, v209
  v_rcp_f32 v210, v210
  v_rcp_f32 v211, v211
  s_nop 0
  v_pk_mul_f32 v[136:137], v[136:137], v[204:205]
  v_pk_mul_f32 v[138:139], v[138:139], v[206:207]
  v_pk_mul_f32 v[140:141], v[140:141], v[208:209]
  v_pk_mul_f32 v[142:143], v[142:143], v[210:211]
  v_cvt_pk_bf16_f32 v240, v136, v137
  v_cvt_pk_bf16_f32 v242, v140, v141
  v_cvt_pk_bf16_f32 v241, v138, v139
  v_cvt_pk_bf16_f32 v243, v142, v143
  s_nop 0
  v_permlane16_swap_b32 v240, v242
  v_permlane16_swap_b32 v241, v243
  buffer_store_dwordx4 v[184:187], v244, s[28:31], s58 offen offset:2048 sc1
  buffer_store_dwordx4 v[188:191], v244, s[28:31], s59 offen offset:2048 sc1
  s_barrier
  buffer_store_dwordx4 v[192:195], v244, s[28:31], s58 offen offset:3072 sc1
  buffer_store_dwordx4 v[196:199], v244, s[28:31], s59 offen offset:3072 sc1
  s_add_u32 m0, s74, 0
  s_add_u32 s70, s72, 0
  buffer_load_dwordx4 v245, s[32:35], s70 offen lds
  s_add_u32 m0, s74, 1024
  s_add_u32 s70, s70, 8192
  buffer_load_dwordx4 v245, s[32:35], s70 offen lds
  s_add_u32 m0, s74, 2048
  s_add_u32 s70, s70, 8192
  buffer_load_dwordx4 v245, s[32:35], s70 offen lds
  s_add_u32 m0, s74, 3072
  s_add_u32 s70, s70, 8192
  buffer_load_dwordx4 v245, s[32:35], s70 offen lds
  s_barrier
  s_add_u32 m0, s74, 16384
  s_add_u32 s70, s72, 458752
  buffer_load_dwordx4 v245, s[32:35], s70 offen lds
  s_add_u32 m0, s74, 17408
  s_add_u32 s70, s70, 8192
  buffer_load_dwordx4 v245, s[32:35], s70 offen lds
  s_add_u32 m0, s74, 18432
  s_add_u32 s70, s70, 8192
  buffer_load_dwordx4 v245, s[32:35], s70 offen lds
  s_add_u32 m0, s74, 19456
  s_add_u32 s70, s70, 8192
  buffer_load_dwordx4 v245, s[32:35], s70 offen lds
  s_add_u32 s3, s58, 4096
  buffer_store_dwordx4 v[200:203], v244, s[28:31], s3 offen offset:0 sc1
  s_add_u32 m0, s74, 32768
  s_add_u32 s70, s72, 917504
  buffer_load_dwordx4 v245, s[32:35], s70 offen lds
  s_add_u32 m0, s74, 33792
  s_add_u32 s70, s70, 8192
  buffer_load_dwordx4 v245, s[32:35], s70 offen lds
  s_add_u32 m0, s74, 34816
  s_add_u32 s70, s70, 8192
  buffer_load_dwordx4 v245, s[32:35], s70 offen lds
  s_add_u32 m0, s74, 35840
  s_add_u32 s70, s70, 8192
  buffer_load_dwordx4 v245, s[32:35], s70 offen lds
  s_barrier
  s_add_u32 m0, s74, 49152
  s_add_u32 s70, s72, 1376256
  buffer_load_dwordx4 v245, s[32:35], s70 offen lds
  s_add_u32 m0, s74, 50176
  s_add_u32 s70, s70, 8192
  buffer_load_dwordx4 v245, s[32:35], s70 offen lds
  s_add_u32 m0, s74, 51200
  s_add_u32 s70, s70, 8192
  buffer_load_dwordx4 v245, s[32:35], s70 offen lds
  s_add_u32 m0, s74, 52224
  s_add_u32 s70, s70, 8192
  buffer_load_dwordx4 v245, s[32:35], s70 offen lds
  s_add_u32 m0, s74, 65536
  s_add_u32 s70, s72, 1835008
  buffer_load_dwordx4 v245, s[32:35], s70 offen lds
  s_add_u32 m0, s74, 66560
  s_add_u32 s70, s70, 8192
  buffer_load_dwordx4 v245, s[32:35], s70 offen lds
  s_add_u32 m0, s74, 67584
  s_add_u32 s70, s70, 8192
  buffer_load_dwordx4 v245, s[32:35], s70 offen lds
  s_add_u32 m0, s74, 68608
  s_add_u32 s70, s70, 8192
  buffer_load_dwordx4 v245, s[32:35], s70 offen lds
  s_barrier
  s_waitcnt vmcnt(21)
  v_mov_b32 v250, s54
  v_mov_b32 v251, s55
  s_mov_b64 exec, 1
  buffer_store_dwordx2 v[250:251], off, s[44:47], s77 sc1
  s_mov_b64 exec, -1
  s_add_u32 s77, s77, 8192
  s_add_u32 m0, s74, 81920
  s_add_u32 s70, s72, 2293760
  buffer_load_dwordx4 v245, s[32:35], s70 offen lds
  s_add_u32 m0, s74, 82944
  s_add_u32 s70, s70, 8192
  buffer_load_dwordx4 v245, s[32:35], s70 offen lds
  s_add_u32 m0, s74, 83968
  s_add_u32 s70, s70, 8192
  buffer_load_dwordx4 v245, s[32:35], s70 offen lds
  s_add_u32 m0, s74, 84992
  s_add_u32 s70, s70, 8192
  buffer_load_dwordx4 v245, s[32:35], s70 offen lds
  s_barrier
  buffer_load_dwordx2 v[248:249], v252, s[44:47], s73 offen sc1
  s_barrier
  s_waitcnt vmcnt(0)
  v_cmp_eq_u64 vcc, s[54:55], v[248:249]
  s_cmp_eq_u64 vcc, -1
  s_cbranch_scc0 L_waith0
L_waith0_ret:
  s_add_u32 s69, s49, 0
  s_add_u32 s71, s69, s50
  buffer_load_dwordx4 v[128:131], v244, s[24:27], s69 offen offset:0 sc1
  buffer_load_dwordx4 v[132:135], v244, s[24:27], s71 offen offset:0 sc1
  buffer_load_dwordx4 v[136:139], v244, s[24:27], s69 offen offset:1024 sc1
  buffer_load_dwordx4 v[140:143], v244, s[24:27], s71 offen offset:1024 sc1
  s_add_u32 s69, s49, 14336
  s_add_u32 s71, s69, s50
  buffer_load_dwordx4 v[144:147], v244, s[24:27], s69 offen offset:0 sc1
  buffer_load_dwordx4 v[148:151], v244, s[24:27], s71 offen offset:0 sc1
  buffer_load_dwordx4 v[152:155], v244, s[24:27], s69 offen offset:1024 sc1
  buffer_load_dwordx4 v[156:159], v244, s[24:27], s71 offen offset:1024 sc1
  s_add_u32 s69, s49, 28672
  s_add_u32 s71, s69, s50
  buffer_load_dwordx4 v[160:163], v244, s[24:27], s69 offen offset:0 sc1
  buffer_load_dwordx4 v[164:167], v244, s[24:27], s71 offen offset:0 sc1
  buffer_load_dwordx4 v[168:171], v244, s[24:27], s69 offen offset:1024 sc1
  buffer_load_dwordx4 v[172:175], v244, s[24:27], s71 offen offset:1024 sc1
  s_add_u32 s69, s49, 43008
  s_add_u32 s71, s69, s50
  buffer_load_dwordx4 v[176:179], v244, s[24:27], s69 offen offset:0 sc1
  buffer_load_dwordx4 v[180:183], v244, s[24:27], s71 offen offset:0 sc1
  s_barrier
  ds_read_b64_tr_b16 v[184:185], v216 offset:0
  ds_read_b64_tr_b16 v[186:187], v216 offset:1024
  ds_read_b64_tr_b16 v[188:189], v217 offset:0
  ds_read_b64_tr_b16 v[190:191], v217 offset:1024
  ds_read_b64_tr_b16 v[192:193], v218 offset:0
  ds_read_b64_tr_b16 v[194:195], v218 offset:1024
  ds_read_b64_tr_b16 v[196:197], v219 offset:0
  ds_read_b64_tr_b16 v[198:199], v219 offset:1024
  s_waitcnt vmcnt(12)
  s_waitcnt lgkmcnt(0)
  v_mfma_f32_32x32x16_bf16 v[0:15], v[184:187], v[128:131], 0
  ds_read_b64_tr_b16 v[200:201], v216 offset:4096
  ds_read_b64_tr_b16 v[202:203], v216 offset:5120
  v_mfma_f32_32x32x16_bf16 v[16:31], v[188:191], v[128:131], 0
  ds_read_b64_tr_b16 v[204:205], v217 offset:4096
  ds_read_b64_tr_b16 v[206:207], v217 offset:5120
  v_mfma_f32_32x32x16_bf16 v[32:47], v[192:195], v[128:131], 0
  ds_read_b64_tr_b16 v[208:209], v218 offset:4096
  ds_read_b64_tr_b16 v[210:211], v218 offset:5120
  v_mfma_f32_32x32x16_bf16 v[48:63], v[196:199], v[128:131], 0
  ds_read_b64_tr_b16 v[212:213], v219 offset:4096
  ds_read_b64_tr_b16 v[214:215], v219 offset:5120
  buffer_load_dwordx4 v[128:131], v244, s[24:27], s69 offen offset:1024 sc1
  v_mfma_f32_32x32x16_bf16 v[64:79], v[184:187], v[132:135], 0
  v_mfma_f32_32x32x16_bf16 v[80:95], v[188:191], v[132:135], 0
  v_mfma_f32_32x32x16_bf16 v[96:111], v[192:195], v[132:135], 0
  v_mfma_f32_32x32x16_bf16 v[112:127], v[196:199], v[132:135], 0
  buffer_load_dwordx4 v[132:135], v244, s[24:27], s71 offen offset:1024 sc1
  s_barrier
  s_waitcnt vmcnt(12)
  s_waitcnt lgkmcnt(0)
  v_mfma_f32_32x32x16_bf16 v[0:15], v[200:203], v[136:139], v[0:15]
  ds_read_b64_tr_b16 v[184:185], v216 offset:16384
  ds_read_b64_tr_b16 v[186:187], v216 offset:17408
  v_mfma_f32_32x32x16_bf16 v[16:31], v[204:207], v[136:139], v[16:31]
  ds_read_b64_tr_b16 v[188:189], v217 offset:16384
  ds_read_b64_tr_b16 v[190:191], v217 offset:17408
  s_add_u32 s69, s49, 57344
  v_mfma_f32_32x32x16_bf16 v[32:47], v[208:211], v[136:139], v[32:47]
  ds_read_b64_tr_b16 v[192:193], v218 offset:16384
  ds_read_b64_tr_b16 v[194:195], v218 offset:17408
  s_add_u32 s71, s69, s50
  v_mfma_f32_32x32x16_bf16 v[48:63], v[212:215], v[136:139], v[48:63]
  ds_read_b64_tr_b16 v[196:197], v219 offset:16384
  ds_read_b64_tr_b16 v[198:199], v219 offset:17408
  buffer_load_dwordx4 v[136:139], v244, s[24:27], s69 offen offset:0 sc1
  v_mfma_f32_32x32x16_bf16 v[64:79], v[200:203], v[140:143], v[64:79]
  s_add_u32 s70, s72, 2752512
  s_add_u32 m0, s74, 98304
  s_add_u32 s3, s59, 4096
  buffer_store_dwordx4 v[224:227], v244, s[28:31], s3 offen offset:0 sc1
  v_mfma_f32_32x32x16_bf16 v[80:95], v[204:207], v[140:143], v[80:95]
  buffer_load_dwordx4 v245, s[32:35], s70 offen lds
  s_add_u32 s70, s70, 8192
  s_add_u32 m0, s74, 99328
  v_mfma_f32_32x32x16_bf16 v[96:111], v[208:211], v[140:143], v[96:111]
  buffer_load_dwordx4 v245, s[32:35], s70 offen lds
  v_mfma_f32_32x32x16_bf16 v[112:127], v[212:215], v[140:143], v[112:127]
  buffer_load_dwordx4 v[140:143], v244, s[24:27], s71 offen offset:0 sc1
  s_waitcnt vmcnt(15)
  s_waitcnt lgkmcnt(0)
  v_mfma_f32_32x32x16_bf16 v[0:15], v[184:187], v[144:147], v[0:15]
  ds_read_b64_tr_b16 v[200:201], v216 offset:20480
  ds_read_b64_tr_b16 v[202:203], v216 offset:21504
  v_mfma_f32_32x32x16_bf16 v[16:31], v[188:191], v[144:147], v[16:31]
  ds_read_b64_tr_b16 v[204:205], v217 offset:20480
  ds_read_b64_tr_b16 v[206:207], v217 offset:21504
  v_mfma_f32_32x32x16_bf16 v[32:47], v[192:195], v[144:147], v[32:47]
  ds_read_b64_tr_b16 v[208:209], v218 offset:20480
  ds_read_b64_tr_b16 v[210:211], v218 offset:21504
  v_mfma_f32_32x32x16_bf16 v[48:63], v[196:199], v[144:147], v[48:63]
  ds_read_b64_tr_b16 v[212:213], v219 offset:20480
  ds_read_b64_tr_b16 v[214:215], v219 offset:21504
  buffer_load_dwordx4 v[144:147], v244, s[24:27], s69 offen offset:1024 sc1
  v_mfma_f32_32x32x16_bf16 v[64:79], v[184:187], v[148:151], v[64:79]
  s_add_u32 s70, s70, 8192
  s_add_u32 m0, s74, 100352
  v_mfma_f32_32x32x16_bf16 v[80:95], v[188:191], v[148:151], v[80:95]
  buffer_load_dwordx4 v245, s[32:35], s70 offen lds
  s_add_u32 s70, s70, 8192
  s_add_u32 m0, s74, 101376
  v_mfma_f32_32x32x16_bf16 v[96:111], v[192:195], v[148:151], v[96:111]
  buffer_load_dwordx4 v245, s[32:35], s70 offen lds
  v_mfma_f32_32x32x16_bf16 v[112:127], v[196:199], v[148:151], v[112:127]
  buffer_load_dwordx4 v[148:151], v244, s[24:27], s71 offen offset:1024 sc1
  s_barrier
  s_waitcnt vmcnt(17)
  s_waitcnt lgkmcnt(0)
  v_mfma_f32_32x32x16_bf16 v[0:15], v[200:203], v[152:155], v[0:15]
  ds_read_b64_tr_b16 v[184:185], v216 offset:32768
  ds_read_b64_tr_b16 v[186:187], v216 offset:33792
  v_mfma_f32_32x32x16_bf16 v[16:31], v[204:207], v[152:155], v[16:31]
  ds_read_b64_tr_b16 v[188:189], v217 offset:32768
  ds_read_b64_tr_b16 v[190:191], v217 offset:33792
  s_add_u32 s69, s49, 71680
  v_mfma_f32_32x32x16_bf16 v[32:47], v[208:211], v[152:155], v[32:47]
  ds_read_b64_tr_b16 v[192:193], v218 offset:32768
  ds_read_b64_tr_b16 v[194:195], v218 offset:33792
  s_add_u32 s71, s69, s50
  v_mfma_f32_32x32x16_bf16 v[48:63], v[212:215], v[152:155], v[48:63]
  ds_read_b64_tr_b16 v[196:197], v219 offset:32768
  ds_read_b64_tr_b16 v[198:199], v219 offset:33792
  buffer_load_dwordx4 v[152:155], v244, s[24:27], s69 offen offset:0 sc1
  v_mfma_f32_32x32x16_bf16 v[64:79], v[200:203], v[156:159], v[64:79]
  s_add_u32 s70, s72, 3211264
  s_add_u32 m0, s74, 0
  s_add_u32 s3, s58, 4096
  buffer_store_dwordx4 v[228:231], v244, s[28:31], s3 offen offset:1024 sc1
  v_mfma_f32_32x32x16_bf16 v[80:95], v[204:207], v[156:159], v[80:95]
  buffer_load_dwordx4 v245, s[32:35], s70 offen lds
  s_add_u32 s70, s70, 8192
  s_add_u32 m0, s74, 1024
  v_mfma_f32_32x32x16_bf16 v[96:111], v[208:211], v[156:159], v[96:111]
  buffer_load_dwordx4 v245, s[32:35], s70 offen lds
  v_mfma_f32_32x32x16_bf16 v[112:127], v[212:215], v[156:159], v[112:127]
  buffer_load_dwordx4 v[156:159], v244, s[24:27], s71 offen offset:0 sc1
  s_waitcnt vmcnt(20)
  s_waitcnt lgkmcnt(0)
  v_mfma_f32_32x32x16_bf16 v[0:15], v[184:187], v[160:163], v[0:15]
  ds_read_b64_tr_b16 v[200:201], v216 offset:36864
  ds_read_b64_tr_b16 v[202:203], v216 offset:37888
  v_mfma_f32_32x32x16_bf16 v[16:31], v[188:191], v[160:163], v[16:31]
  ds_read_b64_tr_b16 v[204:205], v217 offset:36864
  ds_read_b64_tr_b16 v[206:207], v217 offset:37888
  v_mfma_f32_32x32x16_bf16 v[32:47], v[192:195], v[160:163], v[32:47]
  ds_read_b64_tr_b16 v[208:209], v218 offset:36864
  ds_read_b64_tr_b16 v[210:211], v218 offset:37888
  v_mfma_f32_32x32x16_bf16 v[48:63], v[196:199], v[160:163], v[48:63]
  ds_read_b64_tr_b16 v[212:213], v219 offset:36864
  ds_read_b64_tr_b16 v[214:215], v219 offset:37888
  buffer_load_dwordx4 v[160:163], v244, s[24:27], s69 offen offset:1024 sc1
  v_mfma_f32_32x32x16_bf16 v[64:79], v[184:187], v[164:167], v[64:79]
  s_add_u32 s70, s70, 8192
  s_add_u32 m0, s74, 2048
  v_mfma_f32_32x32x16_bf16 v[80:95], v[188:191], v[164:167], v[80:95]
  buffer_load_dwordx4 v245, s[32:35], s70 offen lds
  s_add_u32 s70, s70, 8192
  s_add_u32 m0, s74, 3072
  v_mfma_f32_32x32x16_bf16 v[96:111], v[192:195], v[164:167], v[96:111]
  buffer_load_dwordx4 v245, s[32:35], s70 offen lds
  v_mfma_f32_32x32x16_bf16 v[112:127], v[196:199], v[164:167], v[112:127]
  buffer_load_dwordx4 v[164:167], v244, s[24:27], s71 offen offset:1024 sc1
  s_add_u32 s73, s73, 8192
  buffer_load_dwordx2 v[248:249], v252, s[44:47], s73 offen sc1
  s_barrier
  s_waitcnt vmcnt(23)
  s_waitcnt lgkmcnt(0)
  v_mfma_f32_32x32x16_bf16 v[0:15], v[200:203], v[168:171], v[0:15]
  ds_read_b64_tr_b16 v[184:185], v216 offset:49152
  ds_read_b64_tr_b16 v[186:187], v216 offset:50176
  v_mfma_f32_32x32x16_bf16 v[16:31], v[204:207], v[168:171], v[16:31]
  ds_read_b64_tr_b16 v[188:189], v217 offset:49152
  ds_read_b64_tr_b16 v[190:191], v217 offset:50176
  s_add_u32 s69, s49, 86016
  v_mfma_f32_32x32x16_bf16 v[32:47], v[208:211], v[168:171], v[32:47]
  ds_read_b64_tr_b16 v[192:193], v218 offset:49152
  ds_read_b64_tr_b16 v[194:195], v218 offset:50176
  s_add_u32 s71, s69, s50
  v_mfma_f32_32x32x16_bf16 v[48:63], v[212:215], v[168:171], v[48:63]
  ds_read_b64_tr_b16 v[196:197], v219 offset:49152
  ds_read_b64_tr_b16 v[198:199], v219 offset:50176
  buffer_load_dwordx4 v[168:171], v244, s[24:27], s69 offen offset:0 sc1
  v_mfma_f32_32x32x16_bf16 v[64:79], v[200:203], v[172:175], v[64:79]
  s_add_u32 s70, s72, 65536
  s_add_u32 m0, s74, 16384
  s_add_u32 s3, s59, 4096
  buffer_store_dwordx4 v[232:235], v244, s[28:31], s3 offen offset:1024 sc1
  v_mfma_f32_32x32x16_bf16 v[80:95], v[204:207], v[172:175], v[80:95]
  buffer_load_dwordx4 v245, s[32:35], s70 offen lds
  s_add_u32 s70, s70, 8192
  s_add_u32 m0, s74, 17408
  v_mfma_f32_32x32x16_bf16 v[96:111], v[208:211], v[172:175], v[96:111]
  buffer_load_dwordx4 v245, s[32:35], s70 offen lds
  v_mfma_f32_32x32x16_bf16 v[112:127], v[212:215], v[172:175], v[112:127]
  buffer_load_dwordx4 v[172:175], v244, s[24:27], s71 offen offset:0 sc1
  s_waitcnt vmcnt(26)
  s_waitcnt lgkmcnt(0)
  v_mfma_f32_32x32x16_bf16 v[0:15], v[184:187], v[176:179], v[0:15]
  ds_read_b64_tr_b16 v[200:201], v216 offset:53248
  ds_read_b64_tr_b16 v[202:203], v216 offset:54272
  v_mfma_f32_32x32x16_bf16 v[16:31], v[188:191], v[176:179], v[16:31]
  ds_read_b64_tr_b16 v[204:205], v217 offset:53248
  ds_read_b64_tr_b16 v[206:207], v217 offset:54272
  v_mfma_f32_32x32x16_bf16 v[32:47], v[192:195], v[176:179], v[32:47]
  ds_read_b64_tr_b16 v[208:209], v218 offset:53248
  ds_read_b64_tr_b16 v[210:211], v218 offset:54272
  v_mfma_f32_32x32x16_bf16 v[48:63], v[196:199], v[176:179], v[48:63]
  ds_read_b64_tr_b16 v[212:213], v219 offset:53248
  ds_read_b64_tr_b16 v[214:215], v219 offset:54272
  buffer_load_dwordx4 v[176:179], v244, s[24:27], s69 offen offset:1024 sc1
  v_mfma_f32_32x32x16_bf16 v[64:79], v[184:187], v[180:183], v[64:79]
  s_add_u32 s70, s70, 8192
  s_add_u32 m0, s74, 18432
  v_mfma_f32_32x32x16_bf16 v[80:95], v[188:191], v[180:183], v[80:95]
  buffer_load_dwordx4 v245, s[32:35], s70 offen lds
  s_add_u32 s70, s70, 8192
  s_add_u32 m0, s74, 19456
  v_mfma_f32_32x32x16_bf16 v[96:111], v[192:195], v[180:183], v[96:111]
  buffer_load_dwordx4 v245, s[32:35], s70 offen lds
  v_mfma_f32_32x32x16_bf16 v[112:127], v[196:199], v[180:183], v[112:127]
  buffer_load_dwordx4 v[180:183], v244, s[24:27], s71 offen offset:1024 sc1
  s_barrier
  s_waitcnt vmcnt(28)
  s_waitcnt lgkmcnt(0)
  v_mfma_f32_32x32x16_bf16 v[0:15], v[200:203], v[128:131], v[0:15]
  ds_read_b64_tr_b16 v[184:185], v220 offset:0
  ds_read_b64_tr_b16 v[186:187], v220 offset:1024
  v_mfma_f32_32x32x16_bf16 v[16:31], v[204:207], v[128:131], v[16:31]
  ds_read_b64_tr_b16 v[188:189], v221 offset:0
  ds_read_b64_tr_b16 v[190:191], v221 offset:1024
  s_add_u32 s69, s49, 100352
  v_mfma_f32_32x32x16_bf16 v[32:47], v[208:211], v[128:131], v[32:47]
  ds_read_b64_tr_b16 v[192:193], v222 offset:0
  ds_read_b64_tr_b16 v[194:195], v222 offset:1024
  s_add_u32 s71, s69, s50
  v_mfma_f32_32x32x16_bf16 v[48:63], v[212:215], v[128:131], v[48:63]
  ds_read_b64_tr_b16 v[196:197], v223 offset:0
  ds_read_b64_tr_b16 v[198:199], v223 offset:1024
  buffer_load_dwordx4 v[128:131], v244, s[24:27], s69 offen offset:0 sc1
  v_mfma_f32_32x32x16_bf16 v[64:79], v[200:203], v[132:135], v[64:79]
  s_add_u32 s70, s72, 524288
  s_add_u32 m0, s74, 32768
  s_add_u32 s3, s58, 4096
  buffer_store_dwordx4 v[236:239], v244, s[28:31], s3 offen offset:2048 sc1
  v_mfma_f32_32x32x16_bf16 v[80:95], v[204:207], v[132:135], v[80:95]
  buffer_load_dwordx4 v245, s[32:35], s70 offen lds
  s_add_u32 s70, s70, 8192
  s_add_u32 m0, s74, 33792
  v_mfma_f32_32x32x16_bf16 v[96:111], v[208:211], v[132:135], v[96:111]
  buffer_load_dwordx4 v245, s[32:35], s70 offen lds
  v_mfma_f32_32x32x16_bf16 v[112:127], v[212:215], v[132:135], v[112:127]
  buffer_load_dwordx4 v[132:135], v244, s[24:27], s71 offen offset:0 sc1
  s_waitcnt vmcnt(28)
  s_waitcnt lgkmcnt(0)
  v_mfma_f32_32x32x16_bf16 v[0:15], v[184:187], v[136:139], v[0:15]
  ds_read_b64_tr_b16 v[200:201], v220 offset:4096
  ds_read_b64_tr_b16 v[202:203], v220 offset:5120
  v_mfma_f32_32x32x16_bf16 v[16:31], v[188:191], v[136:139], v[16:31]
  ds_read_b64_tr_b16 v[204:205], v221 offset:4096
  ds_read_b64_tr_b16 v[206:207], v221 offset:5120
  v_mfma_f32_32x32x16_bf16 v[32:47], v[192:195], v[136:139], v[32:47]
  ds_read_b64_tr_b16 v[208:209], v222 offset:4096
  ds_read_b64_tr_b16 v[210:211], v222 offset:5120
  v_mfma_f32_32x32x16_bf16 v[48:63], v[196:199], v[136:139], v[48:63]
  ds_read_b64_tr_b16 v[212:213], v223 offset:4096
  ds_read_b64_tr_b16 v[214:215], v223 offset:5120
  buffer_load_dwordx4 v[136:139], v244, s[24:27], s69 offen offset:1024 sc1
  v_mfma_f32_32x32x16_bf16 v[64:79], v[184:187], v[140:143], v[64:79]
  s_add_u32 s70, s70, 8192
  s_add_u32 m0, s74, 34816
  v_mfma_f32_32x32x16_bf16 v[80:95], v[188:191], v[140:143], v[80:95]
  buffer_load_dwordx4 v245, s[32:35], s70 offen lds
  s_add_u32 s70, s70, 8192
  s_add_u32 m0, s74, 35840
  v_mfma_f32_32x32x16_bf16 v[96:111], v[192:195], v[140:143], v[96:111]
  buffer_load_dwordx4 v245, s[32:35], s70 offen lds
  v_mfma_f32_32x32x16_bf16 v[112:127], v[196:199], v[140:143], v[112:127]
  buffer_load_dwordx4 v[140:143], v244, s[24:27], s71 offen offset:1024 sc1
  s_barrier
  s_waitcnt vmcnt(18)
  v_cmp_eq_u64 vcc, s[54:55], v[248:249]
  s_cmp_eq_u64 vcc, -1
  s_cbranch_scc0 L_waith9
L_waith9_ret:
  s_waitcnt lgkmcnt(0)
  v_mfma_f32_32x32x16_bf16 v[0:15], v[200:203], v[144:147], v[0:15]
  ds_read_b64_tr_b16 v[184:185], v220 offset:16384
  ds_read_b64_tr_b16 v[186:187], v220 offset:17408
  v_mfma_f32_32x32x16_bf16 v[16:31], v[204:207], v[144:147], v[16:31]
  ds_read_b64_tr_b16 v[188:189], v221 offset:16384
  ds_read_b64_tr_b16 v[190:191], v221 offset:17408
  s_add_u32 s69, s49, 2048
  v_mfma_f32_32x32x16_bf16 v[32:47], v[208:211], v[144:147], v[32:47]
  ds_read_b64_tr_b16 v[192:193], v222 offset:16384
  ds_read_b64_tr_b16 v[194:195], v222 offset:17408
  s_add_u32 s71, s69, s50
  v_mfma_f32_32x32x16_bf16 v[48:63], v[212:215], v[144:147], v[48:63]
  ds_read_b64_tr_b16 v[196:197], v223 offset:16384
  ds_read_b64_tr_b16 v[198:199], v223 offset:17408
  buffer_load_dwordx4 v[144:147], v244, s[24:27], s69 offen offset:0 sc1
  v_mfma_f32_32x32x16_bf16 v[64:79], v[200:203], v[148:151], v[64:79]
  s_add_u32 s70, s72, 983040
  s_add_u32 m0, s74, 49152
  s_add_u32 s3, s59, 4096
  buffer_store_dwordx4 v[240:243], v244, s[28:31], s3 offen offset:2048 sc1
  v_mfma_f32_32x32x16_bf16 v[80:95], v[204:207], v[148:151], v[80:95]
  buffer_load_dwordx4 v245, s[32:35], s70 offen lds
  s_add_u32 s70, s70, 8192
  s_add_u32 m0, s74, 50176
  v_mfma_f32_32x32x16_bf16 v[96:111], v[208:211], v[148:151], v[96:111]
  buffer_load_dwordx4 v245, s[32:35], s70 offen lds
  v_mfma_f32_32x32x16_bf16 v[112:127], v[212:215], v[148:151], v[112:127]
  buffer_load_dwordx4 v[148:151], v244, s[24:27], s71 offen offset:0 sc1
  s_waitcnt lgkmcnt(0)
  v_mfma_f32_32x32x16_bf16 v[0:15], v[184:187], v[152:155], v[0:15]
  ds_read_b64_tr_b16 v[200:201], v220 offset:20480
  ds_read_b64_tr_b16 v[202:203], v220 offset:21504
  v_mfma_f32_32x32x16_bf16 v[16:31], v[188:191], v[152:155], v[16:31]
  ds_read_b64_tr_b16 v[204:205], v221 offset:20480
  ds_read_b64_tr_b16 v[206:207], v221 offset:21504
  v_mfma_f32_32x32x16_bf16 v[32:47], v[192:195], v[152:155], v[32:47]
  ds_read_b64_tr_b16 v[208:209], v222 offset:20480
  ds_read_b64_tr_b16 v[210:211], v222 offset:21504
  v_mfma_f32_32x32x16_bf16 v[48:63], v[196:199], v[152:155], v[48:63]
  ds_read_b64_tr_b16 v[212:213], v223 offset:20480
  ds_read_b64_tr_b16 v[214:215], v223 offset:21504
  buffer_load_dwordx4 v[152:155], v244, s[24:27], s69 offen offset:1024 sc1
  v_mfma_f32_32x32x16_bf16 v[64:79], v[184:187], v[156:159], v[64:79]
  s_add_u32 s70, s70, 8192
  s_add_u32 m0, s74, 51200
  v_mfma_f32_32x32x16_bf16 v[80:95], v[188:191], v[156:159], v[80:95]
  buffer_load_dwordx4 v245, s[32:35], s70 offen lds
  s_add_u32 s70, s70, 8192
  s_add_u32 m0, s74, 52224
  v_mfma_f32_32x32x16_bf16 v[96:111], v[192:195], v[156:159], v[96:111]
  buffer_load_dwordx4 v245, s[32:35], s70 offen lds
  v_mfma_f32_32x32x16_bf16 v[112:127], v[196:199], v[156:159], v[112:127]
  buffer_load_dwordx4 v[156:159], v244, s[24:27], s71 offen offset:1024 sc1
  s_barrier
  s_waitcnt lgkmcnt(0)
  v_mfma_f32_32x32x16_bf16 v[0:15], v[200:203], v[160:163], v[0:15]
  ds_read_b64_tr_b16 v[184:185], v220 offset:32768
  ds_read_b64_tr_b16 v[186:187], v220 offset:33792
  v_mfma_f32_32x32x16_bf16 v[16:31], v[204:207], v[160:163], v[16:31]
  ds_read_b64_tr_b16 v[188:189], v221 offset:32768
  ds_read_b64_tr_b16 v[190:191], v221 offset:33792
  s_add_u32 s69, s49, 16384
  v_mfma_f32_32x32x16_bf16 v[32:47], v[208:211], v[160:163], v[32:47]
  ds_read_b64_tr_b16 v[192:193], v222 offset:32768
  ds_read_b64_tr_b16 v[194:195], v222 offset:33792
  s_add_u32 s71, s69, s50
  v_mfma_f32_32x32x16_bf16 v[48:63], v[212:215], v[160:163], v[48:63]
  ds_read_b64_tr_b16 v[196:197], v223 offset:32768
  ds_read_b64_tr_b16 v[198:199], v223 offset:33792
  buffer_load_dwordx4 v[160:163], v244, s[24:27], s69 offen offset:0 sc1
  v_mfma_f32_32x32x16_bf16 v[64:79], v[200:203], v[164:167], v[64:79]
  s_add_u32 s70, s72, 1441792
  s_add_u32 m0, s74, 65536
  v_mfma_f32_32x32x16_bf16 v[80:95], v[204:207], v[164:167], v[80:95]
  buffer_load_dwordx4 v245, s[32:35], s70 offen lds
  s_add_u32 s70, s70, 8192
  s_add_u32 m0, s74, 66560
  v_mfma_f32_32x32x16_bf16 v[96:111], v[208:211], v[164:167], v[96:111]
  buffer_load_dwordx4 v245, s[32:35], s70 offen lds
  v_mfma_f32_32x32x16_bf16 v[112:127], v[212:215], v[164:167], v[112:127]
  buffer_load_dwordx4 v[164:167], v244, s[24:27], s71 offen offset:0 sc1
  s_waitcnt vmcnt(26)
  s_waitcnt lgkmcnt(0)
  v_mfma_f32_32x32x16_bf16 v[0:15], v[184:187], v[168:171], v[0:15]
  ds_read_b64_tr_b16 v[200:201], v220 offset:36864
  ds_read_b64_tr_b16 v[202:203], v220 offset:37888
  v_mfma_f32_32x32x16_bf16 v[16:31], v[188:191], v[168:171], v[16:31]
  ds_read_b64_tr_b16 v[204:205], v221 offset:36864
  ds_read_b64_tr_b16 v[206:207], v221 offset:37888
  v_mfma_f32_32x32x16_bf16 v[32:47], v[192:195], v[168:171], v[32:47]
  ds_read_b64_tr_b16 v[208:209], v222 offset:36864
  ds_read_b64_tr_b16 v[210:211], v222 offset:37888
  v_mfma_f32_32x32x16_bf16 v[48:63], v[196:199], v[168:171], v[48:63]
  ds_read_b64_tr_b16 v[212:213], v223 offset:36864
  ds_read_b64_tr_b16 v[214:215], v223 offset:37888
  buffer_load_dwordx4 v[168:171], v244, s[24:27], s69 offen offset:1024 sc1
  v_mfma_f32_32x32x16_bf16 v[64:79], v[184:187], v[172:175], v[64:79]
  s_add_u32 s70, s70, 8192
  s_add_u32 m0, s74, 67584
  v_mfma_f32_32x32x16_bf16 v[80:95], v[188:191], v[172:175], v[80:95]
  buffer_load_dwordx4 v245, s[32:35], s70 offen lds
  s_add_u32 s70, s70, 8192
  s_add_u32 m0, s74, 68608
  v_mfma_f32_32x32x16_bf16 v[96:111], v[192:195], v[172:175], v[96:111]
  buffer_load_dwordx4 v245, s[32:35], s70 offen lds
  v_mfma_f32_32x32x16_bf16 v[112:127], v[196:199], v[172:175], v[112:127]
  buffer_load_dwordx4 v[172:175], v244, s[24:27], s71 offen offset:1024 sc1
  s_waitcnt vmcnt(15)
  v_mov_b32 v248, s54
  v_mov_b32 v249, s55
  s_mov_b64 exec, 1
  buffer_store_dwordx2 v[248:249], off, s[44:47], s77 sc1
  s_mov_b64 exec, -1
  s_barrier
  s_waitcnt lgkmcnt(0)
  v_mfma_f32_32x32x16_bf16 v[0:15], v[200:203], v[176:179], v[0:15]
  ds_read_b64_tr_b16 v[184:185], v216 offset:0
  ds_read_b64_tr_b16 v[186:187], v216 offset:1024
  v_mfma_f32_32x32x16_bf16 v[16:31], v[204:207], v[176:179], v[16:31]
  ds_read_b64_tr_b16 v[188:189], v217 offset:0
  ds_read_b64_tr_b16 v[190:191], v217 offset:1024
  s_add_u32 s69, s49, 30720
  v_mfma_f32_32x32x16_bf16 v[32:47], v[208:211], v[176:179], v[32:47]
  ds_read_b64_tr_b16 v[192:193], v218 offset:0
  ds_read_b64_tr_b16 v[194:195], v218 offset:1024
  s_add_u32 s71, s69, s50
  v_mfma_f32_32x32x16_bf16 v[48:63], v[212:215], v[176:179], v[48:63]
  ds_read_b64_tr_b16 v[196:197], v219 offset:0
  ds_read_b64_tr_b16 v[198:199], v219 offset:1024
  buffer_load_dwordx4 v[176:179], v244, s[24:27], s69 offen offset:0 sc1
  v_mfma_f32_32x32x16_bf16 v[64:79], v[200:203], v[180:183], v[64:79]
  s_add_u32 s70, s72, 1900544
  s_add_u32 m0, s74, 81920
  v_mfma_f32_32x32x16_bf16 v[80:95], v[204:207], v[180:183], v[80:95]
  buffer_load_dwordx4 v245, s[32:35], s70 offen lds
  s_add_u32 s70, s70, 8192
  s_add_u32 m0, s74, 82944
  v_mfma_f32_32x32x16_bf16 v[96:111], v[208:211], v[180:183], v[96:111]
  buffer_load_dwordx4 v245, s[32:35], s70 offen lds
  v_mfma_f32_32x32x16_bf16 v[112:127], v[212:215], v[180:183], v[112:127]
  buffer_load_dwordx4 v[180:183], v244, s[24:27], s71 offen offset:0 sc1
  s_waitcnt lgkmcnt(0)
  v_mfma_f32_32x32x16_bf16 v[0:15], v[184:187], v[128:131], v[0:15]
  ds_read_b64_tr_b16 v[200:201], v216 offset:4096
  ds_read_b64_tr_b16 v[202:203], v216 offset:5120
  v_mfma_f32_32x32x16_bf16 v[16:31], v[188:191], v[128:131], v[16:31]
  ds_read_b64_tr_b16 v[204:205], v217 offset:4096
  ds_read_b64_tr_b16 v[206:207], v217 offset:5120
  v_mfma_f32_32x32x16_bf16 v[32:47], v[192:195], v[128:131], v[32:47]
  ds_read_b64_tr_b16 v[208:209], v218 offset:4096
  ds_read_b64_tr_b16 v[210:211], v218 offset:5120
  v_mfma_f32_32x32x16_bf16 v[48:63], v[196:199], v[128:131], v[48:63]
  ds_read_b64_tr_b16 v[212:213], v219 offset:4096
  ds_read_b64_tr_b16 v[214:215], v219 offset:5120
  buffer_load_dwordx4 v[128:131], v244, s[24:27], s69 offen offset:1024 sc1
  v_mfma_f32_32x32x16_bf16 v[64:79], v[184:187], v[132:135], v[64:79]
  s_add_u32 s70, s70, 8192
  s_add_u32 m0, s74, 83968
  v_mfma_f32_32x32x16_bf16 v[80:95], v[188:191], v[132:135], v[80:95]
  buffer_load_dwordx4 v245, s[32:35], s70 offen lds
  s_add_u32 s70, s70, 8192
  s_add_u32 m0, s74, 84992
  v_mfma_f32_32x32x16_bf16 v[96:111], v[192:195], v[132:135], v[96:111]
  buffer_load_dwordx4 v245, s[32:35], s70 offen lds
  v_mfma_f32_32x32x16_bf16 v[112:127], v[196:199], v[132:135], v[112:127]
  buffer_load_dwordx4 v[132:135], v244, s[24:27], s71 offen offset:1024 sc1
  s_barrier
  s_waitcnt lgkmcnt(0)
  v_mfma_f32_32x32x16_bf16 v[0:15], v[200:203], v[136:139], v[0:15]
  ds_read_b64_tr_b16 v[184:185], v216 offset:16384
  ds_read_b64_tr_b16 v[186:187], v216 offset:17408
  v_mfma_f32_32x32x16_bf16 v[16:31], v[204:207], v[136:139], v[16:31]
  ds_read_b64_tr_b16 v[188:189], v217 offset:16384
  ds_read_b64_tr_b16 v[190:191], v217 offset:17408
  s_add_u32 s69, s49, 45056
  v_mfma_f32_32x32x16_bf16 v[32:47], v[208:211], v[136:139], v[32:47]
  ds_read_b64_tr_b16 v[192:193], v218 offset:16384
  ds_read_b64_tr_b16 v[194:195], v218 offset:17408
  s_add_u32 s71, s69, s50
  v_mfma_f32_32x32x16_bf16 v[48:63], v[212:215], v[136:139], v[48:63]
  ds_read_b64_tr_b16 v[196:197], v219 offset:16384
  ds_read_b64_tr_b16 v[198:199], v219 offset:17408
  buffer_load_dwordx4 v[136:139], v244, s[24:27], s69 offen offset:0 sc1
  v_mfma_f32_32x32x16_bf16 v[64:79], v[200:203], v[140:143], v[64:79]
  s_add_u32 s70, s72, 2359296
  s_add_u32 m0, s74, 98304
  v_mfma_f32_32x32x16_bf16 v[80:95], v[204:207], v[140:143], v[80:95]
  buffer_load_dwordx4 v245, s[32:35], s70 offen lds
  s_add_u32 s70, s70, 8192
  s_add_u32 m0, s74, 99328
  v_mfma_f32_32x32x16_bf16 v[96:111], v[208:211], v[140:143], v[96:111]
  buffer_load_dwordx4 v245, s[32:35], s70 offen lds
  v_mfma_f32_32x32x16_bf16 v[112:127], v[212:215], v[140:143], v[112:127]
  buffer_load_dwordx4 v[140:143], v244, s[24:27], s71 offen offset:0 sc1
  s_waitcnt vmcnt(25)
  s_waitcnt lgkmcnt(0)
  v_mfma_f32_32x32x16_bf16 v[0:15], v[184:187], v[144:147], v[0:15]
  ds_read_b64_tr_b16 v[200:201], v216 offset:20480
  ds_read_b64_tr_b16 v[202:203], v216 offset:21504
  v_mfma_f32_32x32x16_bf16 v[16:31], v[188:191], v[144:147], v[16:31]
  ds_read_b64_tr_b16 v[204:205], v217 offset:20480
  ds_read_b64_tr_b16 v[206:207], v217 offset:21504
  v_mfma_f32_32x32x16_bf16 v[32:47], v[192:195], v[144:147], v[32:47]
  ds_read_b64_tr_b16 v[208:209], v218 offset:20480
  ds_read_b64_tr_b16 v[210:211], v218 offset:21504
  v_mfma_f32_32x32x16_bf16 v[48:63], v[196:199], v[144:147], v[48:63]
  ds_read_b64_tr_b16 v[212:213], v219 offset:20480
  ds_read_b64_tr_b16 v[214:215], v219 offset:21504
  buffer_load_dwordx4 v[144:147], v244, s[24:27], s69 offen offset:1024 sc1
  v_mfma_f32_32x32x16_bf16 v[64:79], v[184:187], v[148:151], v[64:79]
  s_add_u32 s70, s70, 8192
  s_add_u32 m0, s74, 100352
  v_mfma_f32_32x32x16_bf16 v[80:95], v[188:191], v[148:151], v[80:95]
  buffer_load_dwordx4 v245, s[32:35], s70 offen lds
  s_add_u32 s70, s70, 8192
  s_add_u32 m0, s74, 101376
  v_mfma_f32_32x32x16_bf16 v[96:111], v[192:195], v[148:151], v[96:111]
  buffer_load_dwordx4 v245, s[32:35], s70 offen lds
  v_mfma_f32_32x32x16_bf16 v[112:127], v[196:199], v[148:151], v[112:127]
  buffer_load_dwordx4 v[148:151], v244, s[24:27], s71 offen offset:1024 sc1
  s_barrier
  s_waitcnt vmcnt(25)
  s_waitcnt lgkmcnt(0)
  v_mfma_f32_32x32x16_bf16 v[0:15], v[200:203], v[152:155], v[0:15]
  ds_read_b64_tr_b16 v[184:185], v216 offset:32768
  ds_read_b64_tr_b16 v[186:187], v216 offset:33792
  v_mfma_f32_32x32x16_bf16 v[16:31], v[204:207], v[152:155], v[16:31]
  ds_read_b64_tr_b16 v[188:189], v217 offset:32768
  ds_read_b64_tr_b16 v[190:191], v217 offset:33792
  s_add_u32 s69, s49, 59392
  v_mfma_f32_32x32x16_bf16 v[32:47], v[208:211], v[152:155], v[32:47]
  ds_read_b64_tr_b16 v[192:193], v218 offset:32768
  ds_read_b64_tr_b16 v[194:195], v218 offset:33792
  s_add_u32 s71, s69, s50
  v_mfma_f32_32x32x16_bf16 v[48:63], v[212:215], v[152:155], v[48:63]
  ds_read_b64_tr_b16 v[196:197], v219 offset:32768
  ds_read_b64_tr_b16 v[198:199], v219 offset:33792
  buffer_load_dwordx4 v[152:155], v244, s[24:27], s69 offen offset:0 sc1
  v_mfma_f32_32x32x16_bf16 v[64:79], v[200:203], v[156:159], v[64:79]
  s_add_u32 s70, s72, 2818048
  s_add_u32 m0, s74, 0
  v_mfma_f32_32x32x16_bf16 v[80:95], v[204:207], v[156:159], v[80:95]
  buffer_load_dwordx4 v245, s[32:35], s70 offen lds
  s_add_u32 s70, s70, 8192
  s_add_u32 m0, s74, 1024
  v_mfma_f32_32x32x16_bf16 v[96:111], v[208:211], v[156:159], v[96:111]
  buffer_load_dwordx4 v245, s[32:35], s70 offen lds
  v_mfma_f32_32x32x16_bf16 v[112:127], v[212:215], v[156:159], v[112:127]
  buffer_load_dwordx4 v[156:159], v244, s[24:27], s71 offen offset:0 sc1
  s_waitcnt vmcnt(25)
  s_waitcnt lgkmcnt(0)
  v_mfma_f32_32x32x16_bf16 v[0:15], v[184:187], v[160:163], v[0:15]
  ds_read_b64_tr_b16 v[200:201], v216 offset:36864
  ds_read_b64_tr_b16 v[202:203], v216 offset:37888
  v_mfma_f32_32x32x16_bf16 v[16:31], v[188:191], v[160:163], v[16:31]
  ds_read_b64_tr_b16 v[204:205], v217 offset:36864
  ds_read_b64_tr_b16 v[206:207], v217 offset:37888
  v_mfma_f32_32x32x16_bf16 v[32:47], v[192:195], v[160:163], v[32:47]
  ds_read_b64_tr_b16 v[208:209], v218 offset:36864
  ds_read_b64_tr_b16 v[210:211], v218 offset:37888
  v_mfma_f32_32x32x16_bf16 v[48:63], v[196:199], v[160:163], v[48:63]
  ds_read_b64_tr_b16 v[212:213], v219 offset:36864
  ds_read_b64_tr_b16 v[214:215], v219 offset:37888
  buffer_load_dwordx4 v[160:163], v244, s[24:27], s69 offen offset:1024 sc1
  v_mfma_f32_32x32x16_bf16 v[64:79], v[184:187], v[164:167], v[64:79]
  s_add_u32 s70, s70, 8192
  s_add_u32 m0, s74, 2048
  v_mfma_f32_32x32x16_bf16 v[80:95], v[188:191], v[164:167], v[80:95]
  buffer_load_dwordx4 v245, s[32:35], s70 offen lds
  s_add_u32 s70, s70, 8192
  s_add_u32 m0, s74, 3072
  v_mfma_f32_32x32x16_bf16 v[96:111], v[192:195], v[164:167], v[96:111]
  buffer_load_dwordx4 v245, s[32:35], s70 offen lds
  v_mfma_f32_32x32x16_bf16 v[112:127], v[196:199], v[164:167], v[112:127]
  buffer_load_dwordx4 v[164:167], v244, s[24:27], s71 offen offset:1024 sc1
  s_barrier
  s_waitcnt vmcnt(25)
  s_waitcnt lgkmcnt(0)
  v_mfma_f32_32x32x16_bf16 v[0:15], v[200:203], v[168:171], v[0:15]
  ds_read_b64_tr_b16 v[184:185], v216 offset:49152
  ds_read_b64_tr_b16 v[186:187], v216 offset:50176
  v_mfma_f32_32x32x16_bf16 v[16:31], v[204:207], v[168:171], v[16:31]
  ds_read_b64_tr_b16 v[188:189], v217 offset:49152
  ds_read_b64_tr_b16 v[190:191], v217 offset:50176
  s_add_u32 s69, s49, 73728
  v_mfma_f32_32x32x16_bf16 v[32:47], v[208:211], v[168:171], v[32:47]
  ds_read_b64_tr_b16 v[192:193], v218 offset:49152
  ds_read_b64_tr_b16 v[194:195], v218 offset:50176
  s_add_u32 s71, s69, s50
  v_mfma_f32_32x32x16_bf16 v[48:63], v[212:215], v[168:171], v[48:63]
  ds_read_b64_tr_b16 v[196:197], v219 offset:49152
  ds_read_b64_tr_b16 v[198:199], v219 offset:50176
  buffer_load_dwordx4 v[168:171], v244, s[24:27], s69 offen offset:0 sc1
  v_mfma_f32_32x32x16_bf16 v[64:79], v[200:203], v[172:175], v[64:79]
  s_add_u32 s70, s72, 3276800
  s_add_u32 m0, s74, 16384
  v_mfma_f32_32x32x16_bf16 v[80:95], v[204:207], v[172:175], v[80:95]
  buffer_load_dwordx4 v245, s[32:35], s70 offen lds
  s_add_u32 s70, s70, 8192
  s_add_u32 m0, s74, 17408
  v_mfma_f32_32x32x16_bf16 v[96:111], v[208:211], v[172:175], v[96:111]
  buffer_load_dwordx4 v245, s[32:35], s70 offen lds
  v_mfma_f32_32x32x16_bf16 v[112:127], v[212:215], v[172:175], v[112:127]
  buffer_load_dwordx4 v[172:175], v244, s[24:27], s71 offen offset:0 sc1
  s_waitcnt vmcnt(24)
  s_waitcnt lgkmcnt(0)
  v_mfma_f32_32x32x16_bf16 v[0:15], v[184:187], v[176:179], v[0:15]
  ds_read_b64_tr_b16 v[200:201], v216 offset:53248
  ds_read_b64_tr_b16 v[202:203], v216 offset:54272
  v_mfma_f32_32x32x16_bf16 v[16:31], v[188:191], v[176:179], v[16:31]
  ds_read_b64_tr_b16 v[204:205], v217 offset:53248
  ds_read_b64_tr_b16 v[206:207], v217 offset:54272
  v_mfma_f32_32x32x16_bf16 v[32:47], v[192:195], v[176:179], v[32:47]
  ds_read_b64_tr_b16 v[208:209], v218 offset:53248
  ds_read_b64_tr_b16 v[210:211], v218 offset:54272
  v_mfma_f32_32x32x16_bf16 v[48:63], v[196:199], v[176:179], v[48:63]
  ds_read_b64_tr_b16 v[212:213], v219 offset:53248
  ds_read_b64_tr_b16 v[214:215], v219 offset:54272
  buffer_load_dwordx4 v[176:179], v244, s[24:27], s69 offen offset:1024 sc1
  v_mfma_f32_32x32x16_bf16 v[64:79], v[184:187], v[180:183], v[64:79]
  s_add_u32 s70, s70, 8192
  s_add_u32 m0, s74, 18432
  v_mfma_f32_32x32x16_bf16 v[80:95], v[188:191], v[180:183], v[80:95]
  buffer_load_dwordx4 v245, s[32:35], s70 offen lds
  s_add_u32 s70, s70, 8192
  s_add_u32 m0, s74, 19456
  v_mfma_f32_32x32x16_bf16 v[96:111], v[192:195], v[180:183], v[96:111]
  buffer_load_dwordx4 v245, s[32:35], s70 offen lds
  v_mfma_f32_32x32x16_bf16 v[112:127], v[196:199], v[180:183], v[112:127]
  buffer_load_dwordx4 v[180:183], v244, s[24:27], s71 offen offset:1024 sc1
  s_add_u32 s73, s73, 8192
  buffer_load_dwordx2 v[248:249], v252, s[44:47], s73 offen sc1
  s_barrier
  s_waitcnt vmcnt(25)
  s_waitcnt lgkmcnt(0)
  v_mfma_f32_32x32x16_bf16 v[0:15], v[200:203], v[128:131], v[0:15]
  ds_read_b64_tr_b16 v[184:185], v220 offset:0
  ds_read_b64_tr_b16 v[186:187], v220 offset:1024
  v_mfma_f32_32x32x16_bf16 v[16:31], v[204:207], v[128:131], v[16:31]
  ds_read_b64_tr_b16 v[188:189], v221 offset:0
  ds_read_b64_tr_b16 v[190:191], v221 offset:1024
  s_add_u32 s69, s49, 88064
  v_mfma_f32_32x32x16_bf16 v[32:47], v[208:211], v[128:131], v[32:47]
  ds_read_b64_tr_b16 v[192:193], v222 offset:0
  ds_read_b64_tr_b16 v[194:195], v222 offset:1024
  s_add_u32 s71, s69, s50
  v_mfma_f32_32x32x16_bf16 v[48:63], v[212:215], v[128:131], v[48:63]
  ds_read_b64_tr_b16 v[196:197], v223 offset:0
  ds_read_b64_tr_b16 v[198:199], v223 offset:1024
  buffer_load_dwordx4 v[128:131], v244, s[24:27], s69 offen offset:0 sc1
  v_mfma_f32_32x32x16_bf16 v[64:79], v[200:203], v[132:135], v[64:79]
  s_add_u32 s70, s72, 131072
  s_add_u32 m0, s74, 32768
  v_mfma_f32_32x32x16_bf16 v[80:95], v[204:207], v[132:135], v[80:95]
  buffer_load_dwordx4 v245, s[32:35], s70 offen lds
  s_add_u32 s70, s70, 8192
  s_add_u32 m0, s74, 33792
  v_mfma_f32_32x32x16_bf16 v[96:111], v[208:211], v[132:135], v[96:111]
  buffer_load_dwordx4 v245, s[32:35], s70 offen lds
  v_mfma_f32_32x32x16_bf16 v[112:127], v[212:215], v[132:135], v[112:127]
  buffer_load_dwordx4 v[132:135], v244, s[24:27], s71 offen offset:0 sc1
  s_waitcnt vmcnt(25)
  s_waitcnt lgkmcnt(0)
  v_mfma_f32_32x32x16_bf16 v[0:15], v[184:187], v[136:139], v[0:15]
  ds_read_b64_tr_b16 v[200:201], v220 offset:4096
  ds_read_b64_tr_b16 v[202:203], v220 offset:5120
  v_mfma_f32_32x32x16_bf16 v[16:31], v[188:191], v[136:139], v[16:31]
  ds_read_b64_tr_b16 v[204:205], v221 offset:4096
  ds_read_b64_tr_b16 v[206:207], v221 offset:5120
  v_mfma_f32_32x32x16_bf16 v[32:47], v[192:195], v[136:139], v[32:47]
  ds_read_b64_tr_b16 v[208:209], v222 offset:4096
  ds_read_b64_tr_b16 v[210:211], v222 offset:5120
  v_mfma_f32_32x32x16_bf16 v[48:63], v[196:199], v[136:139], v[48:63]
  ds_read_b64_tr_b16 v[212:213], v223 offset:4096
  ds_read_b64_tr_b16 v[214:215], v223 offset:5120
  buffer_load_dwordx4 v[136:139], v244, s[24:27], s69 offen offset:1024 sc1
  v_mfma_f32_32x32x16_bf16 v[64:79], v[184:187], v[140:143], v[64:79]
  s_add_u32 s70, s70, 8192
  s_add_u32 m0, s74, 34816
  v_mfma_f32_32x32x16_bf16 v[80:95], v[188:191], v[140:143], v[80:95]
  buffer_load_dwordx4 v245, s[32:35], s70 offen lds
  s_add_u32 s70, s70, 8192
  s_add_u32 m0, s74, 35840
  v_mfma_f32_32x32x16_bf16 v[96:111], v[192:195], v[140:143], v[96:111]
  buffer_load_dwordx4 v245, s[32:35], s70 offen lds
  v_mfma_f32_32x32x16_bf16 v[112:127], v[196:199], v[140:143], v[112:127]
  buffer_load_dwordx4 v[140:143], v244, s[24:27], s71 offen offset:1024 sc1
  s_barrier
  s_waitcnt vmcnt(25)
  s_waitcnt lgkmcnt(0)
  v_mfma_f32_32x32x16_bf16 v[0:15], v[200:203], v[144:147], v[0:15]
  ds_read_b64_tr_b16 v[184:185], v220 offset:16384
  ds_read_b64_tr_b16 v[186:187], v220 offset:17408
  v_mfma_f32_32x32x16_bf16 v[16:31], v[204:207], v[144:147], v[16:31]
  ds_read_b64_tr_b16 v[188:189], v221 offset:16384
  ds_read_b64_tr_b16 v[190:191], v221 offset:17408
  s_add_u32 s69, s49, 102400
  v_mfma_f32_32x32x16_bf16 v[32:47], v[208:211], v[144:147], v[32:47]
  ds_read_b64_tr_b16 v[192:193], v222 offset:16384
  ds_read_b64_tr_b16 v[194:195], v222 offset:17408
  s_add_u32 s71, s69, s50
  v_mfma_f32_32x32x16_bf16 v[48:63], v[212:215], v[144:147], v[48:63]
  ds_read_b64_tr_b16 v[196:197], v223 offset:16384
  ds_read_b64_tr_b16 v[198:199], v223 offset:17408
  buffer_load_dwordx4 v[144:147], v244, s[24:27], s69 offen offset:0 sc1
  v_mfma_f32_32x32x16_bf16 v[64:79], v[200:203], v[148:151], v[64:79]
  s_add_u32 s70, s72, 589824
  s_add_u32 m0, s74, 49152
  v_mfma_f32_32x32x16_bf16 v[80:95], v[204:207], v[148:151], v[80:95]
  buffer_load_dwordx4 v245, s[32:35], s70 offen lds
  s_add_u32 s70, s70, 8192
  s_add_u32 m0, s74, 50176
  v_mfma_f32_32x32x16_bf16 v[96:111], v[208:211], v[148:151], v[96:111]
  buffer_load_dwordx4 v245, s[32:35], s70 offen lds
  v_mfma_f32_32x32x16_bf16 v[112:127], v[212:215], v[148:151], v[112:127]
  buffer_load_dwordx4 v[148:151], v244, s[24:27], s71 offen offset:0 sc1
  s_waitcnt vmcnt(25)
  s_waitcnt lgkmcnt(0)
  v_mfma_f32_32x32x16_bf16 v[0:15], v[184:187], v[152:155], v[0:15]
  ds_read_b64_tr_b16 v[200:201], v220 offset:20480
  ds_read_b64_tr_b16 v[202:203], v220 offset:21504
  v_mfma_f32_32x32x16_bf16 v[16:31], v[188:191], v[152:155], v[16:31]
  ds_read_b64_tr_b16 v[204:205], v221 offset:20480
  ds_read_b64_tr_b16 v[206:207], v221 offset:21504
  v_mfma_f32_32x32x16_bf16 v[32:47], v[192:195], v[152:155], v[32:47]
  ds_read_b64_tr_b16 v[208:209], v222 offset:20480
  ds_read_b64_tr_b16 v[210:211], v222 offset:21504
  v_mfma_f32_32x32x16_bf16 v[48:63], v[196:199], v[152:155], v[48:63]
  ds_read_b64_tr_b16 v[212:213], v223 offset:20480
  ds_read_b64_tr_b16 v[214:215], v223 offset:21504
  buffer_load_dwordx4 v[152:155], v244, s[24:27], s69 offen offset:1024 sc1
  v_mfma_f32_32x32x16_bf16 v[64:79], v[184:187], v[156:159], v[64:79]
  s_add_u32 s70, s70, 8192
  s_add_u32 m0, s74, 51200
  v_mfma_f32_32x32x16_bf16 v[80:95], v[188:191], v[156:159], v[80:95]
  buffer_load_dwordx4 v245, s[32:35], s70 offen lds
  s_add_u32 s70, s70, 8192
  s_add_u32 m0, s74, 52224
  v_mfma_f32_32x32x16_bf16 v[96:111], v[192:195], v[156:159], v[96:111]
  buffer_load_dwordx4 v245, s[32:35], s70 offen lds
  v_mfma_f32_32x32x16_bf16 v[112:127], v[196:199], v[156:159], v[112:127]
  buffer_load_dwordx4 v[156:159], v244, s[24:27], s71 offen offset:1024 sc1
  s_barrier
  s_waitcnt vmcnt(16)
  v_cmp_eq_u64 vcc, s[54:55], v[248:249]
  s_cmp_eq_u64 vcc, -1
  s_cbranch_scc0 L_waith25
L_waith25_ret:
  s_waitcnt lgkmcnt(0)
  v_mfma_f32_32x32x16_bf16 v[0:15], v[200:203], v[160:163], v[0:15]
  ds_read_b64_tr_b16 v[184:185], v220 offset:32768
  ds_read_b64_tr_b16 v[186:187], v220 offset:33792
  v_mfma_f32_32x32x16_bf16 v[16:31], v[204:207], v[160:163], v[16:31]
  ds_read_b64_tr_b16 v[188:189], v221 offset:32768
  ds_read_b64_tr_b16 v[190:191], v221 offset:33792
  s_add_u32 s69, s49, 4096
  v_mfma_f32_32x32x16_bf16 v[32:47], v[208:211], v[160:163], v[32:47]
  ds_read_b64_tr_b16 v[192:193], v222 offset:32768
  ds_read_b64_tr_b16 v[194:195], v222 offset:33792
  s_add_u32 s71, s69, s50
  v_mfma_f32_32x32x16_bf16 v[48:63], v[212:215], v[160:163], v[48:63]
  ds_read_b64_tr_b16 v[196:197], v223 offset:32768
  ds_read_b64_tr_b16 v[198:199], v223 offset:33792
  buffer_load_dwordx4 v[160:163], v244, s[24:27], s69 offen offset:0 sc1
  v_mfma_f32_32x32x16_bf16 v[64:79], v[200:203], v[164:167], v[64:79]
  s_add_u32 s70, s72, 1048576
  s_add_u32 m0, s74, 65536
  v_mfma_f32_32x32x16_bf16 v[80:95], v[204:207], v[164:167], v[80:95]
  buffer_load_dwordx4 v245, s[32:35], s70 offen lds
  s_add_u32 s70, s70, 8192
  s_add_u32 m0, s74, 66560
  v_mfma_f32_32x32x16_bf16 v[96:111], v[208:211], v[164:167], v[96:111]
  buffer_load_dwordx4 v245, s[32:35], s70 offen lds
  v_mfma_f32_32x32x16_bf16 v[112:127], v[212:215], v[164:167], v[112:127]
  buffer_load_dwordx4 v[164:167], v244, s[24:27], s71 offen offset:0 sc1
  s_waitcnt lgkmcnt(0)
  v_mfma_f32_32x32x16_bf16 v[0:15], v[184:187], v[168:171], v[0:15]
  ds_read_b64_tr_b16 v[200:201], v220 offset:36864
  ds_read_b64_tr_b16 v[202:203], v220 offset:37888
  v_mfma_f32_32x32x16_bf16 v[16:31], v[188:191], v[168:171], v[16:31]
  ds_read_b64_tr_b16 v[204:205], v221 offset:36864
  ds_read_b64_tr_b16 v[206:207], v221 offset:37888
  v_mfma_f32_32x32x16_bf16 v[32:47], v[192:195], v[168:171], v[32:47]
  ds_read_b64_tr_b16 v[208:209], v222 offset:36864
  ds_read_b64_tr_b16 v[210:211], v222 offset:37888
  v_mfma_f32_32x32x16_bf16 v[48:63], v[196:199], v[168:171], v[48:63]
  ds_read_b64_tr_b16 v[212:213], v223 offset:36864
  ds_read_b64_tr_b16 v[214:215], v223 offset:37888
  buffer_load_dwordx4 v[168:171], v244, s[24:27], s69 offen offset:1024 sc1
  v_mfma_f32_32x32x16_bf16 v[64:79], v[184:187], v[172:175], v[64:79]
  s_add_u32 s70, s70, 8192
  s_add_u32 m0, s74, 67584
  v_mfma_f32_32x32x16_bf16 v[80:95], v[188:191], v[172:175], v[80:95]
  buffer_load_dwordx4 v245, s[32:35], s70 offen lds
  s_add_u32 s70, s70, 8192
  s_add_u32 m0, s74, 68608
  v_mfma_f32_32x32x16_bf16 v[96:111], v[192:195], v[172:175], v[96:111]
  buffer_load_dwordx4 v245, s[32:35], s70 offen lds
  v_mfma_f32_32x32x16_bf16 v[112:127], v[196:199], v[172:175], v[112:127]
  buffer_load_dwordx4 v[172:175], v244, s[24:27], s71 offen offset:1024 sc1
  s_barrier
  s_waitcnt lgkmcnt(0)
  v_mfma_f32_32x32x16_bf16 v[0:15], v[200:203], v[176:179], v[0:15]
  ds_read_b64_tr_b16 v[184:185], v216 offset:0
  ds_read_b64_tr_b16 v[186:187], v216 offset:1024
  v_mfma_f32_32x32x16_bf16 v[16:31], v[204:207], v[176:179], v[16:31]
  ds_read_b64_tr_b16 v[188:189], v217 offset:0
  ds_read_b64_tr_b16 v[190:191], v217 offset:1024
  s_add_u32 s69, s49, 18432
  v_mfma_f32_32x32x16_bf16 v[32:47], v[208:211], v[176:179], v[32:47]
  ds_read_b64_tr_b16 v[192:193], v218 offset:0
  ds_read_b64_tr_b16 v[194:195], v218 offset:1024
  s_add_u32 s71, s69, s50
  v_mfma_f32_32x32x16_bf16 v[48:63], v[212:215], v[176:179], v[48:63]
  ds_read_b64_tr_b16 v[196:197], v219 offset:0
  ds_read_b64_tr_b16 v[198:199], v219 offset:1024
  buffer_load_dwordx4 v[176:179], v244, s[24:27], s69 offen offset:0 sc1
  v_mfma_f32_32x32x16_bf16 v[64:79], v[200:203], v[180:183], v[64:79]
  s_add_u32 s70, s72, 1507328
  s_add_u32 m0, s74, 81920
  v_mfma_f32_32x32x16_bf16 v[80:95], v[204:207], v[180:183], v[80:95]
  buffer_load_dwordx4 v245, s[32:35], s70 offen lds
  s_add_u32 s70, s70, 8192
  s_add_u32 m0, s74, 82944
  v_mfma_f32_32x32x16_bf16 v[96:111], v[208:211], v[180:183], v[96:111]
  buffer_load_dwordx4 v245, s[32:35], s70 offen lds
  v_mfma_f32_32x32x16_bf16 v[112:127], v[212:215], v[180:183], v[112:127]
  buffer_load_dwordx4 v[180:183], v244, s[24:27], s71 offen offset:0 sc1
  s_add_u32 s28, s22, 35651584
  s_addc_u32 s29, s23, 0
  s_and_b32 s29, s29, 0xffff
  s_mov_b32 s30, 4194304
  s_mov_b32 s31, 0x20000
  s_lshl_b32 s58, s2, 2
  s_add_u32 s58, s58, s51
  s_lshl_b32 s77, s58, 3
  s_add_u32 s77, s77, 32768
  s_xor_b32 s79, s77, 1024
  s_lshl_b32 s58, s58, 12
  s_xor_b32 s59, s58, 524288
  v_mov_b32 v248, -1
  v_mov_b32 v249, -1
  v_mov_b32 v250, -1
  v_mov_b32 v251, -1
  buffer_store_dwordx4 v[248:251], v244, s[28:31], s58 offen offset:0 sc1
  buffer_store_dwordx4 v[248:251], v244, s[28:31], s58 offen offset:1024 sc1
  buffer_store_dwordx4 v[248:251], v244, s[28:31], s58 offen offset:2048 sc1
  buffer_store_dwordx4 v[248:251], v244, s[28:31], s58 offen offset:3072 sc1
  s_waitcnt vmcnt(28)
  s_waitcnt lgkmcnt(0)
  v_mfma_f32_32x32x16_bf16 v[0:15], v[184:187], v[128:131], v[0:15]
  ds_read_b64_tr_b16 v[200:201], v216 offset:4096
  ds_read_b64_tr_b16 v[202:203], v216 offset:5120
  v_mfma_f32_32x32x16_bf16 v[16:31], v[188:191], v[128:131], v[16:31]
  ds_read_b64_tr_b16 v[204:205], v217 offset:4096
  ds_read_b64_tr_b16 v[206:207], v217 offset:5120
  v_mfma_f32_32x32x16_bf16 v[32:47], v[192:195], v[128:131], v[32:47]
  ds_read_b64_tr_b16 v[208:209], v218 offset:4096
  ds_read_b64_tr_b16 v[210:211], v218 offset:5120
  v_mfma_f32_32x32x16_bf16 v[48:63], v[196:199], v[128:131], v[48:63]
  ds_read_b64_tr_b16 v[212:213], v219 offset:4096
  ds_read_b64_tr_b16 v[214:215], v219 offset:5120
  buffer_load_dwordx4 v[128:131], v244, s[24:27], s69 offen offset:1024 sc1
  v_mfma_f32_32x32x16_bf16 v[64:79], v[184:187], v[132:135], v[64:79]
  s_add_u32 s70, s70, 8192
  s_add_u32 m0, s74, 83968
  v_mfma_f32_32x32x16_bf16 v[80:95], v[188:191], v[132:135], v[80:95]
  buffer_load_dwordx4 v245, s[32:35], s70 offen lds
  s_add_u32 s70, s70, 8192
  s_add_u32 m0, s74, 84992
  v_mfma_f32_32x32x16_bf16 v[96:111], v[192:195], v[132:135], v[96:111]
  buffer_load_dwordx4 v245, s[32:35], s70 offen lds
  v_mfma_f32_32x32x16_bf16 v[112:127], v[196:199], v[132:135], v[112:127]
  buffer_load_dwordx4 v[132:135], v244, s[24:27], s71 offen offset:1024 sc1
  s_barrier
  s_waitcnt vmcnt(28)
  s_waitcnt lgkmcnt(0)
  v_mfma_f32_32x32x16_bf16 v[0:15], v[200:203], v[136:139], v[0:15]
  ds_read_b64_tr_b16 v[184:185], v216 offset:16384
  ds_read_b64_tr_b16 v[186:187], v216 offset:17408
  v_mfma_f32_32x32x16_bf16 v[16:31], v[204:207], v[136:139], v[16:31]
  ds_read_b64_tr_b16 v[188:189], v217 offset:16384
  ds_read_b64_tr_b16 v[190:191], v217 offset:17408
  s_add_u32 s69, s49, 32768
  v_mfma_f32_32x32x16_bf16 v[32:47], v[208:211], v[136:139], v[32:47]
  ds_read_b64_tr_b16 v[192:193], v218 offset:16384
  ds_read_b64_tr_b16 v[194:195], v218 offset:17408
  s_add_u32 s71, s69, s50
  v_mfma_f32_32x32x16_bf16 v[48:63], v[212:215], v[136:139], v[48:63]
  ds_read_b64_tr_b16 v[196:197], v219 offset:16384
  ds_read_b64_tr_b16 v[198:199], v219 offset:17408
  buffer_load_dwordx4 v[136:139], v244, s[24:27], s69 offen offset:0 sc1
  v_mfma_f32_32x32x16_bf16 v[64:79], v[200:203], v[140:143], v[64:79]
  s_add_u32 s70, s72, 1966080
  s_add_u32 m0, s74, 98304
  v_mfma_f32_32x32x16_bf16 v[80:95], v[204:207], v[140:143], v[80:95]
  buffer_load_dwordx4 v245, s[32:35], s70 offen lds
  s_add_u32 s70, s70, 8192
  s_add_u32 m0, s74, 99328
  v_mfma_f32_32x32x16_bf16 v[96:111], v[208:211], v[140:143], v[96:111]
  buffer_load_dwordx4 v245, s[32:35], s70 offen lds
  v_mfma_f32_32x32x16_bf16 v[112:127], v[212:215], v[140:143], v[112:127]
  buffer_load_dwordx4 v[140:143], v244, s[24:27], s71 offen offset:0 sc1
  s_waitcnt vmcnt(28)
  s_waitcnt lgkmcnt(0)
  v_mfma_f32_32x32x16_bf16 v[0:15], v[184:187], v[144:147], v[0:15]
  ds_read_b64_tr_b16 v[200:201], v216 offset:20480
  ds_read_b64_tr_b16 v[202:203], v216 offset:21504
  v_mfma_f32_32x32x16_bf16 v[16:31], v[188:191], v[144:147], v[16:31]
  ds_read_b64_tr_b16 v[204:205], v217 offset:20480
  ds_read_b64_tr_b16 v[206:207], v217 offset:21504
  v_mfma_f32_32x32x16_bf16 v[32:47], v[192:195], v[144:147], v[32:47]
  ds_read_b64_tr_b16 v[208:209], v218 offset:20480
  ds_read_b64_tr_b16 v[210:211], v218 offset:21504
  v_mfma_f32_32x32x16_bf16 v[48:63], v[196:199], v[144:147], v[48:63]
  ds_read_b64_tr_b16 v[212:213], v219 offset:20480
  ds_read_b64_tr_b16 v[214:215], v219 offset:21504
  buffer_load_dwordx4 v[144:147], v244, s[24:27], s69 offen offset:1024 sc1
  v_mfma_f32_32x32x16_bf16 v[64:79], v[184:187], v[148:151], v[64:79]
  s_add_u32 s70, s70, 8192
  s_add_u32 m0, s74, 100352
  v_mfma_f32_32x32x16_bf16 v[80:95], v[188:191], v[148:151], v[80:95]
  buffer_load_dwordx4 v245, s[32:35], s70 offen lds
  s_add_u32 s70, s70, 8192
  s_add_u32 m0, s74, 101376
  v_mfma_f32_32x32x16_bf16 v[96:111], v[192:195], v[148:151], v[96:111]
  buffer_load_dwordx4 v245, s[32:35], s70 offen lds
  v_mfma_f32_32x32x16_bf16 v[112:127], v[196:199], v[148:151], v[112:127]
  buffer_load_dwordx4 v[148:151], v244, s[24:27], s71 offen offset:1024 sc1
  s_barrier
  s_waitcnt vmcnt(28)
  s_waitcnt lgkmcnt(0)
  v_mfma_f32_32x32x16_bf16 v[0:15], v[200:203], v[152:155], v[0:15]
  ds_read_b64_tr_b16 v[184:185], v216 offset:32768
  ds_read_b64_tr_b16 v[186:187], v216 offset:33792
  v_mfma_f32_32x32x16_bf16 v[16:31], v[204:207], v[152:155], v[16:31]
  ds_read_b64_tr_b16 v[188:189], v217 offset:32768
  ds_read_b64_tr_b16 v[190:191], v217 offset:33792
  s_add_u32 s69, s49, 47104
  v_mfma_f32_32x32x16_bf16 v[32:47], v[208:211], v[152:155], v[32:47]
  ds_read_b64_tr_b16 v[192:193], v218 offset:32768
  ds_read_b64_tr_b16 v[194:195], v218 offset:33792
  s_add_u32 s71, s69, s50
  v_mfma_f32_32x32x16_bf16 v[48:63], v[212:215], v[152:155], v[48:63]
  ds_read_b64_tr_b16 v[196:197], v219 offset:32768
  ds_read_b64_tr_b16 v[198:199], v219 offset:33792
  buffer_load_dwordx4 v[152:155], v244, s[24:27], s69 offen offset:0 sc1
  v_mfma_f32_32x32x16_bf16 v[64:79], v[200:203], v[156:159], v[64:79]
  s_add_u32 s70, s72, 2424832
  s_add_u32 m0, s74, 0
  v_mfma_f32_32x32x16_bf16 v[80:95], v[204:207], v[156:159], v[80:95]
  buffer_load_dwordx4 v245, s[32:35], s70 offen lds
  s_add_u32 s70, s70, 8192
  s_add_u32 m0, s74, 1024
  v_mfma_f32_32x32x16_bf16 v[96:111], v[208:211], v[156:159], v[96:111]
  buffer_load_dwordx4 v245, s[32:35], s70 offen lds
  v_mfma_f32_32x32x16_bf16 v[112:127], v[212:215], v[156:159], v[112:127]
  buffer_load_dwordx4 v[156:159], v244, s[24:27], s71 offen offset:0 sc1
  s_waitcnt vmcnt(28)
  s_waitcnt lgkmcnt(0)
  v_mfma_f32_32x32x16_bf16 v[0:15], v[184:187], v[160:163], v[0:15]
  ds_read_b64_tr_b16 v[200:201], v216 offset:36864
  ds_read_b64_tr_b16 v[202:203], v216 offset:37888
  v_mfma_f32_32x32x16_bf16 v[16:31], v[188:191], v[160:163], v[16:31]
  ds_read_b64_tr_b16 v[204:205], v217 offset:36864
  ds_read_b64_tr_b16 v[206:207], v217 offset:37888
  v_mfma_f32_32x32x16_bf16 v[32:47], v[192:195], v[160:163], v[32:47]
  ds_read_b64_tr_b16 v[208:209], v218 offset:36864
  ds_read_b64_tr_b16 v[210:211], v218 offset:37888
  v_mfma_f32_32x32x16_bf16 v[48:63], v[196:199], v[160:163], v[48:63]
  ds_read_b64_tr_b16 v[212:213], v219 offset:36864
  ds_read_b64_tr_b16 v[214:215], v219 offset:37888
  buffer_load_dwordx4 v[160:163], v244, s[24:27], s69 offen offset:1024 sc1
  v_mfma_f32_32x32x16_bf16 v[64:79], v[184:187], v[164:167], v[64:79]
  s_add_u32 s70, s70, 8192
  s_add_u32 m0, s74, 2048
  v_mfma_f32_32x32x16_bf16 v[80:95], v[188:191], v[164:167], v[80:95]
  buffer_load_dwordx4 v245, s[32:35], s70 offen lds
  s_add_u32 s70, s70, 8192
  s_add_u32 m0, s74, 3072
  v_mfma_f32_32x32x16_bf16 v[96:111], v[192:195], v[164:167], v[96:111]
  buffer_load_dwordx4 v245, s[32:35], s70 offen lds
  v_mfma_f32_32x32x16_bf16 v[112:127], v[196:199], v[164:167], v[112:127]
  buffer_load_dwordx4 v[164:167], v244, s[24:27], s71 offen offset:1024 sc1
  s_barrier
  s_waitcnt vmcnt(28)
  s_waitcnt lgkmcnt(0)
  v_mfma_f32_32x32x16_bf16 v[0:15], v[200:203], v[168:171], v[0:15]
  ds_read_b64_tr_b16 v[184:185], v216 offset:49152
  ds_read_b64_tr_b16 v[186:187], v216 offset:50176
  v_mfma_f32_32x32x16_bf16 v[16:31], v[204:207], v[168:171], v[16:31]
  ds_read_b64_tr_b16 v[188:189], v217 offset:49152
  ds_read_b64_tr_b16 v[190:191], v217 offset:50176
  s_add_u32 s69, s49, 61440
  v_mfma_f32_32x32x16_bf16 v[32:47], v[208:211], v[168:171], v[32:47]
  ds_read_b64_tr_b16 v[192:193], v218 offset:49152
  ds_read_b64_tr_b16 v[194:195], v218 offset:50176
  s_add_u32 s71, s69, s50
  v_mfma_f32_32x32x16_bf16 v[48:63], v[212:215], v[168:171], v[48:63]
  ds_read_b64_tr_b16 v[196:197], v219 offset:49152
  ds_read_b64_tr_b16 v[198:199], v219 offset:50176
  buffer_load_dwordx4 v[168:171], v244, s[24:27], s69 offen offset:0 sc1
  v_mfma_f32_32x32x16_bf16 v[64:79], v[200:203], v[172:175], v[64:79]
  s_add_u32 s70, s72, 2883584
  s_add_u32 m0, s74, 16384
  v_mfma_f32_32x32x16_bf16 v[80:95], v[204:207], v[172:175], v[80:95]
  buffer_load_dwordx4 v245, s[32:35], s70 offen lds
  s_add_u32 s70, s70, 8192
  s_add_u32 m0, s74, 17408
  v_mfma_f32_32x32x16_bf16 v[96:111], v[208:211], v[172:175], v[96:111]
  buffer_load_dwordx4 v245, s[32:35], s70 offen lds
  v_mfma_f32_32x32x16_bf16 v[112:127], v[212:215], v[172:175], v[112:127]
  buffer_load_dwordx4 v[172:175], v244, s[24:27], s71 offen offset:0 sc1
  s_waitcnt vmcnt(28)
  s_waitcnt lgkmcnt(0)
  v_mfma_f32_32x32x16_bf16 v[0:15], v[184:187], v[176:179], v[0:15]
  ds_read_b64_tr_b16 v[200:201], v216 offset:53248
  ds_read_b64_tr_b16 v[202:203], v216 offset:54272
  v_mfma_f32_32x32x16_bf16 v[16:31], v[188:191], v[176:179], v[16:31]
  ds_read_b64_tr_b16 v[204:205], v217 offset:53248
  ds_read_b64_tr_b16 v[206:207], v217 offset:54272
  v_mfma_f32_32x32x16_bf16 v[32:47], v[192:195], v[176:179], v[32:47]
  ds_read_b64_tr_b16 v[208:209], v218 offset:53248
  ds_read_b64_tr_b16 v[210:211], v218 offset:54272
  v_mfma_f32_32x32x16_bf16 v[48:63], v[196:199], v[176:179], v[48:63]
  ds_read_b64_tr_b16 v[212:213], v219 offset:53248
  ds_read_b64_tr_b16 v[214:215], v219 offset:54272
  buffer_load_dwordx4 v[176:179], v244, s[24:27], s69 offen offset:1024 sc1
  v_mfma_f32_32x32x16_bf16 v[64:79], v[184:187], v[180:183], v[64:79]
  s_add_u32 s70, s70, 8192
  s_add_u32 m0, s74, 18432
  v_mfma_f32_32x32x16_bf16 v[80:95], v[188:191], v[180:183], v[80:95]
  buffer_load_dwordx4 v245, s[32:35], s70 offen lds
  s_add_u32 s70, s70, 8192
  s_add_u32 m0, s74, 19456
  v_mfma_f32_32x32x16_bf16 v[96:111], v[192:195], v[180:183], v[96:111]
  buffer_load_dwordx4 v245, s[32:35], s70 offen lds
  v_mfma_f32_32x32x16_bf16 v[112:127], v[196:199], v[180:183], v[112:127]
  buffer_load_dwordx4 v[180:183], v244, s[24:27], s71 offen offset:1024 sc1
  s_barrier
  s_waitcnt vmcnt(24)
  s_waitcnt lgkmcnt(0)
  v_mfma_f32_32x32x16_bf16 v[0:15], v[200:203], v[128:131], v[0:15]
  ds_read_b64_tr_b16 v[184:185], v220 offset:0
  ds_read_b64_tr_b16 v[186:187], v220 offset:1024
  v_mfma_f32_32x32x16_bf16 v[16:31], v[204:207], v[128:131], v[16:31]
  ds_read_b64_tr_b16 v[188:189], v221 offset:0
  ds_read_b64_tr_b16 v[190:191], v221 offset:1024
  s_add_u32 s69, s49, 75776
  v_mfma_f32_32x32x16_bf16 v[32:47], v[208:211], v[128:131], v[32:47]
  ds_read_b64_tr_b16 v[192:193], v222 offset:0
  ds_read_b64_tr_b16 v[194:195], v222 offset:1024
  s_add_u32 s71, s69, s50
  v_mfma_f32_32x32x16_bf16 v[48:63], v[212:215], v[128:131], v[48:63]
  ds_read_b64_tr_b16 v[196:197], v223 offset:0
  ds_read_b64_tr_b16 v[198:199], v223 offset:1024
  buffer_load_dwordx4 v[128:131], v244, s[24:27], s69 offen offset:0 sc1
  v_mfma_f32_32x32x16_bf16 v[64:79], v[200:203], v[132:135], v[64:79]
  s_add_u32 s70, s72, 3342336
  s_add_u32 m0, s74, 32768
  v_mfma_f32_32x32x16_bf16 v[80:95], v[204:207], v[132:135], v[80:95]
  buffer_load_dwordx4 v245, s[32:35], s70 offen lds
  s_add_u32 s70, s70, 8192
  s_add_u32 m0, s74, 33792
  v_mfma_f32_32x32x16_bf16 v[96:111], v[208:211], v[132:135], v[96:111]
  buffer_load_dwordx4 v245, s[32:35], s70 offen lds
  v_mfma_f32_32x32x16_bf16 v[112:127], v[212:215], v[132:135], v[112:127]
  buffer_load_dwordx4 v[132:135], v244, s[24:27], s71 offen offset:0 sc1
  s_waitcnt vmcnt(24)
  s_waitcnt lgkmcnt(0)
  v_mfma_f32_32x32x16_bf16 v[0:15], v[184:187], v[136:139], v[0:15]
  ds_read_b64_tr_b16 v[200:201], v220 offset:4096
  ds_read_b64_tr_b16 v[202:203], v220 offset:5120
  v_mfma_f32_32x32x16_bf16 v[16:31], v[188:191], v[136:139], v[16:31]
  ds_read_b64_tr_b16 v[204:205], v221 offset:4096
  ds_read_b64_tr_b16 v[206:207], v221 offset:5120
  v_mfma_f32_32x32x16_bf16 v[32:47], v[192:195], v[136:139], v[32:47]
  ds_read_b64_tr_b16 v[208:209], v222 offset:4096
  ds_read_b64_tr_b16 v[210:211], v222 offset:5120
  v_mfma_f32_32x32x16_bf16 v[48:63], v[196:199], v[136:139], v[48:63]
  ds_read_b64_tr_b16 v[212:213], v223 offset:4096
  ds_read_b64_tr_b16 v[214:215], v223 offset:5120
  buffer_load_dwordx4 v[136:139], v244, s[24:27], s69 offen offset:1024 sc1
  v_mfma_f32_32x32x16_bf16 v[64:79], v[184:187], v[140:143], v[64:79]
  s_add_u32 s70, s70, 8192
  s_add_u32 m0, s74, 34816
  v_mfma_f32_32x32x16_bf16 v[80:95], v[188:191], v[140:143], v[80:95]
  buffer_load_dwordx4 v245, s[32:35], s70 offen lds
  s_add_u32 s70, s70, 8192
  s_add_u32 m0, s74, 35840
  v_mfma_f32_32x32x16_bf16 v[96:111], v[192:195], v[140:143], v[96:111]
  buffer_load_dwordx4 v245, s[32:35], s70 offen lds
  v_mfma_f32_32x32x16_bf16 v[112:127], v[196:199], v[140:143], v[112:127]
  buffer_load_dwordx4 v[140:143], v244, s[24:27], s71 offen offset:1024 sc1
  s_barrier
  s_waitcnt vmcnt(24)
  s_waitcnt lgkmcnt(0)
  v_mfma_f32_32x32x16_bf16 v[0:15], v[200:203], v[144:147], v[0:15]
  ds_read_b64_tr_b16 v[184:185], v220 offset:16384
  ds_read_b64_tr_b16 v[186:187], v220 offset:17408
  v_mfma_f32_32x32x16_bf16 v[16:31], v[204:207], v[144:147], v[16:31]
  ds_read_b64_tr_b16 v[188:189], v221 offset:16384
  ds_read_b64_tr_b16 v[190:191], v221 offset:17408
  s_add_u32 s69, s49, 90112
  v_mfma_f32_32x32x16_bf16 v[32:47], v[208:211], v[144:147], v[32:47]
  ds_read_b64_tr_b16 v[192:193], v222 offset:16384
  ds_read_b64_tr_b16 v[194:195], v222 offset:17408
  s_add_u32 s71, s69, s50
  v_mfma_f32_32x32x16_bf16 v[48:63], v[212:215], v[144:147], v[48:63]
  ds_read_b64_tr_b16 v[196:197], v223 offset:16384
  ds_read_b64_tr_b16 v[198:199], v223 offset:17408
  buffer_load_dwordx4 v[144:147], v244, s[24:27], s69 offen offset:0 sc1
  v_mfma_f32_32x32x16_bf16 v[64:79], v[200:203], v[148:151], v[64:79]
  s_add_u32 s70, s68, 196608
  s_add_u32 m0, s74, 49152
  v_mfma_f32_32x32x16_bf16 v[80:95], v[204:207], v[148:151], v[80:95]
  buffer_load_dwordx4 v245, s[32:35], s70 offen lds
  s_add_u32 s70, s70, 8192
  s_add_u32 m0, s74, 50176
  v_mfma_f32_32x32x16_bf16 v[96:111], v[208:211], v[148:151], v[96:111]
  buffer_load_dwordx4 v245, s[32:35], s70 offen lds
  v_mfma_f32_32x32x16_bf16 v[112:127], v[212:215], v[148:151], v[112:127]
  buffer_load_dwordx4 v[148:151], v244, s[24:27], s71 offen offset:0 sc1
  v_mov_b32 v248, s54
  v_mov_b32 v249, s55
  s_mov_b64 exec, 1
  buffer_store_dwordx2 v[248:249], off, s[44:47], s77 sc1
  s_mov_b64 exec, -1
  s_waitcnt vmcnt(25)
  s_waitcnt lgkmcnt(0)
  v_mfma_f32_32x32x16_bf16 v[0:15], v[184:187], v[152:155], v[0:15]
  ds_read_b64_tr_b16 v[200:201], v220 offset:20480
  ds_read_b64_tr_b16 v[202:203], v220 offset:21504
  v_mfma_f32_32x32x16_bf16 v[16:31], v[188:191], v[152:155], v[16:31]
  ds_read_b64_tr_b16 v[204:205], v221 offset:20480
  ds_read_b64_tr_b16 v[206:207], v221 offset:21504
  v_mfma_f32_32x32x16_bf16 v[32:47], v[192:195], v[152:155], v[32:47]
  ds_read_b64_tr_b16 v[208:209], v222 offset:20480
  ds_read_b64_tr_b16 v[210:211], v222 offset:21504
  v_mfma_f32_32x32x16_bf16 v[48:63], v[196:199], v[152:155], v[48:63]
  ds_read_b64_tr_b16 v[212:213], v223 offset:20480
  ds_read_b64_tr_b16 v[214:215], v223 offset:21504
  buffer_load_dwordx4 v[152:155], v244, s[24:27], s69 offen offset:1024 sc1
  v_mfma_f32_32x32x16_bf16 v[64:79], v[184:187], v[156:159], v[64:79]
  s_add_u32 s70, s70, 8192
  s_add_u32 m0, s74, 51200
  v_mfma_f32_32x32x16_bf16 v[80:95], v[188:191], v[156:159], v[80:95]
  buffer_load_dwordx4 v245, s[32:35], s70 offen lds
  s_add_u32 s70, s70, 8192
  s_add_u32 m0, s74, 52224
  v_mfma_f32_32x32x16_bf16 v[96:111], v[192:195], v[156:159], v[96:111]
  buffer_load_dwordx4 v245, s[32:35], s70 offen lds
  v_mfma_f32_32x32x16_bf16 v[112:127], v[196:199], v[156:159], v[112:127]
  buffer_load_dwordx4 v[156:159], v244, s[24:27], s71 offen offset:1024 sc1
  s_barrier
  s_waitcnt vmcnt(25)
  s_waitcnt lgkmcnt(0)
  v_mfma_f32_32x32x16_bf16 v[0:15], v[200:203], v[160:163], v[0:15]
  ds_read_b64_tr_b16 v[184:185], v220 offset:32768
  ds_read_b64_tr_b16 v[186:187], v220 offset:33792
  v_mfma_f32_32x32x16_bf16 v[16:31], v[204:207], v[160:163], v[16:31]
  ds_read_b64_tr_b16 v[188:189], v221 offset:32768
  ds_read_b64_tr_b16 v[190:191], v221 offset:33792
  s_add_u32 s69, s49, 104448
  v_mfma_f32_32x32x16_bf16 v[32:47], v[208:211], v[160:163], v[32:47]
  ds_read_b64_tr_b16 v[192:193], v222 offset:32768
  ds_read_b64_tr_b16 v[194:195], v222 offset:33792
  s_add_u32 s71, s69, s50
  v_mfma_f32_32x32x16_bf16 v[48:63], v[212:215], v[160:163], v[48:63]
  ds_read_b64_tr_b16 v[196:197], v223 offset:32768
  ds_read_b64_tr_b16 v[198:199], v223 offset:33792
  buffer_load_dwordx4 v[160:163], v244, s[24:27], s69 offen offset:0 sc1
  v_mfma_f32_32x32x16_bf16 v[64:79], v[200:203], v[164:167], v[64:79]
  s_add_u32 s70, s68, 1114112
  s_add_u32 m0, s74, 65536
  v_mfma_f32_32x32x16_bf16 v[80:95], v[204:207], v[164:167], v[80:95]
  buffer_load_dwordx4 v245, s[32:35], s70 offen lds
  s_add_u32 s70, s70, 8192
  s_add_u32 m0, s74, 66560
  v_mfma_f32_32x32x16_bf16 v[96:111], v[208:211], v[164:167], v[96:111]
  buffer_load_dwordx4 v245, s[32:35], s70 offen lds
  v_mfma_f32_32x32x16_bf16 v[112:127], v[212:215], v[164:167], v[112:127]
  buffer_load_dwordx4 v[164:167], v244, s[24:27], s71 offen offset:0 sc1
  s_waitcnt vmcnt(25)
  s_waitcnt lgkmcnt(0)
  v_mfma_f32_32x32x16_bf16 v[0:15], v[184:187], v[168:171], v[0:15]
  ds_read_b64_tr_b16 v[200:201], v220 offset:36864
  ds_read_b64_tr_b16 v[202:203], v220 offset:37888
  v_mfma_f32_32x32x16_bf16 v[16:31], v[188:191], v[168:171], v[16:31]
  ds_read_b64_tr_b16 v[204:205], v221 offset:36864
  ds_read_b64_tr_b16 v[206:207], v221 offset:37888
  v_mfma_f32_32x32x16_bf16 v[32:47], v[192:195], v[168:171], v[32:47]
  ds_read_b64_tr_b16 v[208:209], v222 offset:36864
  ds_read_b64_tr_b16 v[210:211], v222 offset:37888
  v_mfma_f32_32x32x16_bf16 v[48:63], v[196:199], v[168:171], v[48:63]
  ds_read_b64_tr_b16 v[212:213], v223 offset:36864
  ds_read_b64_tr_b16 v[214:215], v223 offset:37888
  buffer_load_dwordx4 v[168:171], v244, s[24:27], s69 offen offset:1024 sc1
  v_mfma_f32_32x32x16_bf16 v[64:79], v[184:187], v[172:175], v[64:79]
  s_add_u32 s70, s70, 8192
  s_add_u32 m0, s74, 67584
  v_mfma_f32_32x32x16_bf16 v[80:95], v[188:191], v[172:175], v[80:95]
  buffer_load_dwordx4 v245, s[32:35], s70 offen lds
  s_add_u32 s70, s70, 8192
  s_add_u32 m0, s74, 68608
  v_mfma_f32_32x32x16_bf16 v[96:111], v[192:195], v[172:175], v[96:111]
  buffer_load_dwordx4 v245, s[32:35], s70 offen lds
  v_mfma_f32_32x32x16_bf16 v[112:127], v[196:199], v[172:175], v[112:127]
  buffer_load_dwordx4 v[172:175], v244, s[24:27], s71 offen offset:1024 sc1
  s_barrier
  s_waitcnt vmcnt(25)
  s_waitcnt lgkmcnt(0)
  v_mfma_f32_32x32x16_bf16 v[0:15], v[200:203], v[176:179], v[0:15]
  ds_read_b64_tr_b16 v[184:185], v216 offset:0
  ds_read_b64_tr_b16 v[186:187], v216 offset:1024
  v_mfma_f32_32x32x16_bf16 v[16:31], v[204:207], v[176:179], v[16:31]
  ds_read_b64_tr_b16 v[188:189], v217 offset:0
  ds_read_b64_tr_b16 v[190:191], v217 offset:1024
  s_mul_i32 s56, s76, 7168
  v_mfma_f32_32x32x16_bf16 v[32:47], v[208:211], v[176:179], v[32:47]
  ds_read_b64_tr_b16 v[192:193], v218 offset:0
  ds_read_b64_tr_b16 v[194:195], v218 offset:1024
  s_add_u32 s49, s49, s56
  s_add_u32 s69, s49, 6144
  s_add_u32 s71, s69, s50
  v_mfma_f32_32x32x16_bf16 v[48:63], v[212:215], v[176:179], v[48:63]
  ds_read_b64_tr_b16 v[196:197], v219 offset:0
  ds_read_b64_tr_b16 v[198:199], v219 offset:1024
  buffer_load_dwordx4 v[176:179], v244, s[24:27], s69 offen offset:0 sc1
  v_mfma_f32_32x32x16_bf16 v[64:79], v[200:203], v[180:183], v[64:79]
  s_add_u32 s70, s68, 2031616
  s_add_u32 m0, s74, 81920
  v_mfma_f32_32x32x16_bf16 v[80:95], v[204:207], v[180:183], v[80:95]
  buffer_load_dwordx4 v245, s[32:35], s70 offen lds
  s_add_u32 s70, s70, 8192
  s_add_u32 m0, s74, 82944
  v_mfma_f32_32x32x16_bf16 v[96:111], v[208:211], v[180:183], v[96:111]
  buffer_load_dwordx4 v245, s[32:35], s70 offen lds
  v_mfma_f32_32x32x16_bf16 v[112:127], v[212:215], v[180:183], v[112:127]
  buffer_load_dwordx4 v[180:183], v244, s[24:27], s71 offen offset:0 sc1
  s_waitcnt vmcnt(25)
  s_waitcnt lgkmcnt(0)
  v_mfma_f32_32x32x16_bf16 v[0:15], v[184:187], v[128:131], v[0:15]
  ds_read_b64_tr_b16 v[200:201], v216 offset:4096
  ds_read_b64_tr_b16 v[202:203], v216 offset:5120
  v_mfma_f32_32x32x16_bf16 v[16:31], v[188:191], v[128:131], v[16:31]
  ds_read_b64_tr_b16 v[204:205], v217 offset:4096
  ds_read_b64_tr_b16 v[206:207], v217 offset:5120
  s_add_u32 s69, s49, 13312
  v_mfma_f32_32x32x16_bf16 v[32:47], v[192:195], v[128:131], v[32:47]
  ds_read_b64_tr_b16 v[208:209], v218 offset:4096
  ds_read_b64_tr_b16 v[210:211], v218 offset:5120
  s_add_u32 s71, s69, s50
  v_mfma_f32_32x32x16_bf16 v[48:63], v[196:199], v[128:131], v[48:63]
  ds_read_b64_tr_b16 v[212:213], v219 offset:4096
  ds_read_b64_tr_b16 v[214:215], v219 offset:5120
  buffer_load_dwordx4 v[128:131], v244, s[24:27], s69 offen offset:0 sc1
  v_mfma_f32_32x32x16_bf16 v[64:79], v[184:187], v[132:135], v[64:79]
  s_add_u32 s70, s70, 8192
  s_add_u32 m0, s74, 83968
  v_mfma_f32_32x32x16_bf16 v[80:95], v[188:191], v[132:135], v[80:95]
  buffer_load_dwordx4 v245, s[32:35], s70 offen lds
  s_add_u32 s70, s70, 8192
  s_add_u32 m0, s74, 84992
  v_mfma_f32_32x32x16_bf16 v[96:111], v[192:195], v[132:135], v[96:111]
  buffer_load_dwordx4 v245, s[32:35], s70 offen lds
  v_mfma_f32_32x32x16_bf16 v[112:127], v[196:199], v[132:135], v[112:127]
  buffer_load_dwordx4 v[132:135], v244, s[24:27], s71 offen offset:0 sc1
  s_barrier
  s_waitcnt vmcnt(25)
  s_waitcnt lgkmcnt(0)
  v_mfma_f32_32x32x16_bf16 v[0:15], v[200:203], v[136:139], v[0:15]
  ds_read_b64_tr_b16 v[184:185], v216 offset:16384
  ds_read_b64_tr_b16 v[186:187], v216 offset:17408
  v_mfma_f32_32x32x16_bf16 v[16:31], v[204:207], v[136:139], v[16:31]
  ds_read_b64_tr_b16 v[188:189], v217 offset:16384
  ds_read_b64_tr_b16 v[190:191], v217 offset:17408
  s_add_u32 s69, s49, 34816
  v_mfma_f32_32x32x16_bf16 v[32:47], v[208:211], v[136:139], v[32:47]
  ds_read_b64_tr_b16 v[192:193], v218 offset:16384
  ds_read_b64_tr_b16 v[194:195], v218 offset:17408
  s_add_u32 s71, s69, s50
  v_mfma_f32_32x32x16_bf16 v[48:63], v[212:215], v[136:139], v[48:63]
  ds_read_b64_tr_b16 v[196:197], v219 offset:16384
  ds_read_b64_tr_b16 v[198:199], v219 offset:17408
  buffer_load_dwordx4 v[136:139], v244, s[24:27], s69 offen offset:0 sc1
  v_mfma_f32_32x32x16_bf16 v[64:79], v[200:203], v[140:143], v[64:79]
  s_add_u32 s70, s68, 2949120
  s_add_u32 m0, s74, 98304
  v_mfma_f32_32x32x16_bf16 v[80:95], v[204:207], v[140:143], v[80:95]
  buffer_load_dwordx4 v245, s[32:35], s70 offen lds
  s_add_u32 s70, s70, 8192
  s_add_u32 m0, s74, 99328
  v_mfma_f32_32x32x16_bf16 v[96:111], v[208:211], v[140:143], v[96:111]
  buffer_load_dwordx4 v245, s[32:35], s70 offen lds
  v_mfma_f32_32x32x16_bf16 v[112:127], v[212:215], v[140:143], v[112:127]
  buffer_load_dwordx4 v[140:143], v244, s[24:27], s71 offen offset:0 sc1
  buffer_load_dwordx2 v[248:249], off, s[44:47], s79 sc1
  s_waitcnt vmcnt(26)
  s_waitcnt lgkmcnt(0)
  v_mfma_f32_32x32x16_bf16 v[0:15], v[184:187], v[144:147], v[0:15]
  ds_read_b64_tr_b16 v[200:201], v216 offset:20480
  ds_read_b64_tr_b16 v[202:203], v216 offset:21504
  s_add_u32 s70, s70, 8192
  s_add_u32 m0, s74, 100352
  v_mfma_f32_32x32x16_bf16 v[16:31], v[188:191], v[144:147], v[16:31]
  ds_read_b64_tr_b16 v[204:205], v217 offset:20480
  ds_read_b64_tr_b16 v[206:207], v217 offset:21504
  buffer_load_dwordx4 v245, s[32:35], s70 offen lds
  s_add_u32 s69, s49, 41984
  s_add_u32 s71, s69, s50
  v_mfma_f32_32x32x16_bf16 v[32:47], v[192:195], v[144:147], v[32:47]
  ds_read_b64_tr_b16 v[208:209], v218 offset:20480
  ds_read_b64_tr_b16 v[210:211], v218 offset:21504
  s_add_u32 s70, s70, 8192
  s_add_u32 m0, s74, 101376
  v_mfma_f32_32x32x16_bf16 v[48:63], v[196:199], v[144:147], v[48:63]
  ds_read_b64_tr_b16 v[212:213], v219 offset:20480
  ds_read_b64_tr_b16 v[214:215], v219 offset:21504
  buffer_load_dwordx4 v[144:147], v244, s[24:27], s69 offen offset:0 sc1
  buffer_load_dwordx4 v245, s[32:35], s70 offen lds
  v_mfma_f32_32x32x16_bf16 v[64:79], v[184:187], v[148:151], v[64:79]
  s_mov_b32 s3, 1835008
  s_add_u32 m0, s74, 114688
  v_mfma_f32_32x32x16_bf16 v[80:95], v[188:191], v[148:151], v[80:95]
  buffer_load_dwordx4 v254, s[36:39], s3 offen lds
  s_mov_b32 s3, 1851392
  s_add_u32 m0, s74, 115712
  v_mfma_f32_32x32x16_bf16 v[96:111], v[192:195], v[148:151], v[96:111]
  buffer_load_dwordx4 v254, s[36:39], s3 offen lds
  v_mfma_f32_32x32x16_bf16 v[112:127], v[196:199], v[148:151], v[112:127]
  buffer_load_dwordx4 v[148:151], v244, s[24:27], s71 offen offset:0 sc1
  s_barrier
  s_waitcnt vmcnt(27)
  s_waitcnt lgkmcnt(0)
  v_mfma_f32_32x32x16_bf16 v[0:15], v[200:203], v[152:155], v[0:15]
  ds_read_b64_tr_b16 v[184:185], v216 offset:32768
  ds_read_b64_tr_b16 v[186:187], v216 offset:33792
  v_mfma_f32_32x32x16_bf16 v[16:31], v[204:207], v[152:155], v[16:31]
  ds_read_b64_tr_b16 v[188:189], v217 offset:32768
  ds_read_b64_tr_b16 v[190:191], v217 offset:33792
  s_add_u32 s69, s49, 63488
  v_mfma_f32_32x32x16_bf16 v[32:47], v[208:211], v[152:155], v[32:47]
  ds_read_b64_tr_b16 v[192:193], v218 offset:32768
  ds_read_b64_tr_b16 v[194:195], v218 offset:33792
  s_add_u32 s71, s69, s50
  v_mfma_f32_32x32x16_bf16 v[48:63], v[212:215], v[152:155], v[48:63]
  ds_read_b64_tr_b16 v[196:197], v219 offset:32768
  ds_read_b64_tr_b16 v[198:199], v219 offset:33792
  buffer_load_dwordx4 v[152:155], v244, s[24:27], s69 offen offset:0 sc1
  v_mfma_f32_32x32x16_bf16 v[64:79], v[200:203], v[156:159], v[64:79]
  s_mov_b32 s70, 0
  s_add_u32 m0, s74, 0
  v_mfma_f32_32x32x16_bf16 v[80:95], v[204:207], v[156:159], v[80:95]
  buffer_load_dwordx4 v254, s[36:39], s70 offen lds
  s_add_u32 s70, s70, 16384
  s_add_u32 m0, s74, 1024
  v_mfma_f32_32x32x16_bf16 v[96:111], v[208:211], v[156:159], v[96:111]
  buffer_load_dwordx4 v254, s[36:39], s70 offen lds
  v_mfma_f32_32x32x16_bf16 v[112:127], v[212:215], v[156:159], v[112:127]
  buffer_load_dwordx4 v[156:159], v244, s[24:27], s71 offen offset:0 sc1
  s_waitcnt vmcnt(27)
  s_waitcnt lgkmcnt(0)
  v_mfma_f32_32x32x16_bf16 v[0:15], v[184:187], v[160:163], v[0:15]
  ds_read_b64_tr_b16 v[200:201], v216 offset:36864
  ds_read_b64_tr_b16 v[202:203], v216 offset:37888
  s_add_u32 s70, s70, 16384
  s_add_u32 m0, s74, 2048
  v_mfma_f32_32x32x16_bf16 v[16:31], v[188:191], v[160:163], v[16:31]
  ds_read_b64_tr_b16 v[204:205], v217 offset:36864
  ds_read_b64_tr_b16 v[206:207], v217 offset:37888
  buffer_load_dwordx4 v254, s[36:39], s70 offen lds
  s_add_u32 s69, s49, 70656
  s_add_u32 s71, s69, s50
  v_mfma_f32_32x32x16_bf16 v[32:47], v[192:195], v[160:163], v[32:47]
  ds_read_b64_tr_b16 v[208:209], v218 offset:36864
  ds_read_b64_tr_b16 v[210:211], v218 offset:37888
  s_add_u32 s70, s70, 16384
  s_add_u32 m0, s74, 3072
  v_mfma_f32_32x32x16_bf16 v[48:63], v[196:199], v[160:163], v[48:63]
  ds_read_b64_tr_b16 v[212:213], v219 offset:36864
  ds_read_b64_tr_b16 v[214:215], v219 offset:37888
  buffer_load_dwordx4 v[160:163], v244, s[24:27], s69 offen offset:0 sc1
  buffer_load_dwordx4 v254, s[36:39], s70 offen lds
  v_mfma_f32_32x32x16_bf16 v[64:79], v[184:187], v[164:167], v[64:79]
  s_mov_b32 s3, 1867776
  s_add_u32 m0, s74, 116736
  v_mfma_f32_32x32x16_bf16 v[80:95], v[188:191], v[164:167], v[80:95]
  buffer_load_dwordx4 v254, s[36:39], s3 offen lds
  s_mov_b32 s3, 1884160
  s_add_u32 m0, s74, 117760
  v_mfma_f32_32x32x16_bf16 v[96:111], v[192:195], v[164:167], v[96:111]
  buffer_load_dwordx4 v254, s[36:39], s3 offen lds
  v_mfma_f32_32x32x16_bf16 v[112:127], v[196:199], v[164:167], v[112:127]
  buffer_load_dwordx4 v[164:167], v244, s[24:27], s71 offen offset:0 sc1
  s_barrier
  s_waitcnt vmcnt(29)
  s_waitcnt lgkmcnt(0)
  v_mfma_f32_32x32x16_bf16 v[0:15], v[200:203], v[168:171], v[0:15]
  ds_read_b64_tr_b16 v[184:185], v216 offset:49152
  ds_read_b64_tr_b16 v[186:187], v216 offset:50176
  v_mfma_f32_32x32x16_bf16 v[16:31], v[204:207], v[168:171], v[16:31]
  ds_read_b64_tr_b16 v[188:189], v217 offset:49152
  ds_read_b64_tr_b16 v[190:191], v217 offset:50176
  s_add_u32 s69, s49, 92160
  v_mfma_f32_32x32x16_bf16 v[32:47], v[208:211], v[168:171], v[32:47]
  ds_read_b64_tr_b16 v[192:193], v218 offset:49152
  ds_read_b64_tr_b16 v[194:195], v218 offset:50176
  s_add_u32 s71, s69, s50
  v_mfma_f32_32x32x16_bf16 v[48:63], v[212:215], v[168:171], v[48:63]
  ds_read_b64_tr_b16 v[196:197], v219 offset:49152
  ds_read_b64_tr_b16 v[198:199], v219 offset:50176
  buffer_load_dwordx4 v[168:171], v244, s[24:27], s69 offen offset:0 sc1
  v_mfma_f32_32x32x16_bf16 v[64:79], v[200:203], v[172:175], v[64:79]
  s_mov_b32 s70, 262144
  s_add_u32 m0, s74, 16384
  v_mfma_f32_32x32x16_bf16 v[80:95], v[204:207], v[172:175], v[80:95]
  buffer_load_dwordx4 v254, s[36:39], s70 offen lds
  s_add_u32 s70, s70, 16384
  s_add_u32 m0, s74, 17408
  v_mfma_f32_32x32x16_bf16 v[96:111], v[208:211], v[172:175], v[96:111]
  buffer_load_dwordx4 v254, s[36:39], s70 offen lds
  v_mfma_f32_32x32x16_bf16 v[112:127], v[212:215], v[172:175], v[112:127]
  buffer_load_dwordx4 v[172:175], v244, s[24:27], s71 offen offset:0 sc1
  s_waitcnt vmcnt(20)
  v_cmp_eq_u64 vcc, s[54:55], v[248:249]
  s_cmp_eq_u64 vcc, -1
  s_cbranch_scc0 L_waitf
L_waitf_ret:
  s_waitcnt lgkmcnt(0)
  v_mfma_f32_32x32x16_bf16 v[0:15], v[184:187], v[176:179], v[0:15]
  ds_read_b64_tr_b16 v[200:201], v216 offset:53248
  ds_read_b64_tr_b16 v[202:203], v216 offset:54272
  v_mfma_f32_32x32x16_bf16 v[16:31], v[188:191], v[176:179], v[16:31]
  ds_read_b64_tr_b16 v[204:205], v217 offset:53248
  ds_read_b64_tr_b16 v[206:207], v217 offset:54272
  s_add_u32 s69, s49, 99328
  v_mfma_f32_32x32x16_bf16 v[32:47], v[192:195], v[176:179], v[32:47]
  ds_read_b64_tr_b16 v[208:209], v218 offset:53248
  ds_read_b64_tr_b16 v[210:211], v218 offset:54272
  s_add_u32 s71, s69, s50
  v_mfma_f32_32x32x16_bf16 v[48:63], v[196:199], v[176:179], v[48:63]
  ds_read_b64_tr_b16 v[212:213], v219 offset:53248
  ds_read_b64_tr_b16 v[214:215], v219 offset:54272
  buffer_load_dwordx4 v[176:179], v244, s[24:27], s69 offen offset:0 sc1
  v_mfma_f32_32x32x16_bf16 v[64:79], v[184:187], v[180:183], v[64:79]
  s_add_u32 s70, s70, 16384
  s_add_u32 m0, s74, 18432
  v_mfma_f32_32x32x16_bf16 v[80:95], v[188:191], v[180:183], v[80:95]
  buffer_load_dwordx4 v254, s[36:39], s70 offen lds
  s_add_u32 s70, s70, 16384
  s_add_u32 m0, s74, 19456
  v_mfma_f32_32x32x16_bf16 v[96:111], v[192:195], v[180:183], v[96:111]
  buffer_load_dwordx4 v254, s[36:39], s70 offen lds
  v_mfma_f32_32x32x16_bf16 v[112:127], v[196:199], v[180:183], v[112:127]
  buffer_load_dwordx4 v[180:183], v244, s[24:27], s71 offen offset:0 sc1
  s_barrier
  s_waitcnt lgkmcnt(0)
  v_mfma_f32_32x32x16_bf16 v[0:15], v[200:203], v[128:131], v[0:15]
  ds_read_b64_tr_b16 v[184:185], v220 offset:0
  ds_read_b64_tr_b16 v[186:187], v220 offset:1024
  v_mfma_f32_32x32x16_bf16 v[16:31], v[204:207], v[128:131], v[16:31]
  ds_read_b64_tr_b16 v[188:189], v221 offset:0
  ds_read_b64_tr_b16 v[190:191], v221 offset:1024
  v_mfma_f32_32x32x16_bf16 v[32:47], v[208:211], v[128:131], v[32:47]
  ds_read_b64_tr_b16 v[192:193], v222 offset:0
  ds_read_b64_tr_b16 v[194:195], v222 offset:1024
  v_mfma_f32_32x32x16_bf16 v[48:63], v[212:215], v[128:131], v[48:63]
  ds_read_b64_tr_b16 v[196:197], v223 offset:0
  ds_read_b64_tr_b16 v[198:199], v223 offset:1024
  v_mfma_f32_32x32x16_bf16 v[64:79], v[200:203], v[132:135], v[64:79]
  s_mov_b32 s70, 524288
  s_add_u32 m0, s74, 32768
  v_mfma_f32_32x32x16_bf16 v[80:95], v[204:207], v[132:135], v[80:95]
  buffer_load_dwordx4 v254, s[36:39], s70 offen lds
  s_add_u32 s70, s70, 16384
  s_add_u32 m0, s74, 33792
  v_mfma_f32_32x32x16_bf16 v[96:111], v[208:211], v[132:135], v[96:111]
  buffer_load_dwordx4 v254, s[36:39], s70 offen lds
  v_mfma_f32_32x32x16_bf16 v[112:127], v[212:215], v[132:135], v[112:127]
  s_waitcnt lgkmcnt(0)
  v_mfma_f32_32x32x16_bf16 v[0:15], v[184:187], v[136:139], v[0:15]
  ds_read_b64_tr_b16 v[200:201], v220 offset:4096
  ds_read_b64_tr_b16 v[202:203], v220 offset:5120
  v_mfma_f32_32x32x16_bf16 v[16:31], v[188:191], v[136:139], v[16:31]
  ds_read_b64_tr_b16 v[204:205], v221 offset:4096
  ds_read_b64_tr_b16 v[206:207], v221 offset:5120
  v_mfma_f32_32x32x16_bf16 v[32:47], v[192:195], v[136:139], v[32:47]
  ds_read_b64_tr_b16 v[208:209], v222 offset:4096
  ds_read_b64_tr_b16 v[210:211], v222 offset:5120
  v_mfma_f32_32x32x16_bf16 v[48:63], v[196:199], v[136:139], v[48:63]
  ds_read_b64_tr_b16 v[212:213], v223 offset:4096
  ds_read_b64_tr_b16 v[214:215], v223 offset:5120
  v_mfma_f32_32x32x16_bf16 v[64:79], v[184:187], v[140:143], v[64:79]
  s_add_u32 s70, s70, 16384
  s_add_u32 m0, s74, 34816
  v_mfma_f32_32x32x16_bf16 v[80:95], v[188:191], v[140:143], v[80:95]
  buffer_load_dwordx4 v254, s[36:39], s70 offen lds
  s_add_u32 s70, s70, 16384
  s_add_u32 m0, s74, 35840
  v_mfma_f32_32x32x16_bf16 v[96:111], v[192:195], v[140:143], v[96:111]
  buffer_load_dwordx4 v254, s[36:39], s70 offen lds
  v_mfma_f32_32x32x16_bf16 v[112:127], v[196:199], v[140:143], v[112:127]
  s_barrier
  s_waitcnt vmcnt(22)
  s_waitcnt lgkmcnt(0)
  v_mfma_f32_32x32x16_bf16 v[0:15], v[200:203], v[144:147], v[0:15]
  ds_read_b64_tr_b16 v[184:185], v220 offset:16384
  ds_read_b64_tr_b16 v[186:187], v220 offset:17408
  v_mfma_f32_32x32x16_bf16 v[16:31], v[204:207], v[144:147], v[16:31]
  ds_read_b64_tr_b16 v[188:189], v221 offset:16384
  ds_read_b64_tr_b16 v[190:191], v221 offset:17408
  v_mfma_f32_32x32x16_bf16 v[32:47], v[208:211], v[144:147], v[32:47]
  ds_read_b64_tr_b16 v[192:193], v222 offset:16384
  ds_read_b64_tr_b16 v[194:195], v222 offset:17408
  v_mfma_f32_32x32x16_bf16 v[48:63], v[212:215], v[144:147], v[48:63]
  ds_read_b64_tr_b16 v[196:197], v223 offset:16384
  ds_read_b64_tr_b16 v[198:199], v223 offset:17408
  v_mfma_f32_32x32x16_bf16 v[64:79], v[200:203], v[148:151], v[64:79]
  s_mov_b32 s70, 786432
  s_add_u32 m0, s74, 49152
  v_mfma_f32_32x32x16_bf16 v[80:95], v[204:207], v[148:151], v[80:95]
  buffer_load_dwordx4 v254, s[36:39], s70 offen lds
  s_add_u32 s70, s70, 16384
  s_add_u32 m0, s74, 50176
  v_mfma_f32_32x32x16_bf16 v[96:111], v[208:211], v[148:151], v[96:111]
  buffer_load_dwordx4 v254, s[36:39], s70 offen lds
  v_mfma_f32_32x32x16_bf16 v[112:127], v[212:215], v[148:151], v[112:127]
  s_waitcnt vmcnt(20)
  s_waitcnt lgkmcnt(0)
  v_mfma_f32_32x32x16_bf16 v[0:15], v[184:187], v[152:155], v[0:15]
  ds_read_b64_tr_b16 v[200:201], v220 offset:20480
  ds_read_b64_tr_b16 v[202:203], v220 offset:21504
  v_mfma_f32_32x32x16_bf16 v[16:31], v[188:191], v[152:155], v[16:31]
  ds_read_b64_tr_b16 v[204:205], v221 offset:20480
  ds_read_b64_tr_b16 v[206:207], v221 offset:21504
  v_mfma_f32_32x32x16_bf16 v[32:47], v[192:195], v[152:155], v[32:47]
  ds_read_b64_tr_b16 v[208:209], v222 offset:20480
  ds_read_b64_tr_b16 v[210:211], v222 offset:21504
  v_mfma_f32_32x32x16_bf16 v[48:63], v[196:199], v[152:155], v[48:63]
  ds_read_b64_tr_b16 v[212:213], v223 offset:20480
  ds_read_b64_tr_b16 v[214:215], v223 offset:21504
  v_mfma_f32_32x32x16_bf16 v[64:79], v[184:187], v[156:159], v[64:79]
  s_add_u32 s70, s70, 16384
  s_add_u32 m0, s74, 51200
  v_mfma_f32_32x32x16_bf16 v[80:95], v[188:191], v[156:159], v[80:95]
  buffer_load_dwordx4 v254, s[36:39], s70 offen lds
  s_add_u32 s70, s70, 16384
  s_add_u32 m0, s74, 52224
  v_mfma_f32_32x32x16_bf16 v[96:111], v[192:195], v[156:159], v[96:111]
  buffer_load_dwordx4 v254, s[36:39], s70 offen lds
  v_mfma_f32_32x32x16_bf16 v[112:127], v[196:199], v[156:159], v[112:127]
  s_barrier
  s_waitcnt vmcnt(16)
  s_waitcnt lgkmcnt(0)
  v_mfma_f32_32x32x16_bf16 v[0:15], v[200:203], v[160:163], v[0:15]
  ds_read_b64_tr_b16 v[184:185], v220 offset:32768
  ds_read_b64_tr_b16 v[186:187], v220 offset:33792
  v_mfma_f32_32x32x16_bf16 v[16:31], v[204:207], v[160:163], v[16:31]
  ds_read_b64_tr_b16 v[188:189], v221 offset:32768
  ds_read_b64_tr_b16 v[190:191], v221 offset:33792
  v_mfma_f32_32x32x16_bf16 v[32:47], v[208:211], v[160:163], v[32:47]
  ds_read_b64_tr_b16 v[192:193], v222 offset:32768
  ds_read_b64_tr_b16 v[194:195], v222 offset:33792
  v_mfma_f32_32x32x16_bf16 v[48:63], v[212:215], v[160:163], v[48:63]
  ds_read_b64_tr_b16 v[196:197], v223 offset:32768
  ds_read_b64_tr_b16 v[198:199], v223 offset:33792
  v_mfma_f32_32x32x16_bf16 v[64:79], v[200:203], v[164:167], v[64:79]
  s_mov_b32 s70, 1048576
  s_add_u32 m0, s74, 65536
  v_mfma_f32_32x32x16_bf16 v[80:95], v[204:207], v[164:167], v[80:95]
  buffer_load_dwordx4 v254, s[36:39], s70 offen lds
  s_add_u32 s70, s70, 16384
  s_add_u32 m0, s74, 66560
  v_mfma_f32_32x32x16_bf16 v[96:111], v[208:211], v[164:167], v[96:111]
  buffer_load_dwordx4 v254, s[36:39], s70 offen lds
  v_mfma_f32_32x32x16_bf16 v[112:127], v[212:215], v[164:167], v[112:127]
  s_waitcnt vmcnt(14)
  s_waitcnt lgkmcnt(0)
  v_mfma_f32_32x32x16_bf16 v[0:15], v[184:187], v[168:171], v[0:15]
  ds_read_b64_tr_b16 v[200:201], v220 offset:36864
  ds_read_b64_tr_b16 v[202:203], v220 offset:37888
  v_mfma_f32_32x32x16_bf16 v[16:31], v[188:191], v[168:171], v[16:31]
  ds_read_b64_tr_b16 v[204:205], v221 offset:36864
  ds_read_b64_tr_b16 v[206:207], v221 offset:37888
  v_mfma_f32_32x32x16_bf16 v[32:47], v[192:195], v[168:171], v[32:47]
  ds_read_b64_tr_b16 v[208:209], v222 offset:36864
  ds_read_b64_tr_b16 v[210:211], v222 offset:37888
  v_mfma_f32_32x32x16_bf16 v[48:63], v[196:199], v[168:171], v[48:63]
  ds_read_b64_tr_b16 v[212:213], v223 offset:36864
  ds_read_b64_tr_b16 v[214:215], v223 offset:37888
  v_mfma_f32_32x32x16_bf16 v[64:79], v[184:187], v[172:175], v[64:79]
  s_add_u32 s70, s70, 16384
  s_add_u32 m0, s74, 67584
  v_mfma_f32_32x32x16_bf16 v[80:95], v[188:191], v[172:175], v[80:95]
  buffer_load_dwordx4 v254, s[36:39], s70 offen lds
  s_add_u32 s70, s70, 16384
  s_add_u32 m0, s74, 68608
  v_mfma_f32_32x32x16_bf16 v[96:111], v[192:195], v[172:175], v[96:111]
  buffer_load_dwordx4 v254, s[36:39], s70 offen lds
  v_mfma_f32_32x32x16_bf16 v[112:127], v[196:199], v[172:175], v[112:127]
  s_barrier
  s_waitcnt vmcnt(12)
  s_waitcnt lgkmcnt(0)
  v_mfma_f32_32x32x16_bf16 v[0:15], v[200:203], v[176:179], v[0:15]
  s_mov_b32 s70, 1310720
  s_add_u32 m0, s74, 81920
  v_mfma_f32_32x32x16_bf16 v[16:31], v[204:207], v[176:179], v[16:31]
  buffer_load_dwordx4 v254, s[36:39], s70 offen lds
  v_mfma_f32_32x32x16_bf16 v[32:47], v[208:211], v[176:179], v[32:47]
  s_add_u32 s70, s70, 16384
  s_add_u32 m0, s74, 82944
  v_mfma_f32_32x32x16_bf16 v[48:63], v[212:215], v[176:179], v[48:63]
  buffer_load_dwordx4 v254, s[36:39], s70 offen lds
  v_mfma_f32_32x32x16_bf16 v[64:79], v[200:203], v[180:183], v[64:79]
  s_add_u32 s70, s70, 16384
  s_add_u32 m0, s74, 83968
  v_mfma_f32_32x32x16_bf16 v[80:95], v[204:207], v[180:183], v[80:95]
  buffer_load_dwordx4 v254, s[36:39], s70 offen lds
  s_add_u32 s70, s70, 16384
  s_add_u32 m0, s74, 84992
  v_mfma_f32_32x32x16_bf16 v[96:111], v[208:211], v[180:183], v[96:111]
  buffer_load_dwordx4 v254, s[36:39], s70 offen lds
  v_mfma_f32_32x32x16_bf16 v[112:127], v[212:215], v[180:183], v[112:127]
  s_lshl_b32 s56, s51, 13
  v_add_u32 v250, s56, v244
  v_xor_b32 v251, 16384, v250
  s_nop 6
  s_setprio 2
  ds_write_b128 v250, v[96:99] offset:0
  ds_write_b128 v250, v[100:103] offset:1024
  ds_write_b128 v250, v[104:107] offset:2048
  ds_write_b128 v250, v[108:111] offset:3072
  ds_write_b128 v250, v[112:115] offset:4096
  ds_write_b128 v250, v[116:119] offset:5120
  ds_write_b128 v250, v[120:123] offset:6144
  ds_write_b128 v250, v[124:127] offset:7168
  s_waitcnt vmcnt(8) lgkmcnt(0)
  s_barrier
  s_add_u32 m0, s74, 98304
  s_mov_b32 s70, 1572864
  buffer_load_dwordx4 v254, s[36:39], s70 offen lds
  s_add_u32 m0, s74, 99328
  s_add_u32 s70, s70, 16384
  buffer_load_dwordx4 v254, s[36:39], s70 offen lds
  s_add_u32 m0, s74, 100352
  s_add_u32 s70, s70, 16384
  buffer_load_dwordx4 v254, s[36:39], s70 offen lds
  s_add_u32 m0, s74, 101376
  s_add_u32 s70, s70, 16384
  buffer_load_dwordx4 v254, s[36:39], s70 offen lds
  ds_read_b128 v[96:99], v251 offset:0
  ds_read_b128 v[100:103], v251 offset:1024
  ds_read_b128 v[104:107], v251 offset:2048
  ds_read_b128 v[108:111], v251 offset:3072
  ds_read_b128 v[112:115], v251 offset:4096
  ds_read_b128 v[116:119], v251 offset:5120
  ds_read_b128 v[120:123], v251 offset:6144
  ds_read_b128 v[124:127], v251 offset:7168
  s_waitcnt lgkmcnt(7)
  v_add_f32 v32, v32, v96
  v_add_f32 v33, v33, v97
  v_add_f32 v34, v34, v98
  v_add_f32 v35, v35, v99
  s_waitcnt lgkmcnt(6)
  v_add_f32 v36, v36, v100
  v_add_f32 v37, v37, v101
  v_add_f32 v38, v38, v102
  v_add_f32 v39, v39, v103
  v_cvt_pk_bf16_f32 v32, v32, v33
  v_cvt_pk_bf16_f32 v33, v34, v35
  v_cvt_pk_bf16_f32 v34, v36, v37
  v_cvt_pk_bf16_f32 v35, v38, v39
  v_min_u32 v32, -2, v32
  v_min_u32 v33, -2, v33
  v_min_u32 v34, -2, v34
  v_min_u32 v35, -2, v35
  buffer_store_dwordx4 v[32:35], v244, s[28:31], s58 offen offset:0 sc1
  s_waitcnt lgkmcnt(5)
  v_add_f32 v40, v40, v104
  v_add_f32 v41, v41, v105
  v_add_f32 v42, v42, v106
  v_add_f32 v43, v43, v107
  s_waitcnt lgkmcnt(4)
  v_add_f32 v44, v44, v108
  v_add_f32 v45, v45, v109
  v_add_f32 v46, v46, v110
  v_add_f32 v47, v47, v111
  v_cvt_pk_bf16_f32 v40, v40, v41
  v_cvt_pk_bf16_f32 v41, v42, v43
  v_cvt_pk_bf16_f32 v42, v44, v45
  v_cvt_pk_bf16_f32 v43, v46, v47
  v_min_u32 v40, -2, v40
  v_min_u32 v41, -2, v41
  v_min_u32 v42, -2, v42
  v_min_u32 v43, -2, v43
  buffer_store_dwordx4 v[40:43], v244, s[28:31], s58 offen offset:1024 sc1
  s_waitcnt lgkmcnt(3)
  v_add_f32 v48, v48, v112
  v_add_f32 v49, v49, v113
  v_add_f32 v50, v50, v114
  v_add_f32 v51, v51, v115
  s_waitcnt lgkmcnt(2)
  v_add_f32 v52, v52, v116
  v_add_f32 v53, v53, v117
  v_add_f32 v54, v54, v118
  v_add_f32 v55, v55, v119
  v_cvt_pk_bf16_f32 v48, v48, v49
  v_cvt_pk_bf16_f32 v49, v50, v51
  v_cvt_pk_bf16_f32 v50, v52, v53
  v_cvt_pk_bf16_f32 v51, v54, v55
  v_min_u32 v48, -2, v48
  v_min_u32 v49, -2, v49
  v_min_u32 v50, -2, v50
  v_min_u32 v51, -2, v51
  buffer_store_dwordx4 v[48:51], v244, s[28:31], s58 offen offset:2048 sc1
  s_waitcnt lgkmcnt(1)
  v_add_f32 v56, v56, v120
  v_add_f32 v57, v57, v121
  v_add_f32 v58, v58, v122
  v_add_f32 v59, v59, v123
  s_waitcnt lgkmcnt(0)
  v_add_f32 v60, v60, v124
  v_add_f32 v61, v61, v125
  v_add_f32 v62, v62, v126
  v_add_f32 v63, v63, v127
  v_cvt_pk_bf16_f32 v56, v56, v57
  v_cvt_pk_bf16_f32 v57, v58, v59
  v_cvt_pk_bf16_f32 v58, v60, v61
  v_cvt_pk_bf16_f32 v59, v62, v63
  v_min_u32 v56, -2, v56
  v_min_u32 v57, -2, v57
  v_min_u32 v58, -2, v58
  v_min_u32 v59, -2, v59
  buffer_store_dwordx4 v[56:59], v244, s[28:31], s58 offen offset:3072 sc1
  s_barrier
  ds_write_b128 v250, v[64:67] offset:0
  ds_write_b128 v250, v[68:71] offset:1024
  ds_write_b128 v250, v[72:75] offset:2048
  ds_write_b128 v250, v[76:79] offset:3072
  ds_write_b128 v250, v[80:83] offset:4096
  ds_write_b128 v250, v[84:87] offset:5120
  ds_write_b128 v250, v[88:91] offset:6144
  ds_write_b128 v250, v[92:95] offset:7168
  s_waitcnt vmcnt(8) lgkmcnt(0)
  s_barrier
  buffer_load_dwordx4 v[160:163], v244, s[28:31], s59 offen offset:0 sc1
  buffer_load_dwordx4 v[164:167], v244, s[28:31], s59 offen offset:1024 sc1
  buffer_load_dwordx4 v[168:171], v244, s[28:31], s59 offen offset:2048 sc1
  buffer_load_dwordx4 v[172:175], v244, s[28:31], s59 offen offset:3072 sc1
  ds_read_b128 v[64:67], v251 offset:0
  ds_read_b128 v[68:71], v251 offset:1024
  ds_read_b128 v[72:75], v251 offset:2048
  ds_read_b128 v[76:79], v251 offset:3072
  ds_read_b128 v[80:83], v251 offset:4096
  ds_read_b128 v[84:87], v251 offset:5120
  ds_read_b128 v[88:91], v251 offset:6144
  ds_read_b128 v[92:95], v251 offset:7168
  s_waitcnt lgkmcnt(7)
  v_add_f32 v0, v0, v64
  v_add_f32 v1, v1, v65
  v_add_f32 v2, v2, v66
  v_add_f32 v3, v3, v67
  s_waitcnt lgkmcnt(6)
  v_add_f32 v4, v4, v68
  v_add_f32 v5, v5, v69
  v_add_f32 v6, v6, v70
  v_add_f32 v7, v7, v71
  s_waitcnt lgkmcnt(5)
  v_add_f32 v8, v8, v72
  v_add_f32 v9, v9, v73
  v_add_f32 v10, v10, v74
  v_add_f32 v11, v11, v75
  s_waitcnt lgkmcnt(4)
  v_add_f32 v12, v12, v76
  v_add_f32 v13, v13, v77
  v_add_f32 v14, v14, v78
  v_add_f32 v15, v15, v79
  s_waitcnt lgkmcnt(3)
  v_add_f32 v16, v16, v80
  v_add_f32 v17, v17, v81
  v_add_f32 v18, v18, v82
  v_add_f32 v19, v19, v83
  s_waitcnt lgkmcnt(2)
  v_add_f32 v20, v20, v84
  v_add_f32 v21, v21, v85
  v_add_f32 v22, v22, v86
  v_add_f32 v23, v23, v87
  s_waitcnt lgkmcnt(1)
  v_add_f32 v24, v24, v88
  v_add_f32 v25, v25, v89
  v_add_f32 v26, v26, v90
  v_add_f32 v27, v27, v91
  s_waitcnt lgkmcnt(0)
  v_add_f32 v28, v28, v92
  v_add_f32 v29, v29, v93
  v_add_f32 v30, v30, v94
  v_add_f32 v31, v31, v95
  s_mov_b32 s78, 0
L_inbox:
  s_waitcnt vmcnt(0)
  v_max3_u32 v248, v160, v161, v162
  v_max3_u32 v248, v248, v163, v164
  v_max3_u32 v248, v248, v165, v166
  v_max3_u32 v248, v248, v167, v168
  v_max3_u32 v248, v248, v169, v170
  v_max3_u32 v248, v248, v171, v172
  v_max3_u32 v248, v248, v173, v174
  v_max_u32 v248, v248, v175
  v_cmp_eq_u32 vcc, -1, v248
  s_cbranch_vccz L_inbox_ok
  s_add_u32 s78, s78, 1
  s_cmp_gt_u32 s78, 262144
  s_cbranch_scc1 L_inbox_ok
  buffer_load_dwordx4 v[160:163], v244, s[28:31], s59 offen offset:0 sc1
  buffer_load_dwordx4 v[164:167], v244, s[28:31], s59 offen offset:1024 sc1
  buffer_load_dwordx4 v[168:171], v244, s[28:31], s59 offen offset:2048 sc1
  buffer_load_dwordx4 v[172:175], v244, s[28:31], s59 offen offset:3072 sc1
  s_branch L_inbox
L_inbox_ok:
  v_lshlrev_b32 v128, 16, v160
  v_and_b32 v129, 0xffff0000, v160
  v_lshlrev_b32 v130, 16, v161
  v_and_b32 v131, 0xffff0000, v161
  v_lshlrev_b32 v132, 16, v162
  v_and_b32 v133, 0xffff0000, v162
  v_lshlrev_b32 v134, 16, v163
  v_and_b32 v135, 0xffff0000, v163
  v_lshlrev_b32 v136, 16, v164
  v_and_b32 v137, 0xffff0000, v164
  v_lshlrev_b32 v138, 16, v165
  v_and_b32 v139, 0xffff0000, v165
  v_lshlrev_b32 v140, 16, v166
  v_and_b32 v141, 0xffff0000, v166
  v_lshlrev_b32 v142, 16, v167
  v_and_b32 v143, 0xffff0000, v167
  v_add_f32 v0, v0, v128
  v_add_f32 v1, v1, v129
  v_add_f32 v2, v2, v130
  v_add_f32 v3, v3, v131
  v_add_f32 v4, v4, v132
  v_add_f32 v5, v5, v133
  v_add_f32 v6, v6, v134
  v_add_f32 v7, v7, v135
  v_add_f32 v8, v8, v136
  v_add_f32 v9, v9, v137
  v_add_f32 v10, v10, v138
  v_add_f32 v11, v11, v139
  v_add_f32 v12, v12, v140
  v_add_f32 v13, v13, v141
  v_add_f32 v14, v14, v142
  v_add_f32 v15, v15, v143
  v_mul_f32 v128, 0xbfb8aa3b, v0
  v_mul_f32 v129, 0xbfb8aa3b, v1
  v_mul_f32 v130, 0xbfb8aa3b, v2
  v_mul_f32 v131, 0xbfb8aa3b, v3
  v_mul_f32 v132, 0xbfb8aa3b, v4
  v_mul_f32 v133, 0xbfb8aa3b, v5
  v_mul_f32 v134, 0xbfb8aa3b, v6
  v_mul_f32 v135, 0xbfb8aa3b, v7
  v_mul_f32 v136, 0xbfb8aa3b, v8
  v_mul_f32 v137, 0xbfb8aa3b, v9
  v_mul_f32 v138, 0xbfb8aa3b, v10
  v_mul_f32 v139, 0xbfb8aa3b, v11
  v_mul_f32 v140, 0xbfb8aa3b, v12
  v_mul_f32 v141, 0xbfb8aa3b, v13
  v_mul_f32 v142, 0xbfb8aa3b, v14
  v_mul_f32 v143, 0xbfb8aa3b, v15
  v_exp_f32 v128, v128
  v_exp_f32 v129, v129
  v_exp_f32 v130, v130
  v_exp_f32 v131, v131
  v_exp_f32 v132, v132
  v_exp_f32 v133, v133
  v_exp_f32 v134, v134
  v_exp_f32 v135, v135
  v_exp_f32 v136, v136
  v_exp_f32 v137, v137
  v_exp_f32 v138, v138
  v_exp_f32 v139, v139
  v_exp_f32 v140, v140
  v_exp_f32 v141, v141
  v_exp_f32 v142, v142
  v_exp_f32 v143, v143
  s_nop 0
  v_add_f32 v128, 1.0, v128
  v_add_f32 v129, 1.0, v129
  v_add_f32 v130, 1.0, v130
  v_add_f32 v131, 1.0, v131
  v_add_f32 v132, 1.0, v132
  v_add_f32 v133, 1.0, v133
  v_add_f32 v134, 1.0, v134
  v_add_f32 v135, 1.0, v135
  v_add_f32 v136, 1.0, v136
  v_add_f32 v137, 1.0, v137
  v_add_f32 v138, 1.0, v138
  v_add_f32 v139, 1.0, v139
  v_add_f32 v140, 1.0, v140
  v_add_f32 v141, 1.0, v141
  v_add_f32 v142, 1.0, v142
  v_add_f32 v143, 1.0, v143
  v_rcp_f32 v128, v128
  v_rcp_f32 v129, v129
  v_rcp_f32 v130, v130
  v_rcp_f32 v131, v131
  v_rcp_f32 v132, v132
  v_rcp_f32 v133, v133
  v_rcp_f32 v134, v134
  v_rcp_f32 v135, v135
  v_rcp_f32 v136, v136
  v_rcp_f32 v137, v137
  v_rcp_f32 v138, v138
  v_rcp_f32 v139, v139
  v_rcp_f32 v140, v140
  v_rcp_f32 v141, v141
  v_rcp_f32 v142, v142
  v_rcp_f32 v143, v143
  s_nop 0
  v_mul_f32 v0, v0, v128
  v_mul_f32 v1, v1, v129
  v_mul_f32 v2, v2, v130
  v_mul_f32 v3, v3, v131
  v_mul_f32 v4, v4, v132
  v_mul_f32 v5, v5, v133
  v_mul_f32 v6, v6, v134
  v_mul_f32 v7, v7, v135
  v_mul_f32 v8, v8, v136
  v_mul_f32 v9, v9, v137
  v_mul_f32 v10, v10, v138
  v_mul_f32 v11, v11, v139
  v_mul_f32 v12, v12, v140
  v_mul_f32 v13, v13, v141
  v_mul_f32 v14, v14, v142
  v_mul_f32 v15, v15, v143
  v_lshlrev_b32 v144, 16, v168
  v_and_b32 v145, 0xffff0000, v168
  v_lshlrev_b32 v146, 16, v169
  v_and_b32 v147, 0xffff0000, v169
  v_lshlrev_b32 v148, 16, v170
  v_and_b32 v149, 0xffff0000, v170
  v_lshlrev_b32 v150, 16, v171
  v_and_b32 v151, 0xffff0000, v171
  v_lshlrev_b32 v152, 16, v172
  v_and_b32 v153, 0xffff0000, v172
  v_lshlrev_b32 v154, 16, v173
  v_and_b32 v155, 0xffff0000, v173
  v_lshlrev_b32 v156, 16, v174
  v_and_b32 v157, 0xffff0000, v174
  v_lshlrev_b32 v158, 16, v175
  v_and_b32 v159, 0xffff0000, v175
  v_add_f32 v16, v16, v144
  v_add_f32 v17, v17, v145
  v_add_f32 v18, v18, v146
  v_add_f32 v19, v19, v147
  v_add_f32 v20, v20, v148
  v_add_f32 v21, v21, v149
  v_add_f32 v22, v22, v150
  v_add_f32 v23, v23, v151
  v_add_f32 v24, v24, v152
  v_add_f32 v25, v25, v153
  v_add_f32 v26, v26, v154
  v_add_f32 v27, v27, v155
  v_add_f32 v28, v28, v156
  v_add_f32 v29, v29, v157
  v_add_f32 v30, v30, v158
  v_add_f32 v31, v31, v159
  v_mul_f32 v144, 0xbfb8aa3b, v16
  v_mul_f32 v145, 0xbfb8aa3b, v17
  v_mul_f32 v146, 0xbfb8aa3b, v18
  v_mul_f32 v147, 0xbfb8aa3b, v19
  v_mul_f32 v148, 0xbfb8aa3b, v20
  v_mul_f32 v149, 0xbfb8aa3b, v21
  v_mul_f32 v150, 0xbfb8aa3b, v22
  v_mul_f32 v151, 0xbfb8aa3b, v23
  v_mul_f32 v152, 0xbfb8aa3b, v24
  v_mul_f32 v153, 0xbfb8aa3b, v25
  v_mul_f32 v154, 0xbfb8aa3b, v26
  v_mul_f32 v155, 0xbfb8aa3b, v27
  v_mul_f32 v156, 0xbfb8aa3b, v28
  v_mul_f32 v157, 0xbfb8aa3b, v29
  v_mul_f32 v158, 0xbfb8aa3b, v30
  v_mul_f32 v159, 0xbfb8aa3b, v31
  v_exp_f32 v144, v144
  v_exp_f32 v145, v145
  v_exp_f32 v146, v146
  v_exp_f32 v147, v147
  v_exp_f32 v148, v148
  v_exp_f32 v149, v149
  v_exp_f32 v150, v150
  v_exp_f32 v151, v151
  v_exp_f32 v152, v152
  v_exp_f32 v153, v153
  v_exp_f32 v154, v154
  v_exp_f32 v155, v155
  v_exp_f32 v156, v156
  v_exp_f32 v157, v157
  v_exp_f32 v158, v158
  v_exp_f32 v159, v159
  s_nop 0
  v_add_f32 v144, 1.0, v144
  v_add_f32 v145, 1.0, v145
  v_add_f32 v146, 1.0, v146
  v_add_f32 v147, 1.0, v147
  v_add_f32 v148, 1.0, v148
  v_add_f32 v149, 1.0, v149
  v_add_f32 v150, 1.0, v150
  v_add_f32 v151, 1.0, v151
  v_add_f32 v152, 1.0, v152
  v_add_f32 v153, 1.0, v153
  v_add_f32 v154, 1.0, v154
  v_add_f32 v155, 1.0, v155
  v_add_f32 v156, 1.0, v156
  v_add_f32 v157, 1.0, v157
  v_add_f32 v158, 1.0, v158
  v_add_f32 v159, 1.0, v159
  v_rcp_f32 v144, v144
  v_rcp_f32 v145, v145
  v_rcp_f32 v146, v146
  v_rcp_f32 v147, v147
  v_rcp_f32 v148, v148
  v_rcp_f32 v149, v149
  v_rcp_f32 v150, v150
  v_rcp_f32 v151, v151
  v_rcp_f32 v152, v152
  v_rcp_f32 v153, v153
  v_rcp_f32 v154, v154
  v_rcp_f32 v155, v155
  v_rcp_f32 v156, v156
  v_rcp_f32 v157, v157
  v_rcp_f32 v158, v158
  v_rcp_f32 v159, v159
  s_nop 0
  v_mul_f32 v16, v16, v144
  v_mul_f32 v17, v17, v145
  v_mul_f32 v18, v18, v146
  v_mul_f32 v19, v19, v147
  v_mul_f32 v20, v20, v148
  v_mul_f32 v21, v21, v149
  v_mul_f32 v22, v22, v150
  v_mul_f32 v23, v23, v151
  v_mul_f32 v24, v24, v152
  v_mul_f32 v25, v25, v153
  v_mul_f32 v26, v26, v154
  v_mul_f32 v27, v27, v155
  v_mul_f32 v28, v28, v156
  v_mul_f32 v29, v29, v157
  v_mul_f32 v30, v30, v158
  v_mul_f32 v31, v31, v159
  s_barrier
  ds_write_b128 v250, v[0:3] offset:0
  ds_write_b128 v250, v[4:7] offset:1024
  ds_write_b128 v250, v[8:11] offset:2048
  ds_write_b128 v250, v[12:15] offset:3072
  ds_write_b128 v250, v[16:19] offset:4096
  ds_write_b128 v250, v[20:23] offset:5120
  ds_write_b128 v250, v[24:27] offset:6144
  ds_write_b128 v250, v[28:31] offset:7168
  s_waitcnt lgkmcnt(0)
  s_barrier
  s_endpgm
L_waith0:
  s_mov_b32 s78, 0
  s_mov_b64 vcc, 0
L_pollh0:
  s_not_b64 exec, vcc
  buffer_load_dwordx2 v[248:249], v252, s[44:47], s73 offen sc1
  s_mov_b64 exec, -1
  s_add_u32 s78, s78, 1
  s_cmp_gt_u32 s78, 262144
  s_cbranch_scc1 L_pollh0_done
  s_waitcnt vmcnt(0)
  v_cmp_eq_u64 vcc, s[54:55], v[248:249]
  s_cmp_eq_u64 vcc, -1
  s_cbranch_scc0 L_pollh0
L_pollh0_done:
  s_branch L_waith0_ret
L_waith9:
  s_mov_b32 s78, 0
  s_mov_b64 vcc, 0
L_pollh9:
  s_not_b64 exec, vcc
  buffer_load_dwordx2 v[248:249], v252, s[44:47], s73 offen sc1
  s_mov_b64 exec, -1
  s_add_u32 s78, s78, 1
  s_cmp_gt_u32 s78, 262144
  s_cbranch_scc1 L_pollh9_done
  s_waitcnt vmcnt(0)
  v_cmp_eq_u64 vcc, s[54:55], v[248:249]
  s_cmp_eq_u64 vcc, -1
  s_cbranch_scc0 L_pollh9
L_pollh9_done:
  s_branch L_waith9_ret
L_waith25:
  s_mov_b32 s78, 0
  s_mov_b64 vcc, 0
L_pollh25:
  s_not_b64 exec, vcc
  buffer_load_dwordx2 v[248:249], v252, s[44:47], s73 offen sc1
  s_mov_b64 exec, -1
  s_add_u32 s78, s78, 1
  s_cmp_gt_u32 s78, 262144
  s_cbranch_scc1 L_pollh25_done
  s_waitcnt vmcnt(0)
  v_cmp_eq_u64 vcc, s[54:55], v[248:249]
  s_cmp_eq_u64 vcc, -1
  s_cbranch_scc0 L_pollh25
L_pollh25_done:
  s_branch L_waith25_ret
L_waitf:
  v_mov_b32 v253, 0
  s_mov_b32 s78, 0
  s_mov_b64 vcc, 0
L_pollf:
  s_not_b64 exec, vcc
  buffer_load_dwordx2 v[248:249], v253, s[44:47], s79 offen sc1
  s_mov_b64 exec, -1
  s_add_u32 s78, s78, 1
  s_cmp_gt_u32 s78, 262144
  s_cbranch_scc1 L_pollf_done
  s_waitcnt vmcnt(0)
  v_cmp_eq_u64 vcc, s[54:55], v[248:249]
  s_cmp_eq_u64 vcc, -1
  s_cbranch_scc0 L_pollf
L_pollf_done:
  s_branch L_waitf_ret
L_g1_stop:
  s_mov_b32 s26, 0
  s_mov_b32 s30, 0
  s_mov_b32 s34, 0
  s_mov_b32 s38, 0
  s_mov_b32 s73, 196608
  s_mov_b32 s74, 196608
  s_mov_b32 s75, 196608
  s_mov_b32 s76, 196608
  s_branch L_g1_stop_ret
L_touch:
  v_lshlrev_b32 v224, 7, v221
  s_cmp_eq_u32 s51, 2
  s_cbranch_scc1 L_touch_o
  s_cmp_lg_u32 s51, 3
  s_cbranch_scc1 L_touch_ret
  s_lshr_b32 s56, s2, 3
  s_mul_i32 s56, s56, 229376
  s_and_b32 s57, s2, 7
  s_lshl_b32 s57, s57, 13
  s_add_u32 s56, s56, s57
  s_mov_b32 s40, s16
  s_and_b32 s41, s17, 0xffff
  s_mov_b32 s42, 7340032
  s_mov_b32 s43, 0x20000
  buffer_load_dword v225, v224, s[40:43], s56 offen
  s_mov_b32 s42, 0
  s_branch L_touch_ret
L_touch_o:
  s_lshl_b32 s56, s2, 13
  s_mov_b32 s40, s8
  s_and_b32 s41, s9, 0xffff
  s_mov_b32 s42, 2097152
  s_mov_b32 s43, 0x20000
  buffer_load_dword v225, v224, s[40:43], s56 offen
  s_mov_b32 s42, 0
  s_branch L_touch_ret
L_end:
  s_endpgm
.section .rodata,"a"
.p2align 6
.amdhsa_kernel recurrent_scan__mha_block__swiglu_ffn__prompt_kernel
  .amdhsa_next_free_vgpr 256
  .amdhsa_next_free_sgpr 102
  .amdhsa_accum_offset 256
  .amdhsa_group_segment_fixed_size 0
  .amdhsa_kernarg_size 80
  .amdhsa_user_sgpr_count 2
  .amdhsa_user_sgpr_kernarg_segment_ptr 1
  .amdhsa_system_sgpr_workgroup_id_x 1
.end_amdhsa_kernel
```
